```python
import torch

def _softmax(x, axis=-1):
    return torch.softmax(x, dim=axis)
def _gelu(x):
    return torch.nn.functional.gelu(x, approximate="tanh")
def _silu(x):
    return torch.nn.functional.silu(x)
def _sigmoid(x):
    return torch.sigmoid(x)
def _layernorm(x, axis=-1, eps=1e-5):
    m = x.mean(dim=axis, keepdim=True)
    v = x.var(dim=axis, keepdim=True, unbiased=False)
    return (x - m) / torch.sqrt(v + eps)
def _scatter_add(tgt, idx, src, axis=0):
    return tgt.clone().index_add_(axis, idx, src)
def _segment_sum(src, seg, n):
    out = torch.zeros((n,) + src.shape[1:], dtype=src.dtype)
    return out.index_add_(0, seg, src)
def _pad(x, pw):
    flat = tuple(v for pair in reversed(pw) for v in pair)
    return torch.nn.functional.pad(x, flat)

kernel_name = 'standalone__gqa_block_cached__sampling'

def setup_inputs():

    _w = (lambda a: (lambda t: t.to(torch.bfloat16) if t.is_floating_point() else t)(torch.as_tensor(a)))
    B, Sq, D = 32, 16, 512
    Hq, Hkv, Sk, Dh = 32, 8, 2048, 128
    assert Hq % Hkv == 0, (Hq, Hkv)
    return {
        "x": _w((lambda *s: torch.randn(*s, dtype=torch.bfloat16) * 0.8)(B, Sq, D)),
        "k_cache": _w((lambda *s: torch.randn(*s, dtype=torch.bfloat16) * 0.8)(B, Hkv, Sk, Dh)),
        "v_cache": _w((lambda *s: torch.randn(*s, dtype=torch.bfloat16) * 0.05)(B, Hkv, Sk, Dh)),
        "wq": _w((lambda *s: torch.randn(*s, dtype=torch.bfloat16) * 0.8)(D, Hq * Dh) * (D ** -0.5)),
        "wo": _w((lambda *s: torch.randn(*s, dtype=torch.bfloat16) * 0.05)(Hq * Dh, D) * ((Hq * Dh) ** -0.5)),
    }

def reference(x, k_cache, v_cache, wq, wo):
    B, Sq, D = x.shape
    Hq, Dh = 32, 128
    Hkv = k_cache.shape[1]
    rep = Hq // Hkv
    q = (lambda x, *d: x.permute(*d))((x @ wq).reshape(B, Sq, Hq, Dh), 0, 2, 1, 3)
    k = (lambda x, n, axis: torch.repeat_interleave(x, n, dim=axis))(k_cache, rep, axis=1)
    v = (lambda x, n, axis: torch.repeat_interleave(x, n, dim=axis))(v_cache, rep, axis=1)
    scores = torch.einsum("bhqd,bhkd->bhqk", q, k) * (Dh ** -0.5)
    p = _softmax(scores, axis=-1)
    o = torch.einsum("bhqk,bhkd->bhqd", p, v)
    return (lambda x, *d: x.permute(*d))(o, 0, 2, 1, 3).reshape(B, Sq, Hq * Dh) @ wo
```

```asm
; @launch grid=(256,1,1) block=(256,1,1) lds=163840
.amdgcn_target "amdgcn-amd-amdhsa--gfx950"
.macro MM d,a,b
v_mfma_f32_16x16x32_bf16 v[\d:\d+3], v[\a:\a+3], v[\b:\b+3], v[\d:\d+3]
.endm
.macro MZ d,a,b
v_mfma_f32_16x16x32_bf16 v[\d:\d+3], v[\a:\a+3], v[\b:\b+3], 0
.endm
.macro MA d,a,b
v_mfma_f32_16x16x32_bf16 v[\d:\d+3], a[\a:\a+3], v[\b:\b+3], v[\d:\d+3]
.endm
.macro KR d,a,o
ds_read_b128 v[\d:\d+3], v[\a] offset:\o
.endm
.macro TR d,a,o
ds_read_b64_tr_b16 v[\d:\d+1], v[\a] offset:\o
.endm
.macro MN d,a,b
v_mfma_f32_16x16x32_bf16 v[\d:\d+3], v[\a:\a+3], v[\b:\b+3], v[124:127]
.endm
.macro WB n
s_waitcnt vmcnt(\n) lgkmcnt(0)
.endm
.macro EX r
v_exp_f32 v[\r], v[\r]
.endm
.macro CV d,a
v_cvt_pk_bf16_f32 v[\d], v[\a], v[\a+1]
.endm
.macro AD r
v_add_f32 v119, v119, v[\r]
.endm
.macro WL n
s_waitcnt lgkmcnt(\n)
.endm
.macro WM n
s_waitcnt vmcnt(\n)
.endm
.macro DM v,s,o
buffer_load_dwordx4 v[\v], s[\s:\s+3], s48 offen offset:\o nt lds
.endm
.macro DH v,s,o
buffer_load_dwordx4 v[\v], s[\s:\s+3], s43 offen offset:\o lds
.endm
.text
.globl standalone__gqa_block_cached__sampling_kernel
.p2align 8
.type standalone__gqa_block_cached__sampling_kernel,@function
standalone__gqa_block_cached__sampling_kernel:
s_cmp_ge_u32 s2, 256
s_cbranch_scc0 L_go
s_endpgm
L_go:
s_load_dwordx16 s[64:79], s[0:1], 0
v_lshrrev_b32 v1, 6, v0
v_and_b32 v0, 63, v0
v_readfirstlane_b32 s36, v1
s_and_b32 s37, s2, 7
s_lshr_b32 s38, s2, 3
s_lshr_b32 s43, s38, 0
s_mul_i32 s47, s43, 43
s_lshr_b32 s47, s47, 7
s_mul_i32 s6, s47, 3
s_sub_u32 s6, s43, s6
s_and_b32 s39, s47, 7
s_lshl_b32 s39, s39, 1
s_lshr_b32 s43, s47, 3
s_add_u32 s39, s39, s43
s_lshl_b32 s40, s39, 1
s_lshl_b32 s41, s36, 11
s_lshl_b32 s42, s36, 12
v_lshrrev_b32 v1, 4, v0
v_and_b32 v2, 15, v0
v_bfe_u32 v3, v0, 2, 2
v_and_b32 v4, 3, v0
v_lshlrev_b32 v118, 4, v0
v_lshlrev_b32 v18, 1, v1
v_xor_b32 v16, v2, v18
v_xor_b32 v17, 8, v16
v_lshlrev_b32 v16, 4, v16
v_lshlrev_b32 v17, 4, v17
v_lshl_add_u32 v224, v1, 13, v16
v_lshl_add_u32 v225, v1, 13, v17
v_lshl_add_u32 v114, v1, 8, v16
v_lshl_add_u32 v115, v1, 8, v17
v_add_u32 v114, s41, v114
v_add_u32 v115, s41, v115
v_lshl_add_u32 v116, v1, 10, v16
v_lshl_add_u32 v117, v1, 10, v17
s_and_b32 s43, s36, 1
s_lshl_b32 s43, s43, 3
v_xor_b32 v18, v2, v1
v_xor_b32 v19, s43, v18
v_xor_b32 v16, 4, v19
v_lshlrev_b32 v19, 4, v19
v_lshlrev_b32 v16, 4, v16
v_lshl_add_u32 v112, v1, 8, v19
v_lshl_add_u32 v113, v1, 8, v16
v_add_u32 v112, s41, v112
v_add_u32 v113, s41, v113
s_lshl_b32 s43, s36, 6
v_xor_b32 v226, s43, v118
v_xor_b32 v227, 16, v226
v_xor_b32 v228, 32, v226
v_xor_b32 v229, 48, v226
s_lshl_b32 s57, s38, 18
s_add_u32 s57, s57, 8391680
s_lshr_b32 s45, s2, 13
s_lshl_b32 s46, s2, 19
s_lshl_b32 s43, s38, 14
s_lshl_b32 s44, s37, 2
s_add_u32 s44, s44, s36
s_lshl_b32 s44, s44, 8
WL 0
s_add_u32 s8, s66, s46
s_addc_u32 s9, s67, s45
s_mov_b32 s10, 0x80000
s_mov_b32 s11, 0x20000
s_add_u32 s12, s68, s46
s_addc_u32 s13, s69, s45
s_mov_b32 s14, 0x80000
s_mov_b32 s15, 0x20000
s_add_u32 s20, s64, s43
s_addc_u32 s21, s65, 0
s_mov_b32 s22, 16384
s_mov_b32 s23, 0x20000
s_add_u32 s16, s70, s44
s_addc_u32 s17, s71, 0
s_mov_b32 s18, 4186368
s_mov_b32 s19, 0x20000
s_cmp_eq_u32 s6, 0
s_cbranch_scc1 L_r0
s_mov_b32 s48, 507904
s_add_u32 m0, s41, 40960
s_nop 0
DM 112,8,0
DM 113,8,1024
s_mov_b32 s48, 516096
s_add_u32 m0, s41, 49152
s_nop 0
DM 112,8,0
DM 113,8,1024
s_sub_u32 s43, s38, 0
s_lshl_b32 s43, s43, 17
s_mul_i32 s44, s36, 32512
s_add_u32 s43, s43, s44
v_bfe_u32 v20, v0, 3, 2
v_and_b32 v21, 7, v0
v_lshlrev_b32 v21, 7, v21
v_lshl_add_u32 v20, v20, 13, v21
buffer_load_dword v22, v20, s[16:19], s43 offen
s_mov_b32 s48, 507904
s_add_u32 m0, s41, 98304
s_nop 0
DM 114,12,0
DM 115,12,1024
s_mov_b32 s48, 516096
s_add_u32 m0, s41, 106496
s_nop 0
DM 114,12,0
DM 115,12,1024
s_cmp_lg_u32 s6, 1
s_cbranch_scc1 L_nr1
s_getpc_b64 s[60:61]
L_jr1:
s_add_u32 s60, s60, L_role1-L_jr1
s_addc_u32 s61, s61, 0
s_setpc_b64 s[60:61]
L_nr1:
s_getpc_b64 s[60:61]
L_jr2:
s_add_u32 s60, s60, L_role2-L_jr2
s_addc_u32 s61, s61, 0
s_setpc_b64 s[60:61]
L_r0:
s_add_u32 m0, s42, 24576
s_nop 0
buffer_load_dwordx4 v226, s[20:23], s42 offen offset:0  lds
buffer_load_dwordx4 v227, s[20:23], s42 offen offset:1024  lds
buffer_load_dwordx4 v228, s[20:23], s42 offen offset:2048  lds
buffer_load_dwordx4 v229, s[20:23], s42 offen offset:3072  lds
s_xor_b32 s43, s40, 0
s_lshl_b32 s43, s43, 17
s_add_u32 m0, s42, 114688
s_nop 0
DH 224,16,0
s_add_u32 s43, s43, 31744
DH 225,16,1024
s_add_u32 s43, s43, 31744
DH 224,16,2048
s_add_u32 s43, s43, 31744
DH 225,16,3072
s_xor_b32 s43, s40, 1
s_lshl_b32 s43, s43, 17
s_add_u32 m0, s42, 131072
s_nop 0
DH 224,16,0
s_add_u32 s43, s43, 31744
DH 225,16,1024
s_add_u32 s43, s43, 31744
DH 224,16,2048
s_add_u32 s43, s43, 31744
DH 225,16,3072
s_mov_b32 s28, s78
s_mov_b32 s29, s79
s_mov_b32 s30, 0x20000000
s_mov_b32 s31, 0x20000
buffer_load_dword v6, off, s[28:31], s57 sc1
s_getpc_b64 s[60:61]
L_pcp0:
s_sub_u32 s60, s60, L_pcp0-standalone__gqa_block_cached__sampling_kernel
s_subb_u32 s61, s61, 0
s_mov_b32 s62, L_codeend-standalone__gqa_block_cached__sampling_kernel
s_mov_b32 s63, 0x20000
s_lshl_b32 s43, s38, 2
s_add_u32 s43, s43, s36
s_lshl_b32 s43, s43, 11
v_lshlrev_b32 v8, 7, v2
buffer_load_dword v9, v8, s[60:63], s43 offen
s_lshl_b32 s43, s37, 19
s_lshl_b32 s44, s36, 8
s_add_u32 s43, s43, s44
s_add_u32 s24, s72, s43
s_addc_u32 s25, s73, 0
s_mov_b32 s26, 523520
s_mov_b32 s27, 0x20000
s_xor_b32 s43, s40, 2
s_lshl_b32 s43, s43, 17
s_add_u32 m0, s42, 147456
s_nop 0
DH 224,16,0
s_add_u32 s43, s43, 31744
DH 225,16,1024
s_add_u32 s43, s43, 31744
DH 224,16,2048
s_add_u32 s43, s43, 31744
DH 225,16,3072
s_lshl_b32 s43, s38, 14
s_add_u32 s32, s74, s43
s_addc_u32 s33, s75, 0
s_mov_b32 s34, 16384
s_mov_b32 s35, 0x20000
s_mov_b32 s50, 0x3e0293ee
s_mov_b32 s51, 0x41000000
s_mov_b32 s54, 0xfffffc00
s_getpc_b64 s[58:59]
L_pc0:
s_add_u32 s4, s58, L_burst-L_pc0
s_addc_u32 s5, s59, 0
s_add_u32 s64, s58, L_slow1-L_pc0
s_addc_u32 s65, s59, 0
s_add_u32 s58, s58, L_slow0-L_pc0
s_addc_u32 s59, s59, 0
s_lshl_b32 s52, s36, 17
s_add_u32 s52, s52, 262144
s_add_u32 s43, s36, 0
s_and_b32 s44, s43, 1
s_lshl_b32 s44, s44, 12
s_bitcmp1_b32 s43, 1
s_cselect_b32 s43, 40960, 0
s_add_u32 s43, s43, s44
s_add_u32 s66, s43, 24576
s_add_u32 s43, s36, 2
s_and_b32 s44, s43, 1
s_lshl_b32 s44, s44, 12
s_bitcmp1_b32 s43, 1
s_cselect_b32 s43, 40960, 0
s_add_u32 s43, s43, s44
s_add_u32 s67, s43, 24576
s_add_u32 s43, s36, 3
s_and_b32 s44, s43, 1
s_lshl_b32 s44, s44, 12
s_bitcmp1_b32 s43, 1
s_cselect_b32 s43, 40960, 0
s_add_u32 s43, s43, s44
s_add_u32 s68, s43, 24576
s_add_u32 s43, s36, 1
s_and_b32 s44, s43, 1
s_lshl_b32 s44, s44, 12
s_bitcmp1_b32 s43, 1
s_cselect_b32 s43, 40960, 0
s_add_u32 s43, s43, s44
s_add_u32 s69, s43, 24576
s_lshl_b32 s43, s38, 3
s_lshl_b32 s44, s36, 1
s_add_u32 s43, s43, s44
s_lshl_b32 s43, s43, 3
s_add_u32 s43, s43, s37
s_lshl_b32 s43, s43, 12
s_add_u32 s70, s43, 8388608
s_add_u32 s71, s70, 32768
s_lshl_b32 s72, s2, 15
s_lshl_b32 s43, s36, 10
s_add_u32 s72, s72, s43
s_add_u32 s72, s72, 8388608
s_mul_i32 s43, s36, 3
s_add_u32 s43, s43, 0
s_lshr_b32 s44, s43, 1
s_lshl_b32 s44, s44, 5
s_and_b32 s45, s43, 1
s_lshl_b32 s45, s45, 2
s_add_u32 s44, s44, s45
s_lshl_b32 s45, s37, 7
s_add_u32 s44, s44, s45
s_cmp_lt_u32 s43, 8
s_cselect_b32 s73, s44, 0x40000000
s_mul_i32 s43, s36, 3
s_add_u32 s43, s43, 1
s_lshr_b32 s44, s43, 1
s_lshl_b32 s44, s44, 5
s_and_b32 s45, s43, 1
s_lshl_b32 s45, s45, 2
s_add_u32 s44, s44, s45
s_lshl_b32 s45, s37, 7
s_add_u32 s44, s44, s45
s_cmp_lt_u32 s43, 8
s_cselect_b32 s74, s44, 0x40000000
s_mul_i32 s43, s36, 3
s_add_u32 s43, s43, 2
s_lshr_b32 s44, s43, 1
s_lshl_b32 s44, s44, 5
s_and_b32 s45, s43, 1
s_lshl_b32 s45, s45, 2
s_add_u32 s44, s44, s45
s_lshl_b32 s45, s37, 7
s_add_u32 s44, s44, s45
s_cmp_lt_u32 s43, 8
s_cselect_b32 s75, s44, 0x40000000
s_mul_i32 s3, s47, 43
s_lshr_b32 s3, s3, 7
s_mul_i32 s3, s3, 3
s_sub_u32 s3, s47, s3
v_lshlrev_b32 v18, 4, v18
v_lshl_add_u32 v100, v2, 8, v18
v_xor_b32 v101, 64, v100
v_xor_b32 v102, 128, v100
v_xor_b32 v103, 192, v100
v_and_b32 v16, 1, v1
v_lshl_add_u32 v16, v16, 2, v3
v_lshlrev_b32 v16, 5, v16
v_lshl_add_u32 v16, v4, 3, v16
v_lshl_add_u32 v17, v1, 2, v3
v_lshl_add_u32 v16, v17, 8, v16
v_add_u32 v104, 57344, v16
v_xor_b32 v105, 32, v104
v_xor_b32 v106, 64, v104
v_xor_b32 v107, 96, v104
v_xor_b32 v108, 128, v104
v_xor_b32 v109, 160, v104
v_xor_b32 v110, 192, v104
v_xor_b32 v111, 224, v104
v_lshrrev_b32 v8, 1, v1
v_xor_b32 v8, v8, v2
v_lshlrev_b32 v8, 4, v8
v_and_b32 v10, 1, v1
v_lshl_add_u32 v8, v10, 3, v8
v_lshl_add_u32 v8, v2, 10, v8
s_lshl_b32 s43, s39, 6
v_xor_b32 v8, s43, v8
v_add_u32 v11, 24576, v8
s_add_u32 s43, s42, 57344
v_add_u32 v248, s43, v104
v_add_u32 v249, s43, v105
v_add_u32 v250, s43, v106
v_add_u32 v251, s43, v107
v_add_u32 v252, s43, v108
v_add_u32 v253, s43, v109
v_add_u32 v254, s43, v110
v_add_u32 v255, s43, v111
WM 10
TR 56,248,0
TR 60,249,0
TR 64,250,0
TR 68,251,0
TR 72,252,0
TR 76,253,0
TR 80,254,0
TR 84,255,0
WL 0
s_xor_b32 s43, s40, 3
s_lshl_b32 s43, s43, 17
s_add_u32 m0, s42, 114688
s_nop 0
DH 224,16,0
s_add_u32 s43, s43, 31744
DH 225,16,1024
s_add_u32 s43, s43, 31744
DH 224,16,2048
s_add_u32 s43, s43, 31744
DH 225,16,3072
WM 10
TR 58,248,16384
TR 62,249,16384
TR 66,250,16384
TR 70,251,16384
TR 74,252,16384
TR 78,253,16384
TR 82,254,16384
TR 86,255,16384
WL 0
s_xor_b32 s43, s40, 4
s_lshl_b32 s43, s43, 17
s_add_u32 m0, s42, 131072
s_nop 0
DH 224,16,0
s_add_u32 s43, s43, 31744
DH 225,16,1024
s_add_u32 s43, s43, 31744
DH 224,16,2048
s_add_u32 s43, s43, 31744
DH 225,16,3072
s_barrier
ds_read_b64 v[128:129], v11
v_xor_b32 v13, 32, v11
ds_read_b64 v[130:131], v13
v_xor_b32 v12, 64, v11
ds_read_b64 v[132:133], v12
v_xor_b32 v13, 96, v11
ds_read_b64 v[134:135], v13
v_xor_b32 v12, 128, v11
ds_read_b64 v[136:137], v12
v_xor_b32 v13, 160, v11
ds_read_b64 v[138:139], v13
v_xor_b32 v12, 192, v11
ds_read_b64 v[140:141], v12
v_xor_b32 v13, 224, v11
ds_read_b64 v[142:143], v13
v_xor_b32 v12, 256, v11
ds_read_b64 v[144:145], v12
v_xor_b32 v13, 288, v11
ds_read_b64 v[146:147], v13
v_xor_b32 v12, 320, v11
ds_read_b64 v[148:149], v12
v_xor_b32 v13, 352, v11
ds_read_b64 v[150:151], v13
v_xor_b32 v12, 384, v11
ds_read_b64 v[152:153], v12
v_xor_b32 v13, 416, v11
ds_read_b64 v[154:155], v13
v_xor_b32 v12, 448, v11
WL 8
ds_read_b64 v[156:157], v12
v_xor_b32 v13, 480, v11
ds_read_b64 v[158:159], v13
v_xor_b32 v12, 512, v11
ds_read_b64 v[160:161], v12
v_xor_b32 v13, 544, v11
ds_read_b64 v[162:163], v13
v_xor_b32 v12, 576, v11
ds_read_b64 v[164:165], v12
v_xor_b32 v13, 608, v11
ds_read_b64 v[166:167], v13
v_xor_b32 v12, 640, v11
WL 8
ds_read_b64 v[168:169], v12
v_xor_b32 v13, 672, v11
ds_read_b64 v[170:171], v13
v_xor_b32 v12, 704, v11
ds_read_b64 v[172:173], v12
v_xor_b32 v13, 736, v11
ds_read_b64 v[174:175], v13
v_xor_b32 v12, 768, v11
ds_read_b64 v[176:177], v12
v_xor_b32 v13, 800, v11
ds_read_b64 v[178:179], v13
v_xor_b32 v12, 832, v11
WL 8
ds_read_b64 v[180:181], v12
v_xor_b32 v13, 864, v11
ds_read_b64 v[182:183], v13
v_xor_b32 v12, 896, v11
ds_read_b64 v[184:185], v12
v_xor_b32 v13, 928, v11
ds_read_b64 v[186:187], v13
v_xor_b32 v12, 960, v11
ds_read_b64 v[188:189], v12
v_xor_b32 v13, 992, v11
ds_read_b64 v[190:191], v13
WL 0
s_barrier
WM 8
TR 192,248,32768
TR 196,249,32768
TR 200,250,32768
TR 204,251,32768
TR 208,252,32768
TR 212,253,32768
TR 216,254,32768
TR 220,255,32768
WL 0
s_xor_b32 s43, s40, 5
s_lshl_b32 s43, s43, 17
s_add_u32 m0, s42, 147456
s_nop 0
DH 224,16,0
s_add_u32 s43, s43, 31744
DH 225,16,1024
s_add_u32 s43, s43, 31744
DH 224,16,2048
s_add_u32 s43, s43, 31744
DH 225,16,3072
MZ 8,56,128
MZ 12,60,128
MZ 16,64,128
MZ 20,68,128
WM 8
TR 194,248,0
TR 198,249,0
TR 202,250,0
TR 206,251,0
TR 210,252,0
TR 214,253,0
TR 218,254,0
TR 222,255,0
WL 0
s_xor_b32 s43, s40, 6
s_lshl_b32 s43, s43, 17
s_add_u32 m0, s42, 114688
s_nop 0
DH 224,16,0
s_add_u32 s43, s43, 31744
DH 225,16,1024
s_add_u32 s43, s43, 31744
DH 224,16,2048
s_add_u32 s43, s43, 31744
DH 225,16,3072
MZ 24,72,128
MZ 28,76,128
MZ 32,80,128
MZ 36,84,128
WM 8
TR 56,248,16384
TR 60,249,16384
TR 64,250,16384
TR 68,251,16384
TR 72,252,16384
TR 76,253,16384
TR 80,254,16384
TR 84,255,16384
WL 0
s_xor_b32 s43, s40, 7
s_lshl_b32 s43, s43, 17
s_add_u32 m0, s42, 131072
s_nop 0
DH 224,16,0
s_add_u32 s43, s43, 31744
DH 225,16,1024
s_add_u32 s43, s43, 31744
DH 224,16,2048
s_add_u32 s43, s43, 31744
DH 225,16,3072
MM 8,192,132
MM 12,196,132
MM 16,200,132
MM 20,204,132
v_readfirstlane_b32 s49, v6
s_nop 0
s_mul_i32 s53, s49, 0x9e3779b1
s_add_u32 s53, s53, 0x7f4a7c15
WM 8
TR 58,248,32768
TR 62,249,32768
TR 66,250,32768
TR 70,251,32768
TR 74,252,32768
TR 78,253,32768
TR 82,254,32768
TR 86,255,32768
WL 0
s_xor_b32 s43, s40, 8
s_lshl_b32 s43, s43, 17
s_add_u32 m0, s42, 147456
s_nop 0
DH 224,16,0
s_add_u32 s43, s43, 31744
DH 225,16,1024
s_add_u32 s43, s43, 31744
DH 224,16,2048
s_add_u32 s43, s43, 31744
DH 225,16,3072
MM 24,208,132
MM 28,212,132
MM 32,216,132
MM 36,220,132
WM 8
TR 192,248,0
TR 196,249,0
TR 200,250,0
TR 204,251,0
TR 208,252,0
TR 212,253,0
TR 216,254,0
TR 220,255,0
WL 0
s_xor_b32 s43, s40, 9
s_lshl_b32 s43, s43, 17
s_add_u32 m0, s42, 114688
s_nop 0
DH 224,16,0
s_add_u32 s43, s43, 31744
DH 225,16,1024
s_add_u32 s43, s43, 31744
DH 224,16,2048
s_add_u32 s43, s43, 31744
DH 225,16,3072
MM 8,56,136
MM 12,60,136
MM 16,64,136
MM 20,68,136
WM 8
TR 194,248,16384
TR 198,249,16384
TR 202,250,16384
TR 206,251,16384
TR 210,252,16384
TR 214,253,16384
TR 218,254,16384
TR 222,255,16384
WL 0
s_xor_b32 s43, s40, 10
s_lshl_b32 s43, s43, 17
s_add_u32 m0, s42, 131072
s_nop 0
DH 224,16,0
s_add_u32 s43, s43, 31744
DH 225,16,1024
s_add_u32 s43, s43, 31744
DH 224,16,2048
s_add_u32 s43, s43, 31744
DH 225,16,3072
MM 24,72,136
MM 28,76,136
MM 32,80,136
MM 36,84,136
WM 8
TR 56,248,32768
TR 60,249,32768
TR 64,250,32768
TR 68,251,32768
TR 72,252,32768
TR 76,253,32768
TR 80,254,32768
TR 84,255,32768
WL 0
s_xor_b32 s43, s40, 11
s_lshl_b32 s43, s43, 17
s_add_u32 m0, s42, 147456
s_nop 0
DH 224,16,0
s_add_u32 s43, s43, 31744
DH 225,16,1024
s_add_u32 s43, s43, 31744
DH 224,16,2048
s_add_u32 s43, s43, 31744
DH 225,16,3072
MM 8,192,140
MM 12,196,140
MM 16,200,140
MM 20,204,140
WM 8
TR 58,248,0
TR 62,249,0
TR 66,250,0
TR 70,251,0
TR 74,252,0
TR 78,253,0
TR 82,254,0
TR 86,255,0
WL 0
s_xor_b32 s43, s40, 12
s_lshl_b32 s43, s43, 17
s_add_u32 m0, s42, 114688
s_nop 0
DH 224,16,0
s_add_u32 s43, s43, 31744
DH 225,16,1024
s_add_u32 s43, s43, 31744
DH 224,16,2048
s_add_u32 s43, s43, 31744
DH 225,16,3072
MM 24,208,140
MM 28,212,140
MM 32,216,140
MM 36,220,140
WM 8
TR 192,248,16384
TR 196,249,16384
TR 200,250,16384
TR 204,251,16384
TR 208,252,16384
TR 212,253,16384
TR 216,254,16384
TR 220,255,16384
WL 0
s_xor_b32 s43, s40, 13
s_lshl_b32 s43, s43, 17
s_add_u32 m0, s42, 131072
s_nop 0
DH 224,16,0
s_add_u32 s43, s43, 31744
DH 225,16,1024
s_add_u32 s43, s43, 31744
DH 224,16,2048
s_add_u32 s43, s43, 31744
DH 225,16,3072
MM 8,56,144
MM 12,60,144
MM 16,64,144
MM 20,68,144
WM 8
TR 194,248,32768
TR 198,249,32768
TR 202,250,32768
TR 206,251,32768
TR 210,252,32768
TR 214,253,32768
TR 218,254,32768
TR 222,255,32768
WL 0
s_xor_b32 s43, s40, 14
s_lshl_b32 s43, s43, 17
s_add_u32 m0, s42, 147456
s_nop 0
DH 224,16,0
s_add_u32 s43, s43, 31744
DH 225,16,1024
s_add_u32 s43, s43, 31744
DH 224,16,2048
s_add_u32 s43, s43, 31744
DH 225,16,3072
MM 24,72,144
MM 28,76,144
MM 32,80,144
MM 36,84,144
WM 8
TR 56,248,0
TR 60,249,0
TR 64,250,0
TR 68,251,0
TR 72,252,0
TR 76,253,0
TR 80,254,0
TR 84,255,0
WL 0
s_xor_b32 s43, s40, 15
s_lshl_b32 s43, s43, 17
s_add_u32 m0, s42, 114688
s_nop 0
DH 224,16,0
s_add_u32 s43, s43, 31744
DH 225,16,1024
s_add_u32 s43, s43, 31744
DH 224,16,2048
s_add_u32 s43, s43, 31744
DH 225,16,3072
MM 8,192,148
MM 12,196,148
MM 16,200,148
MM 20,204,148
WM 8
TR 58,248,16384
TR 62,249,16384
TR 66,250,16384
TR 70,251,16384
TR 74,252,16384
TR 78,253,16384
TR 82,254,16384
TR 86,255,16384
WL 0
s_xor_b32 s43, s40, 16
s_lshl_b32 s43, s43, 17
s_add_u32 m0, s42, 131072
s_nop 0
DH 224,16,0
s_add_u32 s43, s43, 31744
DH 225,16,1024
s_add_u32 s43, s43, 31744
DH 224,16,2048
s_add_u32 s43, s43, 31744
DH 225,16,3072
MM 24,208,148
MM 28,212,148
MM 32,216,148
MM 36,220,148
WM 8
TR 192,248,32768
TR 196,249,32768
TR 200,250,32768
TR 204,251,32768
TR 208,252,32768
TR 212,253,32768
TR 216,254,32768
TR 220,255,32768
WL 0
s_xor_b32 s43, s40, 17
s_lshl_b32 s43, s43, 17
s_add_u32 m0, s42, 147456
s_nop 0
DH 224,16,0
s_add_u32 s43, s43, 31744
DH 225,16,1024
s_add_u32 s43, s43, 31744
DH 224,16,2048
s_add_u32 s43, s43, 31744
DH 225,16,3072
MM 8,56,152
MM 12,60,152
MM 16,64,152
MM 20,68,152
WM 8
TR 194,248,0
TR 198,249,0
TR 202,250,0
TR 206,251,0
TR 210,252,0
TR 214,253,0
TR 218,254,0
TR 222,255,0
WL 0
s_xor_b32 s43, s40, 18
s_lshl_b32 s43, s43, 17
s_add_u32 m0, s42, 114688
s_nop 0
DH 224,16,0
s_add_u32 s43, s43, 31744
DH 225,16,1024
s_add_u32 s43, s43, 31744
DH 224,16,2048
s_add_u32 s43, s43, 31744
DH 225,16,3072
MM 24,72,152
MM 28,76,152
MM 32,80,152
MM 36,84,152
WM 8
TR 56,248,16384
TR 60,249,16384
TR 64,250,16384
TR 68,251,16384
TR 72,252,16384
TR 76,253,16384
TR 80,254,16384
TR 84,255,16384
WL 0
s_xor_b32 s43, s40, 19
s_lshl_b32 s43, s43, 17
s_add_u32 m0, s42, 131072
s_nop 0
DH 224,16,0
s_add_u32 s43, s43, 31744
DH 225,16,1024
s_add_u32 s43, s43, 31744
DH 224,16,2048
s_add_u32 s43, s43, 31744
DH 225,16,3072
MM 8,192,156
MM 12,196,156
MM 16,200,156
MM 20,204,156
WM 8
TR 58,248,32768
TR 62,249,32768
TR 66,250,32768
TR 70,251,32768
TR 74,252,32768
TR 78,253,32768
TR 82,254,32768
TR 86,255,32768
WL 0
s_xor_b32 s43, s40, 20
s_lshl_b32 s43, s43, 17
s_add_u32 m0, s42, 147456
s_nop 0
DH 224,16,0
s_add_u32 s43, s43, 31744
DH 225,16,1024
s_add_u32 s43, s43, 31744
DH 224,16,2048
s_add_u32 s43, s43, 31744
DH 225,16,3072
MM 24,208,156
MM 28,212,156
MM 32,216,156
MM 36,220,156
WM 8
TR 192,248,0
TR 196,249,0
TR 200,250,0
TR 204,251,0
TR 208,252,0
TR 212,253,0
TR 216,254,0
TR 220,255,0
WL 0
s_xor_b32 s43, s40, 21
s_lshl_b32 s43, s43, 17
s_add_u32 m0, s42, 114688
s_nop 0
DH 224,16,0
s_add_u32 s43, s43, 31744
DH 225,16,1024
s_add_u32 s43, s43, 31744
DH 224,16,2048
s_add_u32 s43, s43, 31744
DH 225,16,3072
MM 8,56,160
MM 12,60,160
MM 16,64,160
MM 20,68,160
WM 8
TR 194,248,16384
TR 198,249,16384
TR 202,250,16384
TR 206,251,16384
TR 210,252,16384
TR 214,253,16384
TR 218,254,16384
TR 222,255,16384
WL 0
s_xor_b32 s43, s40, 22
s_lshl_b32 s43, s43, 17
s_add_u32 m0, s42, 131072
s_nop 0
DH 224,16,0
s_add_u32 s43, s43, 31744
DH 225,16,1024
s_add_u32 s43, s43, 31744
DH 224,16,2048
s_add_u32 s43, s43, 31744
DH 225,16,3072
MM 24,72,160
MM 28,76,160
MM 32,80,160
MM 36,84,160
WM 8
TR 56,248,32768
TR 60,249,32768
TR 64,250,32768
TR 68,251,32768
TR 72,252,32768
TR 76,253,32768
TR 80,254,32768
TR 84,255,32768
WL 0
s_xor_b32 s43, s40, 23
s_lshl_b32 s43, s43, 17
s_add_u32 m0, s42, 147456
s_nop 0
DH 224,16,0
s_add_u32 s43, s43, 31744
DH 225,16,1024
s_add_u32 s43, s43, 31744
DH 224,16,2048
s_add_u32 s43, s43, 31744
DH 225,16,3072
MM 8,192,164
MM 12,196,164
MM 16,200,164
MM 20,204,164
WM 8
TR 58,248,0
TR 62,249,0
TR 66,250,0
TR 70,251,0
TR 74,252,0
TR 78,253,0
TR 82,254,0
TR 86,255,0
WL 0
s_xor_b32 s43, s40, 24
s_lshl_b32 s43, s43, 17
s_add_u32 m0, s42, 114688
s_nop 0
DH 224,16,0
s_add_u32 s43, s43, 31744
DH 225,16,1024
s_add_u32 s43, s43, 31744
DH 224,16,2048
s_add_u32 s43, s43, 31744
DH 225,16,3072
MM 24,208,164
MM 28,212,164
MM 32,216,164
MM 36,220,164
WM 8
TR 192,248,16384
TR 196,249,16384
TR 200,250,16384
TR 204,251,16384
TR 208,252,16384
TR 212,253,16384
TR 216,254,16384
TR 220,255,16384
WL 0
s_xor_b32 s43, s40, 25
s_lshl_b32 s43, s43, 17
s_add_u32 m0, s42, 131072
s_nop 0
DH 224,16,0
s_add_u32 s43, s43, 31744
DH 225,16,1024
s_add_u32 s43, s43, 31744
DH 224,16,2048
s_add_u32 s43, s43, 31744
DH 225,16,3072
MM 8,56,168
MM 12,60,168
MM 16,64,168
MM 20,68,168
WM 8
TR 194,248,32768
TR 198,249,32768
TR 202,250,32768
TR 206,251,32768
TR 210,252,32768
TR 214,253,32768
TR 218,254,32768
TR 222,255,32768
WL 0
s_xor_b32 s43, s40, 26
s_lshl_b32 s43, s43, 17
s_add_u32 m0, s42, 147456
s_nop 0
DH 224,16,0
s_add_u32 s43, s43, 31744
DH 225,16,1024
s_add_u32 s43, s43, 31744
DH 224,16,2048
s_add_u32 s43, s43, 31744
DH 225,16,3072
MM 24,72,168
MM 28,76,168
MM 32,80,168
MM 36,84,168
WM 8
TR 56,248,0
TR 60,249,0
TR 64,250,0
TR 68,251,0
TR 72,252,0
TR 76,253,0
TR 80,254,0
TR 84,255,0
WL 0
s_xor_b32 s43, s40, 27
s_lshl_b32 s43, s43, 17
s_add_u32 m0, s42, 114688
s_nop 0
DH 224,16,0
s_add_u32 s43, s43, 31744
DH 225,16,1024
s_add_u32 s43, s43, 31744
DH 224,16,2048
s_add_u32 s43, s43, 31744
DH 225,16,3072
MM 8,192,172
MM 12,196,172
MM 16,200,172
MM 20,204,172
WM 8
TR 58,248,16384
TR 62,249,16384
TR 66,250,16384
TR 70,251,16384
TR 74,252,16384
TR 78,253,16384
TR 82,254,16384
TR 86,255,16384
WL 0
s_xor_b32 s43, s40, 28
s_lshl_b32 s43, s43, 17
s_add_u32 m0, s42, 131072
s_nop 0
DH 224,16,0
s_add_u32 s43, s43, 31744
DH 225,16,1024
s_add_u32 s43, s43, 31744
DH 224,16,2048
s_add_u32 s43, s43, 31744
DH 225,16,3072
MM 24,208,172
MM 28,212,172
MM 32,216,172
MM 36,220,172
WM 8
TR 192,248,32768
TR 196,249,32768
TR 200,250,32768
TR 204,251,32768
TR 208,252,32768
TR 212,253,32768
TR 216,254,32768
TR 220,255,32768
WL 0
s_xor_b32 s43, s40, 29
s_lshl_b32 s43, s43, 17
s_add_u32 m0, s42, 147456
s_nop 0
DH 224,16,0
s_add_u32 s43, s43, 31744
DH 225,16,1024
s_add_u32 s43, s43, 31744
DH 224,16,2048
s_add_u32 s43, s43, 31744
DH 225,16,3072
MM 8,56,176
MM 12,60,176
MM 16,64,176
MM 20,68,176
WM 8
TR 194,248,0
TR 198,249,0
TR 202,250,0
TR 206,251,0
TR 210,252,0
TR 214,253,0
TR 218,254,0
TR 222,255,0
WL 0
s_xor_b32 s43, s40, 30
s_lshl_b32 s43, s43, 17
s_add_u32 m0, s42, 114688
s_nop 0
DH 224,16,0
s_add_u32 s43, s43, 31744
DH 225,16,1024
s_add_u32 s43, s43, 31744
DH 224,16,2048
s_add_u32 s43, s43, 31744
DH 225,16,3072
MM 24,72,176
MM 28,76,176
MM 32,80,176
MM 36,84,176
WM 8
TR 56,248,16384
TR 60,249,16384
TR 64,250,16384
TR 68,251,16384
TR 72,252,16384
TR 76,253,16384
TR 80,254,16384
TR 84,255,16384
WL 0
s_xor_b32 s43, s40, 31
s_lshl_b32 s43, s43, 17
s_add_u32 m0, s42, 131072
s_nop 0
DH 224,16,0
s_add_u32 s43, s43, 31744
DH 225,16,1024
s_add_u32 s43, s43, 31744
DH 224,16,2048
s_add_u32 s43, s43, 31744
DH 225,16,3072
MM 8,192,180
MM 12,196,180
MM 16,200,180
MM 20,204,180
WM 8
TR 58,248,32768
TR 62,249,32768
TR 66,250,32768
TR 70,251,32768
TR 74,252,32768
TR 78,253,32768
TR 82,254,32768
TR 86,255,32768
WL 0
MM 24,208,180
MM 28,212,180
MM 32,216,180
MM 36,220,180
s_mov_b32 s48, 0
s_add_u32 m0, s41, 32768
s_nop 0
DM 112,8,0
DM 113,8,1024
s_mov_b32 s48, 8192
s_add_u32 m0, s41, 0
s_nop 0
DM 112,8,0
DM 113,8,1024
WM 8
TR 192,248,0
TR 196,249,0
TR 200,250,0
TR 204,251,0
TR 208,252,0
TR 212,253,0
TR 216,254,0
TR 220,255,0
WL 0
MM 8,56,184
MM 12,60,184
MM 16,64,184
MM 20,68,184
s_mov_b32 s48, 0
s_add_u32 m0, s41, 90112
s_nop 0
DM 114,12,0
DM 115,12,1024
s_mov_b32 s48, 16384
s_add_u32 m0, s41, 8192
s_nop 0
DM 112,8,0
DM 113,8,1024
WM 8
TR 194,248,16384
TR 198,249,16384
TR 202,250,16384
TR 206,251,16384
TR 210,252,16384
TR 214,253,16384
TR 218,254,16384
TR 222,255,16384
WL 0
MM 24,72,184
MM 28,76,184
MM 32,80,184
MM 36,84,184
MM 8,192,188
MM 12,196,188
MM 16,200,188
MM 20,204,188
MM 24,208,188
MM 28,212,188
MM 32,216,188
MM 36,220,188
s_nop 2
v_mul_f32 v8, s50, v8
v_mul_f32 v9, s50, v9
v_mul_f32 v10, s50, v10
v_mul_f32 v11, s50, v11
v_mul_f32 v12, s50, v12
v_mul_f32 v13, s50, v13
v_mul_f32 v14, s50, v14
v_mul_f32 v15, s50, v15
v_mul_f32 v16, s50, v16
v_mul_f32 v17, s50, v17
v_mul_f32 v18, s50, v18
v_mul_f32 v19, s50, v19
v_mul_f32 v20, s50, v20
v_mul_f32 v21, s50, v21
v_mul_f32 v22, s50, v22
v_mul_f32 v23, s50, v23
v_mul_f32 v24, s50, v24
v_mul_f32 v25, s50, v25
v_mul_f32 v26, s50, v26
v_mul_f32 v27, s50, v27
v_mul_f32 v28, s50, v28
v_mul_f32 v29, s50, v29
v_mul_f32 v30, s50, v30
v_mul_f32 v31, s50, v31
v_mul_f32 v32, s50, v32
v_mul_f32 v33, s50, v33
v_mul_f32 v34, s50, v34
v_mul_f32 v35, s50, v35
v_mul_f32 v36, s50, v36
v_mul_f32 v37, s50, v37
v_mul_f32 v38, s50, v38
v_mul_f32 v39, s50, v39
CV 40,8
CV 42,12
CV 41,10
CV 43,14
CV 44,16
CV 46,20
CV 45,18
CV 47,22
CV 48,24
CV 50,28
CV 49,26
CV 51,30
CV 52,32
CV 54,36
CV 53,34
CV 55,38
v_permlane32_swap_b32 v40, v42
v_permlane32_swap_b32 v41, v43
v_permlane32_swap_b32 v44, v46
v_permlane32_swap_b32 v45, v47
v_permlane32_swap_b32 v48, v50
v_permlane32_swap_b32 v49, v51
v_permlane32_swap_b32 v52, v54
v_permlane32_swap_b32 v53, v55
v_permlane16_swap_b32 v40, v42
v_permlane16_swap_b32 v41, v43
v_permlane16_swap_b32 v44, v46
v_permlane16_swap_b32 v45, v47
v_permlane16_swap_b32 v48, v50
v_permlane16_swap_b32 v49, v51
v_permlane16_swap_b32 v52, v54
v_permlane16_swap_b32 v53, v55
s_mov_b32 s48, 8192
s_add_u32 m0, s41, 57344
s_nop 0
DM 114,12,0
DM 115,12,1024
s_mov_b32 s48, 24576
s_add_u32 m0, s41, 16384
s_nop 0
DM 112,8,0
DM 113,8,1024
WB 10
s_barrier
KR 56,100,32768
KR 60,100,36864
KR 64,101,32768
KR 68,101,36864
KR 72,102,32768
KR 76,102,36864
KR 80,103,32768
KR 84,103,36864
s_mov_b32 s48, 16384
s_add_u32 m0, s41, 65536
s_nop 0
DM 114,12,0
DM 115,12,1024
s_mov_b32 s48, 32768
s_add_u32 m0, s41, 24576
s_nop 0
DM 112,8,0
DM 113,8,1024
s_mov_b32 s48, 24576
s_add_u32 m0, s41, 73728
s_nop 0
DM 114,12,0
DM 115,12,1024
WL 4
MZ 88,56,40
MZ 92,60,40
MM 88,64,44
MM 92,68,44
WL 0
MM 88,72,48
MM 92,76,48
MM 88,80,52
MM 92,84,52
WB 12
s_barrier
KR 56,100,0
KR 60,100,4096
KR 64,101,0
KR 68,101,4096
KR 72,102,0
KR 76,102,4096
KR 80,103,0
KR 84,103,4096
WL 4
MZ 0,56,40
TR 56,104,32768
TR 58,104,36864
MZ 4,60,40
s_mov_b32 s48, 40960
s_add_u32 m0, s41, 32768
TR 60,105,32768
TR 62,105,36864
DM 112,8,0
DM 113,8,1024
MM 0,64,44
TR 64,106,32768
TR 66,106,36864
MM 4,68,44
TR 68,107,32768
TR 70,107,36864
WL 8
MM 0,72,48
TR 72,108,32768
TR 74,108,36864
MM 4,76,48
s_mov_b32 s48, 32768
s_add_u32 m0, s41, 81920
TR 76,109,32768
TR 78,109,36864
DM 114,12,0
DM 115,12,1024
MM 0,80,52
TR 80,110,32768
TR 82,110,36864
MM 4,84,52
WL 12
TR 84,111,32768
TR 86,111,36864
v_max3_f32 v120, v88, v89, v90
v_max3_f32 v121, v91, v92, v93
v_max3_f32 v120, v120, v94, v95
v_max_f32 v120, v120, v121
v_mov_b32 v121, v120
s_nop 1
v_permlane32_swap_b32 v120, v121
v_max_f32 v120, v120, v121
v_mov_b32 v121, v120
s_nop 1
v_permlane16_swap_b32 v120, v121
v_max_f32 v120, v120, v121
v_sub_f32 v124, 0, v120
v_sub_f32 v125, 0, v120
v_sub_f32 v126, 0, v120
v_sub_f32 v127, 0, v120
v_sub_f32 v88, v88, v120
v_sub_f32 v89, v89, v120
v_sub_f32 v90, v90, v120
v_sub_f32 v91, v91, v120
v_sub_f32 v92, v92, v120
v_sub_f32 v93, v93, v120
v_sub_f32 v94, v94, v120
v_sub_f32 v95, v95, v120
EX 88
EX 89
EX 90
EX 91
EX 92
EX 93
EX 94
EX 95
CV 96,88
CV 97,90
CV 98,92
CV 99,94
WB 12
s_barrier
MZ 8,56,96
s_mov_b32 s48, 49152
s_add_u32 m0, s41, 0
KR 56,100,8192
v_mov_b32 v119, v88
DM 112,8,0
MZ 12,60,96
KR 60,100,12288
AD 89
MZ 16,64,96
KR 64,101,8192
AD 90
MZ 20,68,96
KR 68,101,12288
AD 91
MZ 24,72,96
KR 72,102,8192
AD 92
MZ 28,76,96
KR 76,102,12288
AD 93
MZ 32,80,96
KR 80,103,8192
AD 94
DM 113,8,1024
MZ 36,84,96
KR 84,103,12288
AD 95
WL 4
MN 88,56,40
TR 56,104,0
TR 58,104,4096
MN 92,60,40
s_mov_b32 s48, 40960
s_add_u32 m0, s41, 90112
TR 60,105,0
TR 62,105,4096
DM 114,12,0
MM 88,64,44
TR 64,106,0
TR 66,106,4096
MM 92,68,44
TR 68,107,0
TR 70,107,4096
WL 8
MM 88,72,48
TR 72,108,0
TR 74,108,4096
MM 92,76,48
TR 76,109,0
TR 78,109,4096
DM 115,12,1024
MM 88,80,52
TR 80,110,0
TR 82,110,4096
MM 92,84,52
WL 12
TR 84,111,0
TR 86,111,4096
v_add_f32 v0, v0, v124
v_add_f32 v1, v1, v124
v_add_f32 v2, v2, v124
v_add_f32 v3, v3, v124
v_add_f32 v4, v4, v124
v_add_f32 v5, v5, v124
v_add_f32 v6, v6, v124
v_add_f32 v7, v7, v124
v_max3_f32 v120, v0, v1, v2
v_max3_f32 v121, v3, v4, v5
v_max3_f32 v120, v120, v6, v7
v_max_f32 v120, v120, v121
v_cmp_lt_f32 vcc, s51, v120
s_cbranch_vccnz L_tramp0_1
L_back0_1:
EX 0
EX 1
EX 2
EX 3
EX 4
EX 5
EX 6
EX 7
CV 96,0
CV 97,2
CV 98,4
CV 99,6
WB 12
s_barrier
MM 8,56,96
s_mov_b32 s48, 57344
s_add_u32 m0, s41, 8192
KR 56,100,16384
AD 0
DM 112,8,0
MM 12,60,96
KR 60,100,20480
AD 1
MM 16,64,96
KR 64,101,16384
AD 2
MM 20,68,96
KR 68,101,20480
AD 3
MM 24,72,96
KR 72,102,16384
AD 4
MM 28,76,96
KR 76,102,20480
AD 5
MM 32,80,96
KR 80,103,16384
AD 6
DM 113,8,1024
MM 36,84,96
KR 84,103,20480
AD 7
WL 4
MN 0,56,40
TR 56,104,8192
TR 58,104,12288
MN 4,60,40
s_mov_b32 s48, 49152
s_add_u32 m0, s41, 57344
TR 60,105,8192
TR 62,105,12288
DM 114,12,0
v_max3_f32 v120, v88, v89, v90
MM 0,64,44
TR 64,106,8192
TR 66,106,12288
v_max3_f32 v121, v91, v92, v93
MM 4,68,44
TR 68,107,8192
TR 70,107,12288
v_max3_f32 v120, v120, v94, v95
WL 8
MM 0,72,48
TR 72,108,8192
TR 74,108,12288
v_max_f32 v120, v120, v121
MM 4,76,48
TR 76,109,8192
TR 78,109,12288
DM 115,12,1024
MM 0,80,52
TR 80,110,8192
TR 82,110,12288
MM 4,84,52
WL 12
TR 84,111,8192
TR 86,111,12288
v_cmp_lt_f32 vcc, s51, v120
s_cbranch_vccnz L_tramp0_2
L_back0_2:
EX 88
EX 89
EX 90
EX 91
EX 92
EX 93
EX 94
EX 95
CV 96,88
CV 97,90
CV 98,92
CV 99,94
WB 12
s_barrier
MM 8,56,96
s_mov_b32 s48, 65536
s_add_u32 m0, s41, 16384
KR 56,100,24576
AD 88
DM 112,8,0
MM 12,60,96
KR 60,100,28672
AD 89
MM 16,64,96
KR 64,101,24576
AD 90
MM 20,68,96
KR 68,101,28672
AD 91
MM 24,72,96
KR 72,102,24576
AD 92
MM 28,76,96
KR 76,102,28672
AD 93
MM 32,80,96
KR 80,103,24576
AD 94
DM 113,8,1024
MM 36,84,96
KR 84,103,28672
AD 95
s_xor_b32 s43, s38, 0
s_lshl_b32 s43, s43, 14
s_mul_i32 s44, s36, 3840
s_add_u32 s43, s43, s44
v_and_b32 v122, 0x1f0, v118
v_lshlrev_b32 v122, 3, v122
buffer_load_dword v123, v122, s[24:27], s43 offen
WL 4
MN 88,56,40
TR 56,104,16384
TR 58,104,20480
MN 92,60,40
s_mov_b32 s48, 57344
s_add_u32 m0, s41, 65536
TR 60,105,16384
TR 62,105,20480
DM 114,12,0
v_max3_f32 v120, v0, v1, v2
MM 88,64,44
TR 64,106,16384
TR 66,106,20480
v_max3_f32 v121, v3, v4, v5
MM 92,68,44
TR 68,107,16384
TR 70,107,20480
v_max3_f32 v120, v120, v6, v7
WL 8
MM 88,72,48
TR 72,108,16384
TR 74,108,20480
v_max_f32 v120, v120, v121
MM 92,76,48
TR 76,109,16384
TR 78,109,20480
DM 115,12,1024
MM 88,80,52
TR 80,110,16384
TR 82,110,20480
MM 92,84,52
WL 12
TR 84,111,16384
TR 86,111,20480
v_cmp_lt_f32 vcc, s51, v120
s_cbranch_vccnz L_tramp0_3
L_back0_3:
EX 0
EX 1
EX 2
EX 3
EX 4
EX 5
EX 6
EX 7
CV 96,0
CV 97,2
CV 98,4
CV 99,6
WB 13
s_barrier
MM 8,56,96
s_mov_b32 s48, 73728
s_add_u32 m0, s41, 24576
KR 56,100,32768
AD 0
DM 112,8,0
MM 12,60,96
KR 60,100,36864
AD 1
MM 16,64,96
KR 64,101,32768
AD 2
MM 20,68,96
KR 68,101,36864
AD 3
MM 24,72,96
KR 72,102,32768
AD 4
MM 28,76,96
KR 76,102,36864
AD 5
MM 32,80,96
KR 80,103,32768
AD 6
DM 113,8,1024
MM 36,84,96
KR 84,103,36864
AD 7
WL 4
MN 0,56,40
TR 56,104,24576
TR 58,104,28672
MN 4,60,40
s_mov_b32 s48, 65536
s_add_u32 m0, s41, 73728
TR 60,105,24576
TR 62,105,28672
DM 114,12,0
v_max3_f32 v120, v88, v89, v90
MM 0,64,44
TR 64,106,24576
TR 66,106,28672
v_max3_f32 v121, v91, v92, v93
MM 4,68,44
TR 68,107,24576
TR 70,107,28672
v_max3_f32 v120, v120, v94, v95
WL 8
MM 0,72,48
TR 72,108,24576
TR 74,108,28672
v_max_f32 v120, v120, v121
MM 4,76,48
TR 76,109,24576
TR 78,109,28672
DM 115,12,1024
MM 0,80,52
TR 80,110,24576
TR 82,110,28672
MM 4,84,52
WL 12
TR 84,111,24576
TR 86,111,28672
v_cmp_lt_f32 vcc, s51, v120
s_cbranch_vccnz L_tramp0_4
L_back0_4:
EX 88
EX 89
EX 90
EX 91
EX 92
EX 93
EX 94
EX 95
CV 96,88
CV 97,90
CV 98,92
CV 99,94
WB 13
s_barrier
MM 8,56,96
s_mov_b32 s48, 81920
s_add_u32 m0, s41, 32768
KR 56,100,0
AD 88
DM 112,8,0
MM 12,60,96
KR 60,100,4096
AD 89
MM 16,64,96
KR 64,101,0
AD 90
MM 20,68,96
KR 68,101,4096
AD 91
MM 24,72,96
KR 72,102,0
AD 92
MM 28,76,96
KR 76,102,4096
AD 93
MM 32,80,96
KR 80,103,0
AD 94
DM 113,8,1024
MM 36,84,96
KR 84,103,4096
AD 95
WL 4
MN 88,56,40
TR 56,104,32768
TR 58,104,36864
MN 92,60,40
s_mov_b32 s48, 73728
s_add_u32 m0, s41, 81920
TR 60,105,32768
TR 62,105,36864
DM 114,12,0
v_max3_f32 v120, v0, v1, v2
MM 88,64,44
TR 64,106,32768
TR 66,106,36864
v_max3_f32 v121, v3, v4, v5
MM 92,68,44
TR 68,107,32768
TR 70,107,36864
v_max3_f32 v120, v120, v6, v7
WL 8
MM 88,72,48
TR 72,108,32768
TR 74,108,36864
v_max_f32 v120, v120, v121
MM 92,76,48
TR 76,109,32768
TR 78,109,36864
DM 115,12,1024
MM 88,80,52
TR 80,110,32768
TR 82,110,36864
MM 92,84,52
WL 12
TR 84,111,32768
TR 86,111,36864
v_cmp_lt_f32 vcc, s51, v120
s_cbranch_vccnz L_tramp0_5
L_back0_5:
EX 0
EX 1
EX 2
EX 3
EX 4
EX 5
EX 6
EX 7
CV 96,0
CV 97,2
CV 98,4
CV 99,6
WB 13
s_barrier
MM 8,56,96
s_mov_b32 s48, 90112
s_add_u32 m0, s41, 0
KR 56,100,8192
AD 0
DM 112,8,0
MM 12,60,96
KR 60,100,12288
AD 1
MM 16,64,96
KR 64,101,8192
AD 2
MM 20,68,96
KR 68,101,12288
AD 3
MM 24,72,96
KR 72,102,8192
AD 4
MM 28,76,96
KR 76,102,12288
AD 5
MM 32,80,96
KR 80,103,8192
AD 6
DM 113,8,1024
MM 36,84,96
KR 84,103,12288
AD 7
WL 4
MN 0,56,40
TR 56,104,0
TR 58,104,4096
MN 4,60,40
s_mov_b32 s48, 81920
s_add_u32 m0, s41, 90112
TR 60,105,0
TR 62,105,4096
DM 114,12,0
v_max3_f32 v120, v88, v89, v90
MM 0,64,44
TR 64,106,0
TR 66,106,4096
v_max3_f32 v121, v91, v92, v93
MM 4,68,44
TR 68,107,0
TR 70,107,4096
v_max3_f32 v120, v120, v94, v95
WL 8
MM 0,72,48
TR 72,108,0
TR 74,108,4096
v_max_f32 v120, v120, v121
MM 4,76,48
TR 76,109,0
TR 78,109,4096
DM 115,12,1024
MM 0,80,52
TR 80,110,0
TR 82,110,4096
MM 4,84,52
WL 12
TR 84,111,0
TR 86,111,4096
v_cmp_lt_f32 vcc, s51, v120
s_cbranch_vccnz L_tramp0_6
L_back0_6:
EX 88
EX 89
EX 90
EX 91
EX 92
EX 93
EX 94
EX 95
CV 96,88
CV 97,90
CV 98,92
CV 99,94
WB 12
s_barrier
MM 8,56,96
s_mov_b32 s48, 98304
s_add_u32 m0, s41, 8192
KR 56,100,16384
AD 88
DM 112,8,0
MM 12,60,96
KR 60,100,20480
AD 89
MM 16,64,96
KR 64,101,16384
AD 90
MM 20,68,96
KR 68,101,20480
AD 91
MM 24,72,96
KR 72,102,16384
AD 92
MM 28,76,96
KR 76,102,20480
AD 93
MM 32,80,96
KR 80,103,16384
AD 94
DM 113,8,1024
MM 36,84,96
KR 84,103,20480
AD 95
WL 4
MN 88,56,40
TR 56,104,8192
TR 58,104,12288
MN 92,60,40
s_mov_b32 s48, 90112
s_add_u32 m0, s41, 57344
TR 60,105,8192
TR 62,105,12288
DM 114,12,0
v_max3_f32 v120, v0, v1, v2
MM 88,64,44
TR 64,106,8192
TR 66,106,12288
v_max3_f32 v121, v3, v4, v5
MM 92,68,44
TR 68,107,8192
TR 70,107,12288
v_max3_f32 v120, v120, v6, v7
WL 8
MM 88,72,48
TR 72,108,8192
TR 74,108,12288
v_max_f32 v120, v120, v121
MM 92,76,48
TR 76,109,8192
TR 78,109,12288
DM 115,12,1024
MM 88,80,52
TR 80,110,8192
TR 82,110,12288
MM 92,84,52
WL 12
TR 84,111,8192
TR 86,111,12288
v_cmp_lt_f32 vcc, s51, v120
s_cbranch_vccnz L_tramp0_7
L_back0_7:
EX 0
EX 1
EX 2
EX 3
EX 4
EX 5
EX 6
EX 7
CV 96,0
CV 97,2
CV 98,4
CV 99,6
WB 12
s_barrier
MM 8,56,96
s_mov_b32 s48, 106496
s_add_u32 m0, s41, 16384
KR 56,100,24576
AD 0
DM 112,8,0
MM 12,60,96
KR 60,100,28672
AD 1
MM 16,64,96
KR 64,101,24576
AD 2
MM 20,68,96
KR 68,101,28672
AD 3
MM 24,72,96
KR 72,102,24576
AD 4
MM 28,76,96
KR 76,102,28672
AD 5
MM 32,80,96
KR 80,103,24576
AD 6
DM 113,8,1024
MM 36,84,96
KR 84,103,28672
AD 7
WL 4
MN 0,56,40
TR 56,104,16384
TR 58,104,20480
MN 4,60,40
s_mov_b32 s48, 98304
s_add_u32 m0, s41, 65536
TR 60,105,16384
TR 62,105,20480
DM 114,12,0
v_max3_f32 v120, v88, v89, v90
MM 0,64,44
TR 64,106,16384
TR 66,106,20480
v_max3_f32 v121, v91, v92, v93
MM 4,68,44
TR 68,107,16384
TR 70,107,20480
v_max3_f32 v120, v120, v94, v95
WL 8
MM 0,72,48
TR 72,108,16384
TR 74,108,20480
v_max_f32 v120, v120, v121
MM 4,76,48
TR 76,109,16384
TR 78,109,20480
DM 115,12,1024
MM 0,80,52
TR 80,110,16384
TR 82,110,20480
MM 4,84,52
WL 12
TR 84,111,16384
TR 86,111,20480
v_cmp_lt_f32 vcc, s51, v120
s_cbranch_vccnz L_tramp0_8
L_back0_8:
EX 88
EX 89
EX 90
EX 91
EX 92
EX 93
EX 94
EX 95
CV 96,88
CV 97,90
CV 98,92
CV 99,94
WB 12
s_barrier
MM 8,56,96
s_mov_b32 s48, 114688
s_add_u32 m0, s41, 24576
KR 56,100,32768
AD 88
DM 112,8,0
MM 12,60,96
KR 60,100,36864
AD 89
MM 16,64,96
KR 64,101,32768
AD 90
MM 20,68,96
KR 68,101,36864
AD 91
MM 24,72,96
KR 72,102,32768
AD 92
MM 28,76,96
KR 76,102,36864
AD 93
MM 32,80,96
KR 80,103,32768
AD 94
DM 113,8,1024
MM 36,84,96
KR 84,103,36864
AD 95
WL 4
MN 88,56,40
TR 56,104,24576
TR 58,104,28672
MN 92,60,40
s_mov_b32 s48, 106496
s_add_u32 m0, s41, 73728
TR 60,105,24576
TR 62,105,28672
DM 114,12,0
v_max3_f32 v120, v0, v1, v2
MM 88,64,44
TR 64,106,24576
TR 66,106,28672
v_max3_f32 v121, v3, v4, v5
MM 92,68,44
TR 68,107,24576
TR 70,107,28672
v_max3_f32 v120, v120, v6, v7
WL 8
MM 88,72,48
TR 72,108,24576
TR 74,108,28672
v_max_f32 v120, v120, v121
MM 92,76,48
TR 76,109,24576
TR 78,109,28672
DM 115,12,1024
MM 88,80,52
TR 80,110,24576
TR 82,110,28672
MM 92,84,52
WL 12
TR 84,111,24576
TR 86,111,28672
v_cmp_lt_f32 vcc, s51, v120
s_cbranch_vccnz L_tramp0_9
L_back0_9:
EX 0
EX 1
EX 2
EX 3
EX 4
EX 5
EX 6
EX 7
CV 96,0
CV 97,2
CV 98,4
CV 99,6
WB 12
s_barrier
MM 8,56,96
s_mov_b32 s48, 122880
s_add_u32 m0, s41, 32768
KR 56,100,0
AD 0
DM 112,8,0
MM 12,60,96
KR 60,100,4096
AD 1
MM 16,64,96
KR 64,101,0
AD 2
MM 20,68,96
KR 68,101,4096
AD 3
MM 24,72,96
KR 72,102,0
AD 4
MM 28,76,96
KR 76,102,4096
AD 5
MM 32,80,96
KR 80,103,0
AD 6
DM 113,8,1024
MM 36,84,96
KR 84,103,4096
AD 7
WL 4
MN 0,56,40
TR 56,104,32768
TR 58,104,36864
MN 4,60,40
s_mov_b32 s48, 114688
s_add_u32 m0, s41, 81920
TR 60,105,32768
TR 62,105,36864
DM 114,12,0
v_max3_f32 v120, v88, v89, v90
MM 0,64,44
TR 64,106,32768
TR 66,106,36864
v_max3_f32 v121, v91, v92, v93
MM 4,68,44
TR 68,107,32768
TR 70,107,36864
v_max3_f32 v120, v120, v94, v95
WL 8
MM 0,72,48
TR 72,108,32768
TR 74,108,36864
v_max_f32 v120, v120, v121
MM 4,76,48
TR 76,109,32768
TR 78,109,36864
DM 115,12,1024
MM 0,80,52
TR 80,110,32768
TR 82,110,36864
MM 4,84,52
WL 12
TR 84,111,32768
TR 86,111,36864
v_cmp_lt_f32 vcc, s51, v120
s_cbranch_vccnz L_tramp0_10
L_back0_10:
EX 88
EX 89
EX 90
EX 91
EX 92
EX 93
EX 94
EX 95
CV 96,88
CV 97,90
CV 98,92
CV 99,94
WB 12
s_barrier
MM 8,56,96
s_mov_b32 s48, 131072
s_add_u32 m0, s41, 0
KR 56,100,8192
AD 88
DM 112,8,0
MM 12,60,96
KR 60,100,12288
AD 89
MM 16,64,96
KR 64,101,8192
AD 90
MM 20,68,96
KR 68,101,12288
AD 91
MM 24,72,96
KR 72,102,8192
AD 92
MM 28,76,96
KR 76,102,12288
AD 93
MM 32,80,96
KR 80,103,8192
AD 94
DM 113,8,1024
MM 36,84,96
KR 84,103,12288
AD 95
WL 4
MN 88,56,40
TR 56,104,0
TR 58,104,4096
MN 92,60,40
s_mov_b32 s48, 122880
s_add_u32 m0, s41, 90112
TR 60,105,0
TR 62,105,4096
DM 114,12,0
v_max3_f32 v120, v0, v1, v2
MM 88,64,44
TR 64,106,0
TR 66,106,4096
v_max3_f32 v121, v3, v4, v5
MM 92,68,44
TR 68,107,0
TR 70,107,4096
v_max3_f32 v120, v120, v6, v7
WL 8
MM 88,72,48
TR 72,108,0
TR 74,108,4096
v_max_f32 v120, v120, v121
MM 92,76,48
TR 76,109,0
TR 78,109,4096
DM 115,12,1024
MM 88,80,52
TR 80,110,0
TR 82,110,4096
MM 92,84,52
WL 12
TR 84,111,0
TR 86,111,4096
v_cmp_lt_f32 vcc, s51, v120
s_cbranch_vccnz L_tramp0_11
L_back0_11:
EX 0
EX 1
EX 2
EX 3
EX 4
EX 5
EX 6
EX 7
CV 96,0
CV 97,2
CV 98,4
CV 99,6
WB 12
s_barrier
MM 8,56,96
s_mov_b32 s48, 139264
s_add_u32 m0, s41, 8192
KR 56,100,16384
AD 0
DM 112,8,0
MM 12,60,96
KR 60,100,20480
AD 1
MM 16,64,96
KR 64,101,16384
AD 2
MM 20,68,96
KR 68,101,20480
AD 3
MM 24,72,96
KR 72,102,16384
AD 4
MM 28,76,96
KR 76,102,20480
AD 5
MM 32,80,96
KR 80,103,16384
AD 6
DM 113,8,1024
MM 36,84,96
KR 84,103,20480
AD 7
WL 4
MN 0,56,40
TR 56,104,8192
TR 58,104,12288
MN 4,60,40
s_mov_b32 s48, 131072
s_add_u32 m0, s41, 57344
TR 60,105,8192
TR 62,105,12288
DM 114,12,0
v_max3_f32 v120, v88, v89, v90
MM 0,64,44
TR 64,106,8192
TR 66,106,12288
v_max3_f32 v121, v91, v92, v93
MM 4,68,44
TR 68,107,8192
TR 70,107,12288
v_max3_f32 v120, v120, v94, v95
WL 8
MM 0,72,48
TR 72,108,8192
TR 74,108,12288
v_max_f32 v120, v120, v121
MM 4,76,48
TR 76,109,8192
TR 78,109,12288
DM 115,12,1024
MM 0,80,52
TR 80,110,8192
TR 82,110,12288
MM 4,84,52
WL 12
TR 84,111,8192
TR 86,111,12288
v_cmp_lt_f32 vcc, s51, v120
s_cbranch_vccnz L_tramp0_12
L_back0_12:
EX 88
EX 89
EX 90
EX 91
EX 92
EX 93
EX 94
EX 95
CV 96,88
CV 97,90
CV 98,92
CV 99,94
WB 12
s_barrier
MM 8,56,96
s_mov_b32 s48, 147456
s_add_u32 m0, s41, 16384
KR 56,100,24576
AD 88
DM 112,8,0
MM 12,60,96
KR 60,100,28672
AD 89
MM 16,64,96
KR 64,101,24576
AD 90
MM 20,68,96
KR 68,101,28672
AD 91
MM 24,72,96
KR 72,102,24576
AD 92
MM 28,76,96
KR 76,102,28672
AD 93
MM 32,80,96
KR 80,103,24576
AD 94
DM 113,8,1024
MM 36,84,96
KR 84,103,28672
AD 95
WL 4
MN 88,56,40
TR 56,104,16384
TR 58,104,20480
MN 92,60,40
s_mov_b32 s48, 139264
s_add_u32 m0, s41, 65536
TR 60,105,16384
TR 62,105,20480
DM 114,12,0
v_max3_f32 v120, v0, v1, v2
MM 88,64,44
TR 64,106,16384
TR 66,106,20480
v_max3_f32 v121, v3, v4, v5
MM 92,68,44
TR 68,107,16384
TR 70,107,20480
v_max3_f32 v120, v120, v6, v7
WL 8
MM 88,72,48
TR 72,108,16384
TR 74,108,20480
v_max_f32 v120, v120, v121
MM 92,76,48
TR 76,109,16384
TR 78,109,20480
DM 115,12,1024
MM 88,80,52
TR 80,110,16384
TR 82,110,20480
MM 92,84,52
WL 12
TR 84,111,16384
TR 86,111,20480
v_cmp_lt_f32 vcc, s51, v120
s_cbranch_vccnz L_tramp0_13
L_back0_13:
EX 0
EX 1
EX 2
EX 3
EX 4
EX 5
EX 6
EX 7
CV 96,0
CV 97,2
CV 98,4
CV 99,6
WB 12
s_barrier
MM 8,56,96
s_mov_b32 s48, 155648
s_add_u32 m0, s41, 24576
KR 56,100,32768
AD 0
DM 112,8,0
MM 12,60,96
KR 60,100,36864
AD 1
MM 16,64,96
KR 64,101,32768
AD 2
MM 20,68,96
KR 68,101,36864
AD 3
MM 24,72,96
KR 72,102,32768
AD 4
MM 28,76,96
KR 76,102,36864
AD 5
MM 32,80,96
KR 80,103,32768
AD 6
DM 113,8,1024
MM 36,84,96
KR 84,103,36864
AD 7
WL 4
MN 0,56,40
TR 56,104,24576
TR 58,104,28672
MN 4,60,40
s_mov_b32 s48, 147456
s_add_u32 m0, s41, 73728
TR 60,105,24576
TR 62,105,28672
DM 114,12,0
v_max3_f32 v120, v88, v89, v90
MM 0,64,44
TR 64,106,24576
TR 66,106,28672
v_max3_f32 v121, v91, v92, v93
MM 4,68,44
TR 68,107,24576
TR 70,107,28672
v_max3_f32 v120, v120, v94, v95
WL 8
MM 0,72,48
TR 72,108,24576
TR 74,108,28672
v_max_f32 v120, v120, v121
MM 4,76,48
TR 76,109,24576
TR 78,109,28672
DM 115,12,1024
MM 0,80,52
TR 80,110,24576
TR 82,110,28672
MM 4,84,52
WL 12
TR 84,111,24576
TR 86,111,28672
v_cmp_lt_f32 vcc, s51, v120
s_cbranch_vccnz L_tramp0_14
L_back0_14:
EX 88
EX 89
EX 90
EX 91
EX 92
EX 93
EX 94
EX 95
CV 96,88
CV 97,90
CV 98,92
CV 99,94
WB 12
s_barrier
MM 8,56,96
s_mov_b32 s48, 163840
s_add_u32 m0, s41, 32768
KR 56,100,0
AD 88
DM 112,8,0
MM 12,60,96
KR 60,100,4096
AD 89
MM 16,64,96
KR 64,101,0
AD 90
MM 20,68,96
KR 68,101,4096
AD 91
MM 24,72,96
KR 72,102,0
AD 92
MM 28,76,96
KR 76,102,4096
AD 93
MM 32,80,96
KR 80,103,0
AD 94
DM 113,8,1024
MM 36,84,96
KR 84,103,4096
AD 95
WL 4
MN 88,56,40
TR 56,104,32768
TR 58,104,36864
MN 92,60,40
s_mov_b32 s48, 155648
s_add_u32 m0, s41, 81920
TR 60,105,32768
TR 62,105,36864
DM 114,12,0
v_max3_f32 v120, v0, v1, v2
MM 88,64,44
TR 64,106,32768
TR 66,106,36864
v_max3_f32 v121, v3, v4, v5
MM 92,68,44
TR 68,107,32768
TR 70,107,36864
v_max3_f32 v120, v120, v6, v7
WL 8
MM 88,72,48
TR 72,108,32768
TR 74,108,36864
v_max_f32 v120, v120, v121
MM 92,76,48
TR 76,109,32768
TR 78,109,36864
DM 115,12,1024
MM 88,80,52
TR 80,110,32768
TR 82,110,36864
MM 92,84,52
WL 12
TR 84,111,32768
TR 86,111,36864
v_cmp_lt_f32 vcc, s51, v120
s_cbranch_vccnz L_tramp0_15
L_back0_15:
EX 0
EX 1
EX 2
EX 3
EX 4
EX 5
EX 6
EX 7
CV 96,0
CV 97,2
CV 98,4
CV 99,6
WB 12
s_barrier
MM 8,56,96
s_mov_b32 s48, 172032
s_add_u32 m0, s41, 0
KR 56,100,8192
AD 0
DM 112,8,0
MM 12,60,96
KR 60,100,12288
AD 1
MM 16,64,96
KR 64,101,8192
AD 2
MM 20,68,96
KR 68,101,12288
AD 3
MM 24,72,96
KR 72,102,8192
AD 4
MM 28,76,96
KR 76,102,12288
AD 5
MM 32,80,96
KR 80,103,8192
AD 6
DM 113,8,1024
MM 36,84,96
KR 84,103,12288
AD 7
WL 4
MN 0,56,40
TR 56,104,0
TR 58,104,4096
MN 4,60,40
s_mov_b32 s48, 163840
s_add_u32 m0, s41, 90112
TR 60,105,0
TR 62,105,4096
DM 114,12,0
v_max3_f32 v120, v88, v89, v90
MM 0,64,44
TR 64,106,0
TR 66,106,4096
v_max3_f32 v121, v91, v92, v93
MM 4,68,44
TR 68,107,0
TR 70,107,4096
v_max3_f32 v120, v120, v94, v95
WL 8
MM 0,72,48
TR 72,108,0
TR 74,108,4096
v_max_f32 v120, v120, v121
MM 4,76,48
TR 76,109,0
TR 78,109,4096
DM 115,12,1024
MM 0,80,52
TR 80,110,0
TR 82,110,4096
MM 4,84,52
WL 12
TR 84,111,0
TR 86,111,4096
v_cmp_lt_f32 vcc, s51, v120
s_cbranch_vccnz L_tramp0_16
L_back0_16:
EX 88
EX 89
EX 90
EX 91
EX 92
EX 93
EX 94
EX 95
CV 96,88
CV 97,90
CV 98,92
CV 99,94
WB 12
s_barrier
MM 8,56,96
s_mov_b32 s48, 180224
s_add_u32 m0, s41, 8192
KR 56,100,16384
AD 88
DM 112,8,0
MM 12,60,96
KR 60,100,20480
AD 89
MM 16,64,96
KR 64,101,16384
AD 90
MM 20,68,96
KR 68,101,20480
AD 91
MM 24,72,96
KR 72,102,16384
AD 92
MM 28,76,96
KR 76,102,20480
AD 93
MM 32,80,96
KR 80,103,16384
AD 94
DM 113,8,1024
MM 36,84,96
KR 84,103,20480
AD 95
WL 4
MN 88,56,40
TR 56,104,8192
TR 58,104,12288
MN 92,60,40
s_mov_b32 s48, 172032
s_add_u32 m0, s41, 57344
TR 60,105,8192
TR 62,105,12288
DM 114,12,0
v_max3_f32 v120, v0, v1, v2
MM 88,64,44
TR 64,106,8192
TR 66,106,12288
v_max3_f32 v121, v3, v4, v5
MM 92,68,44
TR 68,107,8192
TR 70,107,12288
v_max3_f32 v120, v120, v6, v7
WL 8
MM 88,72,48
TR 72,108,8192
TR 74,108,12288
v_max_f32 v120, v120, v121
MM 92,76,48
TR 76,109,8192
TR 78,109,12288
DM 115,12,1024
MM 88,80,52
TR 80,110,8192
TR 82,110,12288
MM 92,84,52
WL 12
TR 84,111,8192
TR 86,111,12288
v_cmp_lt_f32 vcc, s51, v120
s_cbranch_vccnz L_tramp0_17
L_back0_17:
EX 0
EX 1
EX 2
EX 3
EX 4
EX 5
EX 6
EX 7
CV 96,0
CV 97,2
CV 98,4
CV 99,6
WB 12
s_barrier
MM 8,56,96
s_mov_b32 s48, 188416
s_add_u32 m0, s41, 16384
KR 56,100,24576
AD 0
DM 112,8,0
MM 12,60,96
KR 60,100,28672
AD 1
MM 16,64,96
KR 64,101,24576
AD 2
MM 20,68,96
KR 68,101,28672
AD 3
MM 24,72,96
KR 72,102,24576
AD 4
MM 28,76,96
KR 76,102,28672
AD 5
MM 32,80,96
KR 80,103,24576
AD 6
DM 113,8,1024
MM 36,84,96
KR 84,103,28672
AD 7
WL 4
MN 0,56,40
TR 56,104,16384
TR 58,104,20480
MN 4,60,40
s_mov_b32 s48, 180224
s_add_u32 m0, s41, 65536
TR 60,105,16384
TR 62,105,20480
DM 114,12,0
v_max3_f32 v120, v88, v89, v90
MM 0,64,44
TR 64,106,16384
TR 66,106,20480
v_max3_f32 v121, v91, v92, v93
MM 4,68,44
TR 68,107,16384
TR 70,107,20480
v_max3_f32 v120, v120, v94, v95
WL 8
MM 0,72,48
TR 72,108,16384
TR 74,108,20480
v_max_f32 v120, v120, v121
MM 4,76,48
TR 76,109,16384
TR 78,109,20480
DM 115,12,1024
MM 0,80,52
TR 80,110,16384
TR 82,110,20480
MM 4,84,52
WL 12
TR 84,111,16384
TR 86,111,20480
v_cmp_lt_f32 vcc, s51, v120
s_cbranch_vccnz L_tramp0_18
L_back0_18:
EX 88
EX 89
EX 90
EX 91
EX 92
EX 93
EX 94
EX 95
CV 96,88
CV 97,90
CV 98,92
CV 99,94
WB 12
s_barrier
MM 8,56,96
s_mov_b32 s48, 196608
s_add_u32 m0, s41, 24576
KR 56,100,32768
AD 88
DM 112,8,0
MM 12,60,96
KR 60,100,36864
AD 89
MM 16,64,96
KR 64,101,32768
AD 90
MM 20,68,96
KR 68,101,36864
AD 91
MM 24,72,96
KR 72,102,32768
AD 92
MM 28,76,96
KR 76,102,36864
AD 93
MM 32,80,96
KR 80,103,32768
AD 94
DM 113,8,1024
MM 36,84,96
KR 84,103,36864
AD 95
WL 4
MN 88,56,40
TR 56,104,24576
TR 58,104,28672
MN 92,60,40
s_mov_b32 s48, 188416
s_add_u32 m0, s41, 73728
TR 60,105,24576
TR 62,105,28672
DM 114,12,0
v_max3_f32 v120, v0, v1, v2
MM 88,64,44
TR 64,106,24576
TR 66,106,28672
v_max3_f32 v121, v3, v4, v5
MM 92,68,44
TR 68,107,24576
TR 70,107,28672
v_max3_f32 v120, v120, v6, v7
WL 8
MM 88,72,48
TR 72,108,24576
TR 74,108,28672
v_max_f32 v120, v120, v121
MM 92,76,48
TR 76,109,24576
TR 78,109,28672
DM 115,12,1024
MM 88,80,52
TR 80,110,24576
TR 82,110,28672
MM 92,84,52
WL 12
TR 84,111,24576
TR 86,111,28672
v_cmp_lt_f32 vcc, s51, v120
s_cbranch_vccnz L_tramp0_19
L_back0_19:
EX 0
EX 1
EX 2
EX 3
EX 4
EX 5
EX 6
EX 7
CV 96,0
CV 97,2
CV 98,4
CV 99,6
WB 12
s_barrier
MM 8,56,96
s_mov_b32 s48, 204800
s_add_u32 m0, s41, 32768
KR 56,100,0
AD 0
DM 112,8,0
MM 12,60,96
KR 60,100,4096
AD 1
MM 16,64,96
KR 64,101,0
AD 2
MM 20,68,96
KR 68,101,4096
AD 3
MM 24,72,96
KR 72,102,0
AD 4
MM 28,76,96
KR 76,102,4096
AD 5
MM 32,80,96
KR 80,103,0
AD 6
DM 113,8,1024
MM 36,84,96
KR 84,103,4096
AD 7
WL 4
MN 0,56,40
TR 56,104,32768
TR 58,104,36864
MN 4,60,40
s_mov_b32 s48, 196608
s_add_u32 m0, s41, 81920
TR 60,105,32768
TR 62,105,36864
DM 114,12,0
v_max3_f32 v120, v88, v89, v90
MM 0,64,44
TR 64,106,32768
TR 66,106,36864
v_max3_f32 v121, v91, v92, v93
MM 4,68,44
TR 68,107,32768
TR 70,107,36864
v_max3_f32 v120, v120, v94, v95
WL 8
MM 0,72,48
TR 72,108,32768
TR 74,108,36864
v_max_f32 v120, v120, v121
MM 4,76,48
TR 76,109,32768
TR 78,109,36864
DM 115,12,1024
MM 0,80,52
TR 80,110,32768
TR 82,110,36864
MM 4,84,52
WL 12
TR 84,111,32768
TR 86,111,36864
v_cmp_lt_f32 vcc, s51, v120
s_cbranch_vccnz L_tramp0_20
L_back0_20:
EX 88
EX 89
EX 90
EX 91
EX 92
EX 93
EX 94
EX 95
CV 96,88
CV 97,90
CV 98,92
CV 99,94
WB 12
s_barrier
MM 8,56,96
s_mov_b32 s48, 212992
s_add_u32 m0, s41, 0
KR 56,100,8192
AD 88
DM 112,8,0
MM 12,60,96
KR 60,100,12288
AD 89
MM 16,64,96
KR 64,101,8192
AD 90
MM 20,68,96
KR 68,101,12288
AD 91
MM 24,72,96
KR 72,102,8192
AD 92
MM 28,76,96
KR 76,102,12288
AD 93
MM 32,80,96
KR 80,103,8192
AD 94
DM 113,8,1024
MM 36,84,96
KR 84,103,12288
AD 95
WL 4
MN 88,56,40
TR 56,104,0
TR 58,104,4096
MN 92,60,40
s_mov_b32 s48, 204800
s_add_u32 m0, s41, 90112
TR 60,105,0
TR 62,105,4096
DM 114,12,0
v_max3_f32 v120, v0, v1, v2
MM 88,64,44
TR 64,106,0
TR 66,106,4096
v_max3_f32 v121, v3, v4, v5
MM 92,68,44
TR 68,107,0
TR 70,107,4096
v_max3_f32 v120, v120, v6, v7
WL 8
MM 88,72,48
TR 72,108,0
TR 74,108,4096
v_max_f32 v120, v120, v121
MM 92,76,48
TR 76,109,0
TR 78,109,4096
DM 115,12,1024
MM 88,80,52
TR 80,110,0
TR 82,110,4096
MM 92,84,52
WL 12
TR 84,111,0
TR 86,111,4096
v_cmp_lt_f32 vcc, s51, v120
s_cbranch_vccnz L_tramp0_21
L_back0_21:
EX 0
EX 1
EX 2
EX 3
EX 4
EX 5
EX 6
EX 7
CV 96,0
CV 97,2
CV 98,4
CV 99,6
WB 12
s_barrier
MM 8,56,96
s_mov_b32 s48, 221184
s_add_u32 m0, s41, 8192
KR 56,100,16384
AD 0
DM 112,8,0
MM 12,60,96
KR 60,100,20480
AD 1
MM 16,64,96
KR 64,101,16384
AD 2
MM 20,68,96
KR 68,101,20480
AD 3
MM 24,72,96
KR 72,102,16384
AD 4
MM 28,76,96
KR 76,102,20480
AD 5
MM 32,80,96
KR 80,103,16384
AD 6
DM 113,8,1024
MM 36,84,96
KR 84,103,20480
AD 7
WL 4
MN 0,56,40
TR 56,104,8192
TR 58,104,12288
MN 4,60,40
s_mov_b32 s48, 212992
s_add_u32 m0, s41, 57344
TR 60,105,8192
TR 62,105,12288
DM 114,12,0
v_max3_f32 v120, v88, v89, v90
MM 0,64,44
TR 64,106,8192
TR 66,106,12288
v_max3_f32 v121, v91, v92, v93
MM 4,68,44
TR 68,107,8192
TR 70,107,12288
v_max3_f32 v120, v120, v94, v95
WL 8
MM 0,72,48
TR 72,108,8192
TR 74,108,12288
v_max_f32 v120, v120, v121
MM 4,76,48
TR 76,109,8192
TR 78,109,12288
DM 115,12,1024
MM 0,80,52
TR 80,110,8192
TR 82,110,12288
MM 4,84,52
WL 12
TR 84,111,8192
TR 86,111,12288
v_cmp_lt_f32 vcc, s51, v120
s_cbranch_vccnz L_tramp0_22
L_back0_22:
EX 88
EX 89
EX 90
EX 91
EX 92
EX 93
EX 94
EX 95
CV 96,88
CV 97,90
CV 98,92
CV 99,94
WB 12
s_barrier
MM 8,56,96
s_mov_b32 s48, 229376
s_add_u32 m0, s41, 16384
KR 56,100,24576
AD 88
DM 112,8,0
MM 12,60,96
KR 60,100,28672
AD 89
MM 16,64,96
KR 64,101,24576
AD 90
MM 20,68,96
KR 68,101,28672
AD 91
MM 24,72,96
KR 72,102,24576
AD 92
MM 28,76,96
KR 76,102,28672
AD 93
MM 32,80,96
KR 80,103,24576
AD 94
DM 113,8,1024
MM 36,84,96
KR 84,103,28672
AD 95
s_cmp_eq_u32 s3, 0
s_cbranch_scc1 L_btramp0_22_0
L_bback0_22_0:
WL 4
MN 88,56,40
TR 56,104,16384
TR 58,104,20480
MN 92,60,40
s_mov_b32 s48, 221184
s_add_u32 m0, s41, 65536
TR 60,105,16384
TR 62,105,20480
DM 114,12,0
v_max3_f32 v120, v0, v1, v2
MM 88,64,44
TR 64,106,16384
TR 66,106,20480
v_max3_f32 v121, v3, v4, v5
MM 92,68,44
TR 68,107,16384
TR 70,107,20480
v_max3_f32 v120, v120, v6, v7
WL 8
MM 88,72,48
TR 72,108,16384
TR 74,108,20480
v_max_f32 v120, v120, v121
MM 92,76,48
TR 76,109,16384
TR 78,109,20480
DM 115,12,1024
MM 88,80,52
TR 80,110,16384
TR 82,110,20480
MM 92,84,52
WL 12
TR 84,111,16384
TR 86,111,20480
v_cmp_lt_f32 vcc, s51, v120
s_cbranch_vccnz L_tramp0_23
L_back0_23:
EX 0
EX 1
EX 2
EX 3
EX 4
EX 5
EX 6
EX 7
CV 96,0
CV 97,2
CV 98,4
CV 99,6
WB 12
s_barrier
MM 8,56,96
s_mov_b32 s48, 237568
s_add_u32 m0, s41, 24576
KR 56,100,32768
AD 0
DM 112,8,0
MM 12,60,96
KR 60,100,36864
AD 1
MM 16,64,96
KR 64,101,32768
AD 2
MM 20,68,96
KR 68,101,36864
AD 3
MM 24,72,96
KR 72,102,32768
AD 4
MM 28,76,96
KR 76,102,36864
AD 5
MM 32,80,96
KR 80,103,32768
AD 6
DM 113,8,1024
MM 36,84,96
KR 84,103,36864
AD 7
WL 4
MN 0,56,40
TR 56,104,24576
TR 58,104,28672
MN 4,60,40
s_mov_b32 s48, 229376
s_add_u32 m0, s41, 73728
TR 60,105,24576
TR 62,105,28672
DM 114,12,0
v_max3_f32 v120, v88, v89, v90
MM 0,64,44
TR 64,106,24576
TR 66,106,28672
v_max3_f32 v121, v91, v92, v93
MM 4,68,44
TR 68,107,24576
TR 70,107,28672
v_max3_f32 v120, v120, v94, v95
WL 8
MM 0,72,48
TR 72,108,24576
TR 74,108,28672
v_max_f32 v120, v120, v121
MM 4,76,48
TR 76,109,24576
TR 78,109,28672
DM 115,12,1024
MM 0,80,52
TR 80,110,24576
TR 82,110,28672
MM 4,84,52
WL 12
TR 84,111,24576
TR 86,111,28672
v_cmp_lt_f32 vcc, s51, v120
s_cbranch_vccnz L_tramp0_24
L_back0_24:
EX 88
EX 89
EX 90
EX 91
EX 92
EX 93
EX 94
EX 95
CV 96,88
CV 97,90
CV 98,92
CV 99,94
WB 12
s_barrier
MM 8,56,96
KR 56,100,0
AD 88
MM 12,60,96
KR 60,100,4096
AD 89
MM 16,64,96
KR 64,101,0
AD 90
MM 20,68,96
KR 68,101,4096
AD 91
MM 24,72,96
KR 72,102,0
AD 92
MM 28,76,96
KR 76,102,4096
AD 93
MM 32,80,96
KR 80,103,0
AD 94
MM 36,84,96
KR 84,103,4096
AD 95
WL 4
MN 88,56,40
TR 56,104,32768
TR 58,104,36864
MN 92,60,40
TR 60,105,32768
TR 62,105,36864
v_max3_f32 v120, v0, v1, v2
MM 88,64,44
TR 64,106,32768
TR 66,106,36864
v_max3_f32 v121, v3, v4, v5
MM 92,68,44
TR 68,107,32768
TR 70,107,36864
v_max3_f32 v120, v120, v6, v7
WL 8
MM 88,72,48
TR 72,108,32768
TR 74,108,36864
v_max_f32 v120, v120, v121
MM 92,76,48
TR 76,109,32768
TR 78,109,36864
MM 88,80,52
TR 80,110,32768
TR 82,110,36864
MM 92,84,52
WL 12
TR 84,111,32768
TR 86,111,36864
v_cmp_lt_f32 vcc, s51, v120
s_cbranch_vccnz L_tramp0_25
L_back0_25:
EX 0
EX 1
EX 2
EX 3
EX 4
EX 5
EX 6
EX 7
CV 96,0
CV 97,2
CV 98,4
CV 99,6
WB 8
s_barrier
MM 8,56,96
s_mov_b32 s48, 245760
s_add_u32 m0, s41, 32768
KR 56,100,8192
AD 0
DM 112,8,0
MM 12,60,96
KR 60,100,12288
AD 1
MM 16,64,96
KR 64,101,8192
AD 2
MM 20,68,96
KR 68,101,12288
AD 3
MM 24,72,96
KR 72,102,8192
AD 4
MM 28,76,96
KR 76,102,12288
AD 5
MM 32,80,96
KR 80,103,8192
AD 6
DM 113,8,1024
MM 36,84,96
KR 84,103,12288
AD 7
WL 4
MN 0,56,40
TR 56,104,0
TR 58,104,4096
MN 4,60,40
TR 60,105,0
TR 62,105,4096
v_max3_f32 v120, v88, v89, v90
MM 0,64,44
TR 64,106,0
TR 66,106,4096
v_max3_f32 v121, v91, v92, v93
MM 4,68,44
TR 68,107,0
TR 70,107,4096
v_max3_f32 v120, v120, v94, v95
WL 8
MM 0,72,48
TR 72,108,0
TR 74,108,4096
v_max_f32 v120, v120, v121
MM 4,76,48
TR 76,109,0
TR 78,109,4096
MM 0,80,52
TR 80,110,0
TR 82,110,4096
MM 4,84,52
WL 12
TR 84,111,0
TR 86,111,4096
v_cmp_lt_f32 vcc, s51, v120
s_cbranch_vccnz L_tramp0_26
L_back0_26:
EX 88
EX 89
EX 90
EX 91
EX 92
EX 93
EX 94
EX 95
CV 96,88
CV 97,90
CV 98,92
CV 99,94
WB 6
s_barrier
MM 8,56,96
s_mov_b32 s48, 237568
s_add_u32 m0, s41, 81920
KR 56,100,16384
AD 88
DM 114,12,0
MM 12,60,96
KR 60,100,20480
AD 89
MM 16,64,96
KR 64,101,16384
AD 90
MM 20,68,96
KR 68,101,20480
AD 91
MM 24,72,96
KR 72,102,16384
AD 92
MM 28,76,96
KR 76,102,20480
AD 93
MM 32,80,96
KR 80,103,16384
AD 94
DM 115,12,1024
MM 36,84,96
KR 84,103,20480
AD 95
WL 4
MN 88,56,40
TR 56,104,8192
TR 58,104,12288
MN 92,60,40
s_mov_b32 s48, 253952
s_add_u32 m0, s41, 0
TR 60,105,8192
TR 62,105,12288
DM 112,8,0
v_max3_f32 v120, v0, v1, v2
MM 88,64,44
TR 64,106,8192
TR 66,106,12288
v_max3_f32 v121, v3, v4, v5
MM 92,68,44
TR 68,107,8192
TR 70,107,12288
v_max3_f32 v120, v120, v6, v7
WL 8
MM 88,72,48
TR 72,108,8192
TR 74,108,12288
v_max_f32 v120, v120, v121
MM 92,76,48
TR 76,109,8192
TR 78,109,12288
DM 113,8,1024
MM 88,80,52
TR 80,110,8192
TR 82,110,12288
MM 92,84,52
WL 12
TR 84,111,8192
TR 86,111,12288
v_cmp_lt_f32 vcc, s51, v120
s_cbranch_vccnz L_tramp0_27
L_back0_27:
EX 0
EX 1
EX 2
EX 3
EX 4
EX 5
EX 6
EX 7
CV 96,0
CV 97,2
CV 98,4
CV 99,6
WB 6
s_barrier
MM 8,56,96
s_mov_b32 s48, 245760
s_add_u32 m0, s41, 90112
KR 56,100,24576
AD 0
DM 114,12,0
MM 12,60,96
KR 60,100,28672
AD 1
MM 16,64,96
KR 64,101,24576
AD 2
MM 20,68,96
KR 68,101,28672
AD 3
MM 24,72,96
KR 72,102,24576
AD 4
MM 28,76,96
KR 76,102,28672
AD 5
MM 32,80,96
KR 80,103,24576
AD 6
DM 115,12,1024
MM 36,84,96
KR 84,103,28672
AD 7
WL 4
MN 0,56,40
TR 56,104,16384
TR 58,104,20480
MN 4,60,40
s_mov_b32 s48, 262144
s_add_u32 m0, s41, 8192
TR 60,105,16384
TR 62,105,20480
DM 112,8,0
v_max3_f32 v120, v88, v89, v90
MM 0,64,44
TR 64,106,16384
TR 66,106,20480
v_max3_f32 v121, v91, v92, v93
MM 4,68,44
TR 68,107,16384
TR 70,107,20480
v_max3_f32 v120, v120, v94, v95
WL 8
MM 0,72,48
TR 72,108,16384
TR 74,108,20480
v_max_f32 v120, v120, v121
MM 4,76,48
TR 76,109,16384
TR 78,109,20480
DM 113,8,1024
MM 0,80,52
TR 80,110,16384
TR 82,110,20480
MM 4,84,52
WL 12
TR 84,111,16384
TR 86,111,20480
v_cmp_lt_f32 vcc, s51, v120
s_cbranch_vccnz L_tramp0_28
L_back0_28:
EX 88
EX 89
EX 90
EX 91
EX 92
EX 93
EX 94
EX 95
CV 96,88
CV 97,90
CV 98,92
CV 99,94
WB 6
s_barrier
MM 8,56,96
s_mov_b32 s48, 253952
s_add_u32 m0, s41, 57344
KR 56,100,32768
AD 88
DM 114,12,0
MM 12,60,96
KR 60,100,36864
AD 89
MM 16,64,96
KR 64,101,32768
AD 90
MM 20,68,96
KR 68,101,36864
AD 91
MM 24,72,96
KR 72,102,32768
AD 92
MM 28,76,96
KR 76,102,36864
AD 93
MM 32,80,96
KR 80,103,32768
AD 94
DM 115,12,1024
MM 36,84,96
KR 84,103,36864
AD 95
s_cmp_eq_u32 s3, 1
s_cbranch_scc1 L_btramp0_28_0
L_bback0_28_0:
WL 4
MN 88,56,40
TR 56,104,24576
TR 58,104,28672
MN 92,60,40
s_mov_b32 s48, 270336
s_add_u32 m0, s41, 16384
TR 60,105,24576
TR 62,105,28672
DM 112,8,0
v_max3_f32 v120, v0, v1, v2
MM 88,64,44
TR 64,106,24576
TR 66,106,28672
v_max3_f32 v121, v3, v4, v5
MM 92,68,44
TR 68,107,24576
TR 70,107,28672
v_max3_f32 v120, v120, v6, v7
WL 8
MM 88,72,48
TR 72,108,24576
TR 74,108,28672
v_max_f32 v120, v120, v121
MM 92,76,48
TR 76,109,24576
TR 78,109,28672
DM 113,8,1024
MM 88,80,52
TR 80,110,24576
TR 82,110,28672
MM 92,84,52
WL 12
TR 84,111,24576
TR 86,111,28672
v_cmp_lt_f32 vcc, s51, v120
s_cbranch_vccnz L_tramp0_29
L_back0_29:
EX 0
EX 1
EX 2
EX 3
EX 4
EX 5
EX 6
EX 7
CV 96,0
CV 97,2
CV 98,4
CV 99,6
WB 6
s_barrier
MM 8,56,96
s_mov_b32 s48, 262144
s_add_u32 m0, s41, 65536
KR 56,100,0
AD 0
DM 114,12,0
MM 12,60,96
KR 60,100,4096
AD 1
MM 16,64,96
KR 64,101,0
AD 2
MM 20,68,96
KR 68,101,4096
AD 3
MM 24,72,96
KR 72,102,0
AD 4
MM 28,76,96
KR 76,102,4096
AD 5
MM 32,80,96
KR 80,103,0
AD 6
DM 115,12,1024
MM 36,84,96
KR 84,103,4096
AD 7
WL 4
MN 0,56,40
TR 56,104,32768
TR 58,104,36864
MN 4,60,40
s_mov_b32 s48, 278528
s_add_u32 m0, s41, 24576
TR 60,105,32768
TR 62,105,36864
DM 112,8,0
v_max3_f32 v120, v88, v89, v90
MM 0,64,44
TR 64,106,32768
TR 66,106,36864
v_max3_f32 v121, v91, v92, v93
MM 4,68,44
TR 68,107,32768
TR 70,107,36864
v_max3_f32 v120, v120, v94, v95
WL 8
MM 0,72,48
TR 72,108,32768
TR 74,108,36864
v_max_f32 v120, v120, v121
MM 4,76,48
TR 76,109,32768
TR 78,109,36864
DM 113,8,1024
MM 0,80,52
TR 80,110,32768
TR 82,110,36864
MM 4,84,52
WL 12
TR 84,111,32768
TR 86,111,36864
v_cmp_lt_f32 vcc, s51, v120
s_cbranch_vccnz L_tramp0_30
L_back0_30:
EX 88
EX 89
EX 90
EX 91
EX 92
EX 93
EX 94
EX 95
CV 96,88
CV 97,90
CV 98,92
CV 99,94
WB 6
s_barrier
MM 8,56,96
s_mov_b32 s48, 270336
s_add_u32 m0, s41, 73728
KR 56,100,8192
AD 88
DM 114,12,0
MM 12,60,96
KR 60,100,12288
AD 89
MM 16,64,96
KR 64,101,8192
AD 90
MM 20,68,96
KR 68,101,12288
AD 91
MM 24,72,96
KR 72,102,8192
AD 92
MM 28,76,96
KR 76,102,12288
AD 93
MM 32,80,96
KR 80,103,8192
AD 94
DM 115,12,1024
MM 36,84,96
KR 84,103,12288
AD 95
WL 4
MN 88,56,40
TR 56,104,0
TR 58,104,4096
MN 92,60,40
s_mov_b32 s48, 286720
s_add_u32 m0, s41, 32768
TR 60,105,0
TR 62,105,4096
DM 112,8,0
v_max3_f32 v120, v0, v1, v2
MM 88,64,44
TR 64,106,0
TR 66,106,4096
v_max3_f32 v121, v3, v4, v5
MM 92,68,44
TR 68,107,0
TR 70,107,4096
v_max3_f32 v120, v120, v6, v7
WL 8
MM 88,72,48
TR 72,108,0
TR 74,108,4096
v_max_f32 v120, v120, v121
MM 92,76,48
TR 76,109,0
TR 78,109,4096
DM 113,8,1024
MM 88,80,52
TR 80,110,0
TR 82,110,4096
MM 92,84,52
WL 12
TR 84,111,0
TR 86,111,4096
v_cmp_lt_f32 vcc, s51, v120
s_cbranch_vccnz L_tramp0_31
L_back0_31:
EX 0
EX 1
EX 2
EX 3
EX 4
EX 5
EX 6
EX 7
CV 96,0
CV 97,2
CV 98,4
CV 99,6
WB 6
s_barrier
MM 8,56,96
s_mov_b32 s48, 278528
s_add_u32 m0, s41, 81920
KR 56,100,16384
AD 0
DM 114,12,0
MM 12,60,96
KR 60,100,20480
AD 1
MM 16,64,96
KR 64,101,16384
AD 2
MM 20,68,96
KR 68,101,20480
AD 3
MM 24,72,96
KR 72,102,16384
AD 4
MM 28,76,96
KR 76,102,20480
AD 5
MM 32,80,96
KR 80,103,16384
AD 6
DM 115,12,1024
MM 36,84,96
KR 84,103,20480
AD 7
WL 4
MN 0,56,40
TR 56,104,8192
TR 58,104,12288
MN 4,60,40
s_mov_b32 s48, 294912
s_add_u32 m0, s41, 0
TR 60,105,8192
TR 62,105,12288
DM 112,8,0
v_max3_f32 v120, v88, v89, v90
MM 0,64,44
TR 64,106,8192
TR 66,106,12288
v_max3_f32 v121, v91, v92, v93
MM 4,68,44
TR 68,107,8192
TR 70,107,12288
v_max3_f32 v120, v120, v94, v95
WL 8
MM 0,72,48
TR 72,108,8192
TR 74,108,12288
v_max_f32 v120, v120, v121
MM 4,76,48
TR 76,109,8192
TR 78,109,12288
DM 113,8,1024
MM 0,80,52
TR 80,110,8192
TR 82,110,12288
MM 4,84,52
WL 12
TR 84,111,8192
TR 86,111,12288
v_cmp_lt_f32 vcc, s51, v120
s_cbranch_vccnz L_tramp0_32
L_back0_32:
EX 88
EX 89
EX 90
EX 91
EX 92
EX 93
EX 94
EX 95
CV 96,88
CV 97,90
CV 98,92
CV 99,94
WB 6
s_barrier
MM 8,56,96
s_mov_b32 s48, 286720
s_add_u32 m0, s41, 90112
KR 56,100,24576
AD 88
DM 114,12,0
MM 12,60,96
KR 60,100,28672
AD 89
MM 16,64,96
KR 64,101,24576
AD 90
MM 20,68,96
KR 68,101,28672
AD 91
MM 24,72,96
KR 72,102,24576
AD 92
MM 28,76,96
KR 76,102,28672
AD 93
MM 32,80,96
KR 80,103,24576
AD 94
DM 115,12,1024
MM 36,84,96
KR 84,103,28672
AD 95
WL 4
MN 88,56,40
TR 56,104,16384
TR 58,104,20480
MN 92,60,40
s_mov_b32 s48, 303104
s_add_u32 m0, s41, 8192
TR 60,105,16384
TR 62,105,20480
DM 112,8,0
v_max3_f32 v120, v0, v1, v2
MM 88,64,44
TR 64,106,16384
TR 66,106,20480
v_max3_f32 v121, v3, v4, v5
MM 92,68,44
TR 68,107,16384
TR 70,107,20480
v_max3_f32 v120, v120, v6, v7
WL 8
MM 88,72,48
TR 72,108,16384
TR 74,108,20480
v_max_f32 v120, v120, v121
MM 92,76,48
TR 76,109,16384
TR 78,109,20480
DM 113,8,1024
MM 88,80,52
TR 80,110,16384
TR 82,110,20480
MM 92,84,52
WL 12
TR 84,111,16384
TR 86,111,20480
v_cmp_lt_f32 vcc, s51, v120
s_cbranch_vccnz L_tramp0_33
L_back0_33:
EX 0
EX 1
EX 2
EX 3
EX 4
EX 5
EX 6
EX 7
CV 96,0
CV 97,2
CV 98,4
CV 99,6
WB 6
s_barrier
MM 8,56,96
s_mov_b32 s48, 294912
s_add_u32 m0, s41, 57344
KR 56,100,32768
AD 0
DM 114,12,0
MM 12,60,96
KR 60,100,36864
AD 1
MM 16,64,96
KR 64,101,32768
AD 2
MM 20,68,96
KR 68,101,36864
AD 3
MM 24,72,96
KR 72,102,32768
AD 4
MM 28,76,96
KR 76,102,36864
AD 5
MM 32,80,96
KR 80,103,32768
AD 6
DM 115,12,1024
MM 36,84,96
KR 84,103,36864
AD 7
WL 4
MN 0,56,40
TR 56,104,24576
TR 58,104,28672
MN 4,60,40
s_mov_b32 s48, 311296
s_add_u32 m0, s41, 16384
TR 60,105,24576
TR 62,105,28672
DM 112,8,0
v_max3_f32 v120, v88, v89, v90
MM 0,64,44
TR 64,106,24576
TR 66,106,28672
v_max3_f32 v121, v91, v92, v93
MM 4,68,44
TR 68,107,24576
TR 70,107,28672
v_max3_f32 v120, v120, v94, v95
WL 8
MM 0,72,48
TR 72,108,24576
TR 74,108,28672
v_max_f32 v120, v120, v121
MM 4,76,48
TR 76,109,24576
TR 78,109,28672
DM 113,8,1024
MM 0,80,52
TR 80,110,24576
TR 82,110,28672
MM 4,84,52
WL 12
TR 84,111,24576
TR 86,111,28672
v_cmp_lt_f32 vcc, s51, v120
s_cbranch_vccnz L_tramp0_34
L_back0_34:
EX 88
EX 89
EX 90
EX 91
EX 92
EX 93
EX 94
EX 95
CV 96,88
CV 97,90
CV 98,92
CV 99,94
WB 6
s_barrier
MM 8,56,96
s_mov_b32 s48, 303104
s_add_u32 m0, s41, 65536
KR 56,100,0
AD 88
DM 114,12,0
MM 12,60,96
KR 60,100,4096
AD 89
MM 16,64,96
KR 64,101,0
AD 90
MM 20,68,96
KR 68,101,4096
AD 91
MM 24,72,96
KR 72,102,0
AD 92
MM 28,76,96
KR 76,102,4096
AD 93
MM 32,80,96
KR 80,103,0
AD 94
DM 115,12,1024
MM 36,84,96
KR 84,103,4096
AD 95
s_cmp_eq_u32 s3, 2
s_cbranch_scc1 L_btramp0_34_0
L_bback0_34_0:
WL 4
MN 88,56,40
TR 56,104,32768
TR 58,104,36864
MN 92,60,40
s_mov_b32 s48, 319488
s_add_u32 m0, s41, 24576
TR 60,105,32768
TR 62,105,36864
DM 112,8,0
v_max3_f32 v120, v0, v1, v2
MM 88,64,44
TR 64,106,32768
TR 66,106,36864
v_max3_f32 v121, v3, v4, v5
MM 92,68,44
TR 68,107,32768
TR 70,107,36864
v_max3_f32 v120, v120, v6, v7
WL 8
MM 88,72,48
TR 72,108,32768
TR 74,108,36864
v_max_f32 v120, v120, v121
MM 92,76,48
TR 76,109,32768
TR 78,109,36864
DM 113,8,1024
MM 88,80,52
TR 80,110,32768
TR 82,110,36864
MM 92,84,52
WL 12
TR 84,111,32768
TR 86,111,36864
v_cmp_lt_f32 vcc, s51, v120
s_cbranch_vccnz L_tramp0_35
L_back0_35:
EX 0
EX 1
EX 2
EX 3
EX 4
EX 5
EX 6
EX 7
CV 96,0
CV 97,2
CV 98,4
CV 99,6
WB 6
s_barrier
MM 8,56,96
s_mov_b32 s48, 311296
s_add_u32 m0, s41, 73728
KR 56,100,8192
AD 0
DM 114,12,0
MM 12,60,96
KR 60,100,12288
AD 1
MM 16,64,96
KR 64,101,8192
AD 2
MM 20,68,96
KR 68,101,12288
AD 3
MM 24,72,96
KR 72,102,8192
AD 4
MM 28,76,96
KR 76,102,12288
AD 5
MM 32,80,96
KR 80,103,8192
AD 6
DM 115,12,1024
MM 36,84,96
KR 84,103,12288
AD 7
WL 4
MN 0,56,40
TR 56,104,0
TR 58,104,4096
MN 4,60,40
s_mov_b32 s48, 327680
s_add_u32 m0, s41, 32768
TR 60,105,0
TR 62,105,4096
DM 112,8,0
v_max3_f32 v120, v88, v89, v90
MM 0,64,44
TR 64,106,0
TR 66,106,4096
v_max3_f32 v121, v91, v92, v93
MM 4,68,44
TR 68,107,0
TR 70,107,4096
v_max3_f32 v120, v120, v94, v95
WL 8
MM 0,72,48
TR 72,108,0
TR 74,108,4096
v_max_f32 v120, v120, v121
MM 4,76,48
TR 76,109,0
TR 78,109,4096
DM 113,8,1024
MM 0,80,52
TR 80,110,0
TR 82,110,4096
MM 4,84,52
WL 12
TR 84,111,0
TR 86,111,4096
v_cmp_lt_f32 vcc, s51, v120
s_cbranch_vccnz L_tramp0_36
L_back0_36:
EX 88
EX 89
EX 90
EX 91
EX 92
EX 93
EX 94
EX 95
CV 96,88
CV 97,90
CV 98,92
CV 99,94
WB 6
s_barrier
MM 8,56,96
s_mov_b32 s48, 319488
s_add_u32 m0, s41, 81920
KR 56,100,16384
AD 88
DM 114,12,0
MM 12,60,96
KR 60,100,20480
AD 89
MM 16,64,96
KR 64,101,16384
AD 90
MM 20,68,96
KR 68,101,20480
AD 91
MM 24,72,96
KR 72,102,16384
AD 92
MM 28,76,96
KR 76,102,20480
AD 93
MM 32,80,96
KR 80,103,16384
AD 94
DM 115,12,1024
MM 36,84,96
KR 84,103,20480
AD 95
WL 4
MN 88,56,40
TR 56,104,8192
TR 58,104,12288
MN 92,60,40
s_mov_b32 s48, 335872
s_add_u32 m0, s41, 0
TR 60,105,8192
TR 62,105,12288
DM 112,8,0
v_max3_f32 v120, v0, v1, v2
MM 88,64,44
TR 64,106,8192
TR 66,106,12288
v_max3_f32 v121, v3, v4, v5
MM 92,68,44
TR 68,107,8192
TR 70,107,12288
v_max3_f32 v120, v120, v6, v7
WL 8
MM 88,72,48
TR 72,108,8192
TR 74,108,12288
v_max_f32 v120, v120, v121
MM 92,76,48
TR 76,109,8192
TR 78,109,12288
DM 113,8,1024
MM 88,80,52
TR 80,110,8192
TR 82,110,12288
MM 92,84,52
WL 12
TR 84,111,8192
TR 86,111,12288
v_cmp_lt_f32 vcc, s51, v120
s_cbranch_vccnz L_tramp0_37
L_back0_37:
EX 0
EX 1
EX 2
EX 3
EX 4
EX 5
EX 6
EX 7
CV 96,0
CV 97,2
CV 98,4
CV 99,6
WB 6
s_barrier
MM 8,56,96
s_mov_b32 s48, 327680
s_add_u32 m0, s41, 90112
KR 56,100,24576
AD 0
DM 114,12,0
MM 12,60,96
KR 60,100,28672
AD 1
MM 16,64,96
KR 64,101,24576
AD 2
MM 20,68,96
KR 68,101,28672
AD 3
MM 24,72,96
KR 72,102,24576
AD 4
MM 28,76,96
KR 76,102,28672
AD 5
MM 32,80,96
KR 80,103,24576
AD 6
DM 115,12,1024
MM 36,84,96
KR 84,103,28672
AD 7
WL 4
MN 0,56,40
TR 56,104,16384
TR 58,104,20480
MN 4,60,40
s_mov_b32 s48, 344064
s_add_u32 m0, s41, 8192
TR 60,105,16384
TR 62,105,20480
DM 112,8,0
v_max3_f32 v120, v88, v89, v90
MM 0,64,44
TR 64,106,16384
TR 66,106,20480
v_max3_f32 v121, v91, v92, v93
MM 4,68,44
TR 68,107,16384
TR 70,107,20480
v_max3_f32 v120, v120, v94, v95
WL 8
MM 0,72,48
TR 72,108,16384
TR 74,108,20480
v_max_f32 v120, v120, v121
MM 4,76,48
TR 76,109,16384
TR 78,109,20480
DM 113,8,1024
MM 0,80,52
TR 80,110,16384
TR 82,110,20480
MM 4,84,52
WL 12
TR 84,111,16384
TR 86,111,20480
v_cmp_lt_f32 vcc, s51, v120
s_cbranch_vccnz L_tramp0_38
L_back0_38:
EX 88
EX 89
EX 90
EX 91
EX 92
EX 93
EX 94
EX 95
CV 96,88
CV 97,90
CV 98,92
CV 99,94
WB 6
s_barrier
MM 8,56,96
s_mov_b32 s48, 335872
s_add_u32 m0, s41, 57344
KR 56,100,32768
AD 88
DM 114,12,0
MM 12,60,96
KR 60,100,36864
AD 89
MM 16,64,96
KR 64,101,32768
AD 90
MM 20,68,96
KR 68,101,36864
AD 91
MM 24,72,96
KR 72,102,32768
AD 92
MM 28,76,96
KR 76,102,36864
AD 93
MM 32,80,96
KR 80,103,32768
AD 94
DM 115,12,1024
MM 36,84,96
KR 84,103,36864
AD 95
WL 4
MN 88,56,40
TR 56,104,24576
TR 58,104,28672
MN 92,60,40
s_mov_b32 s48, 352256
s_add_u32 m0, s41, 16384
TR 60,105,24576
TR 62,105,28672
DM 112,8,0
v_max3_f32 v120, v0, v1, v2
MM 88,64,44
TR 64,106,24576
TR 66,106,28672
v_max3_f32 v121, v3, v4, v5
MM 92,68,44
TR 68,107,24576
TR 70,107,28672
v_max3_f32 v120, v120, v6, v7
WL 8
MM 88,72,48
TR 72,108,24576
TR 74,108,28672
v_max_f32 v120, v120, v121
MM 92,76,48
TR 76,109,24576
TR 78,109,28672
DM 113,8,1024
MM 88,80,52
TR 80,110,24576
TR 82,110,28672
MM 92,84,52
WL 12
TR 84,111,24576
TR 86,111,28672
v_cmp_lt_f32 vcc, s51, v120
s_cbranch_vccnz L_tramp0_39
L_back0_39:
EX 0
EX 1
EX 2
EX 3
EX 4
EX 5
EX 6
EX 7
CV 96,0
CV 97,2
CV 98,4
CV 99,6
WB 6
s_barrier
MM 8,56,96
s_mov_b32 s48, 344064
s_add_u32 m0, s41, 65536
KR 56,100,0
AD 0
DM 114,12,0
MM 12,60,96
KR 60,100,4096
AD 1
MM 16,64,96
KR 64,101,0
AD 2
MM 20,68,96
KR 68,101,4096
AD 3
MM 24,72,96
KR 72,102,0
AD 4
MM 28,76,96
KR 76,102,4096
AD 5
MM 32,80,96
KR 80,103,0
AD 6
DM 115,12,1024
MM 36,84,96
KR 84,103,4096
AD 7
WL 4
MN 0,56,40
TR 56,104,32768
TR 58,104,36864
MN 4,60,40
s_mov_b32 s48, 360448
s_add_u32 m0, s41, 24576
TR 60,105,32768
TR 62,105,36864
DM 112,8,0
v_max3_f32 v120, v88, v89, v90
MM 0,64,44
TR 64,106,32768
TR 66,106,36864
v_max3_f32 v121, v91, v92, v93
MM 4,68,44
TR 68,107,32768
TR 70,107,36864
v_max3_f32 v120, v120, v94, v95
WL 8
MM 0,72,48
TR 72,108,32768
TR 74,108,36864
v_max_f32 v120, v120, v121
MM 4,76,48
TR 76,109,32768
TR 78,109,36864
DM 113,8,1024
MM 0,80,52
TR 80,110,32768
TR 82,110,36864
MM 4,84,52
WL 12
TR 84,111,32768
TR 86,111,36864
v_cmp_lt_f32 vcc, s51, v120
s_cbranch_vccnz L_tramp0_40
L_back0_40:
EX 88
EX 89
EX 90
EX 91
EX 92
EX 93
EX 94
EX 95
CV 96,88
CV 97,90
CV 98,92
CV 99,94
WB 6
s_barrier
MM 8,56,96
s_mov_b32 s48, 352256
s_add_u32 m0, s41, 73728
KR 56,100,8192
AD 88
DM 114,12,0
MM 12,60,96
KR 60,100,12288
AD 89
MM 16,64,96
KR 64,101,8192
AD 90
MM 20,68,96
KR 68,101,12288
AD 91
MM 24,72,96
KR 72,102,8192
AD 92
MM 28,76,96
KR 76,102,12288
AD 93
MM 32,80,96
KR 80,103,8192
AD 94
DM 115,12,1024
MM 36,84,96
KR 84,103,12288
AD 95
WL 4
MN 88,56,40
TR 56,104,0
TR 58,104,4096
MN 92,60,40
s_mov_b32 s48, 368640
s_add_u32 m0, s41, 32768
TR 60,105,0
TR 62,105,4096
DM 112,8,0
v_max3_f32 v120, v0, v1, v2
MM 88,64,44
TR 64,106,0
TR 66,106,4096
v_max3_f32 v121, v3, v4, v5
MM 92,68,44
TR 68,107,0
TR 70,107,4096
v_max3_f32 v120, v120, v6, v7
WL 8
MM 88,72,48
TR 72,108,0
TR 74,108,4096
v_max_f32 v120, v120, v121
MM 92,76,48
TR 76,109,0
TR 78,109,4096
DM 113,8,1024
MM 88,80,52
TR 80,110,0
TR 82,110,4096
MM 92,84,52
WL 12
TR 84,111,0
TR 86,111,4096
v_cmp_lt_f32 vcc, s51, v120
s_cbranch_vccnz L_tramp0_41
L_back0_41:
EX 0
EX 1
EX 2
EX 3
EX 4
EX 5
EX 6
EX 7
CV 96,0
CV 97,2
CV 98,4
CV 99,6
WB 6
s_barrier
MM 8,56,96
s_mov_b32 s48, 360448
s_add_u32 m0, s41, 81920
KR 56,100,16384
AD 0
DM 114,12,0
MM 12,60,96
KR 60,100,20480
AD 1
MM 16,64,96
KR 64,101,16384
AD 2
MM 20,68,96
KR 68,101,20480
AD 3
MM 24,72,96
KR 72,102,16384
AD 4
MM 28,76,96
KR 76,102,20480
AD 5
MM 32,80,96
KR 80,103,16384
AD 6
DM 115,12,1024
MM 36,84,96
KR 84,103,20480
AD 7
WL 4
MN 0,56,40
TR 56,104,8192
TR 58,104,12288
MN 4,60,40
s_mov_b32 s48, 376832
s_add_u32 m0, s41, 0
TR 60,105,8192
TR 62,105,12288
DM 112,8,0
v_max3_f32 v120, v88, v89, v90
MM 0,64,44
TR 64,106,8192
TR 66,106,12288
v_max3_f32 v121, v91, v92, v93
MM 4,68,44
TR 68,107,8192
TR 70,107,12288
v_max3_f32 v120, v120, v94, v95
WL 8
MM 0,72,48
TR 72,108,8192
TR 74,108,12288
v_max_f32 v120, v120, v121
MM 4,76,48
TR 76,109,8192
TR 78,109,12288
DM 113,8,1024
MM 0,80,52
TR 80,110,8192
TR 82,110,12288
MM 4,84,52
WL 12
TR 84,111,8192
TR 86,111,12288
v_cmp_lt_f32 vcc, s51, v120
s_cbranch_vccnz L_tramp0_42
L_back0_42:
EX 88
EX 89
EX 90
EX 91
EX 92
EX 93
EX 94
EX 95
CV 96,88
CV 97,90
CV 98,92
CV 99,94
WB 6
s_barrier
MM 8,56,96
s_mov_b32 s48, 368640
s_add_u32 m0, s41, 90112
KR 56,100,24576
AD 88
DM 114,12,0
MM 12,60,96
KR 60,100,28672
AD 89
MM 16,64,96
KR 64,101,24576
AD 90
MM 20,68,96
KR 68,101,28672
AD 91
MM 24,72,96
KR 72,102,24576
AD 92
MM 28,76,96
KR 76,102,28672
AD 93
MM 32,80,96
KR 80,103,24576
AD 94
DM 115,12,1024
MM 36,84,96
KR 84,103,28672
AD 95
WL 4
MN 88,56,40
TR 56,104,16384
TR 58,104,20480
MN 92,60,40
s_mov_b32 s48, 385024
s_add_u32 m0, s41, 8192
TR 60,105,16384
TR 62,105,20480
DM 112,8,0
v_max3_f32 v120, v0, v1, v2
MM 88,64,44
TR 64,106,16384
TR 66,106,20480
v_max3_f32 v121, v3, v4, v5
MM 92,68,44
TR 68,107,16384
TR 70,107,20480
v_max3_f32 v120, v120, v6, v7
WL 8
MM 88,72,48
TR 72,108,16384
TR 74,108,20480
v_max_f32 v120, v120, v121
MM 92,76,48
TR 76,109,16384
TR 78,109,20480
DM 113,8,1024
MM 88,80,52
TR 80,110,16384
TR 82,110,20480
MM 92,84,52
WL 12
TR 84,111,16384
TR 86,111,20480
v_cmp_lt_f32 vcc, s51, v120
s_cbranch_vccnz L_tramp0_43
L_back0_43:
EX 0
EX 1
EX 2
EX 3
EX 4
EX 5
EX 6
EX 7
CV 96,0
CV 97,2
CV 98,4
CV 99,6
WB 6
s_barrier
MM 8,56,96
s_mov_b32 s48, 376832
s_add_u32 m0, s41, 57344
KR 56,100,32768
AD 0
DM 114,12,0
MM 12,60,96
KR 60,100,36864
AD 1
MM 16,64,96
KR 64,101,32768
AD 2
MM 20,68,96
KR 68,101,36864
AD 3
MM 24,72,96
KR 72,102,32768
AD 4
MM 28,76,96
KR 76,102,36864
AD 5
MM 32,80,96
KR 80,103,32768
AD 6
DM 115,12,1024
MM 36,84,96
KR 84,103,36864
AD 7
WL 4
MN 0,56,40
TR 56,104,24576
TR 58,104,28672
MN 4,60,40
s_mov_b32 s48, 393216
s_add_u32 m0, s41, 16384
TR 60,105,24576
TR 62,105,28672
DM 112,8,0
v_max3_f32 v120, v88, v89, v90
MM 0,64,44
TR 64,106,24576
TR 66,106,28672
v_max3_f32 v121, v91, v92, v93
MM 4,68,44
TR 68,107,24576
TR 70,107,28672
v_max3_f32 v120, v120, v94, v95
WL 8
MM 0,72,48
TR 72,108,24576
TR 74,108,28672
v_max_f32 v120, v120, v121
MM 4,76,48
TR 76,109,24576
TR 78,109,28672
DM 113,8,1024
MM 0,80,52
TR 80,110,24576
TR 82,110,28672
MM 4,84,52
WL 12
TR 84,111,24576
TR 86,111,28672
v_cmp_lt_f32 vcc, s51, v120
s_cbranch_vccnz L_tramp0_44
L_back0_44:
EX 88
EX 89
EX 90
EX 91
EX 92
EX 93
EX 94
EX 95
CV 96,88
CV 97,90
CV 98,92
CV 99,94
WB 6
s_barrier
MM 8,56,96
s_mov_b32 s48, 385024
s_add_u32 m0, s41, 65536
KR 56,100,0
AD 88
DM 114,12,0
MM 12,60,96
KR 60,100,4096
AD 89
MM 16,64,96
KR 64,101,0
AD 90
MM 20,68,96
KR 68,101,4096
AD 91
MM 24,72,96
KR 72,102,0
AD 92
MM 28,76,96
KR 76,102,4096
AD 93
MM 32,80,96
KR 80,103,0
AD 94
DM 115,12,1024
MM 36,84,96
KR 84,103,4096
AD 95
WL 4
MN 88,56,40
TR 56,104,32768
TR 58,104,36864
MN 92,60,40
s_mov_b32 s48, 401408
s_add_u32 m0, s41, 24576
TR 60,105,32768
TR 62,105,36864
DM 112,8,0
v_max3_f32 v120, v0, v1, v2
MM 88,64,44
TR 64,106,32768
TR 66,106,36864
v_max3_f32 v121, v3, v4, v5
MM 92,68,44
TR 68,107,32768
TR 70,107,36864
v_max3_f32 v120, v120, v6, v7
WL 8
MM 88,72,48
TR 72,108,32768
TR 74,108,36864
v_max_f32 v120, v120, v121
MM 92,76,48
TR 76,109,32768
TR 78,109,36864
DM 113,8,1024
MM 88,80,52
TR 80,110,32768
TR 82,110,36864
MM 92,84,52
WL 12
TR 84,111,32768
TR 86,111,36864
v_cmp_lt_f32 vcc, s51, v120
s_cbranch_vccnz L_tramp0_45
L_back0_45:
EX 0
EX 1
EX 2
EX 3
EX 4
EX 5
EX 6
EX 7
CV 96,0
CV 97,2
CV 98,4
CV 99,6
WB 6
s_barrier
MM 8,56,96
s_mov_b32 s48, 393216
s_add_u32 m0, s41, 73728
KR 56,100,8192
AD 0
DM 114,12,0
MM 12,60,96
KR 60,100,12288
AD 1
MM 16,64,96
KR 64,101,8192
AD 2
MM 20,68,96
KR 68,101,12288
AD 3
MM 24,72,96
KR 72,102,8192
AD 4
MM 28,76,96
KR 76,102,12288
AD 5
MM 32,80,96
KR 80,103,8192
AD 6
DM 115,12,1024
MM 36,84,96
KR 84,103,12288
AD 7
WL 4
MN 0,56,40
TR 56,104,0
TR 58,104,4096
MN 4,60,40
s_mov_b32 s48, 409600
s_add_u32 m0, s41, 32768
TR 60,105,0
TR 62,105,4096
DM 112,8,0
v_max3_f32 v120, v88, v89, v90
MM 0,64,44
TR 64,106,0
TR 66,106,4096
v_max3_f32 v121, v91, v92, v93
MM 4,68,44
TR 68,107,0
TR 70,107,4096
v_max3_f32 v120, v120, v94, v95
WL 8
MM 0,72,48
TR 72,108,0
TR 74,108,4096
v_max_f32 v120, v120, v121
MM 4,76,48
TR 76,109,0
TR 78,109,4096
DM 113,8,1024
MM 0,80,52
TR 80,110,0
TR 82,110,4096
MM 4,84,52
WL 12
TR 84,111,0
TR 86,111,4096
v_cmp_lt_f32 vcc, s51, v120
s_cbranch_vccnz L_tramp0_46
L_back0_46:
EX 88
EX 89
EX 90
EX 91
EX 92
EX 93
EX 94
EX 95
CV 96,88
CV 97,90
CV 98,92
CV 99,94
WB 6
s_barrier
MM 8,56,96
s_mov_b32 s48, 401408
s_add_u32 m0, s41, 81920
KR 56,100,16384
AD 88
DM 114,12,0
MM 12,60,96
KR 60,100,20480
AD 89
MM 16,64,96
KR 64,101,16384
AD 90
MM 20,68,96
KR 68,101,20480
AD 91
MM 24,72,96
KR 72,102,16384
AD 92
MM 28,76,96
KR 76,102,20480
AD 93
MM 32,80,96
KR 80,103,16384
AD 94
DM 115,12,1024
MM 36,84,96
KR 84,103,20480
AD 95
WL 4
MN 88,56,40
TR 56,104,8192
TR 58,104,12288
MN 92,60,40
s_mov_b32 s48, 417792
s_add_u32 m0, s41, 0
TR 60,105,8192
TR 62,105,12288
DM 112,8,0
v_max3_f32 v120, v0, v1, v2
MM 88,64,44
TR 64,106,8192
TR 66,106,12288
v_max3_f32 v121, v3, v4, v5
MM 92,68,44
TR 68,107,8192
TR 70,107,12288
v_max3_f32 v120, v120, v6, v7
WL 8
MM 88,72,48
TR 72,108,8192
TR 74,108,12288
v_max_f32 v120, v120, v121
MM 92,76,48
TR 76,109,8192
TR 78,109,12288
DM 113,8,1024
MM 88,80,52
TR 80,110,8192
TR 82,110,12288
MM 92,84,52
WL 12
TR 84,111,8192
TR 86,111,12288
v_cmp_lt_f32 vcc, s51, v120
s_cbranch_vccnz L_tramp0_47
L_back0_47:
EX 0
EX 1
EX 2
EX 3
EX 4
EX 5
EX 6
EX 7
CV 96,0
CV 97,2
CV 98,4
CV 99,6
WB 6
s_barrier
MM 8,56,96
s_mov_b32 s48, 409600
s_add_u32 m0, s41, 90112
KR 56,100,24576
AD 0
DM 114,12,0
MM 12,60,96
KR 60,100,28672
AD 1
MM 16,64,96
KR 64,101,24576
AD 2
MM 20,68,96
KR 68,101,28672
AD 3
MM 24,72,96
KR 72,102,24576
AD 4
MM 28,76,96
KR 76,102,28672
AD 5
MM 32,80,96
KR 80,103,24576
AD 6
DM 115,12,1024
MM 36,84,96
KR 84,103,28672
AD 7
WL 4
MN 0,56,40
TR 56,104,16384
TR 58,104,20480
MN 4,60,40
s_mov_b32 s48, 425984
s_add_u32 m0, s41, 8192
TR 60,105,16384
TR 62,105,20480
DM 112,8,0
v_max3_f32 v120, v88, v89, v90
MM 0,64,44
TR 64,106,16384
TR 66,106,20480
v_max3_f32 v121, v91, v92, v93
MM 4,68,44
TR 68,107,16384
TR 70,107,20480
v_max3_f32 v120, v120, v94, v95
WL 8
MM 0,72,48
TR 72,108,16384
TR 74,108,20480
v_max_f32 v120, v120, v121
MM 4,76,48
TR 76,109,16384
TR 78,109,20480
DM 113,8,1024
MM 0,80,52
TR 80,110,16384
TR 82,110,20480
MM 4,84,52
WL 12
TR 84,111,16384
TR 86,111,20480
v_cmp_lt_f32 vcc, s51, v120
s_cbranch_vccnz L_tramp0_48
L_back0_48:
EX 88
EX 89
EX 90
EX 91
EX 92
EX 93
EX 94
EX 95
CV 96,88
CV 97,90
CV 98,92
CV 99,94
WB 6
s_barrier
MM 8,56,96
s_mov_b32 s48, 417792
s_add_u32 m0, s41, 57344
KR 56,100,32768
AD 88
DM 114,12,0
MM 12,60,96
KR 60,100,36864
AD 89
MM 16,64,96
KR 64,101,32768
AD 90
MM 20,68,96
KR 68,101,36864
AD 91
MM 24,72,96
KR 72,102,32768
AD 92
MM 28,76,96
KR 76,102,36864
AD 93
MM 32,80,96
KR 80,103,32768
AD 94
DM 115,12,1024
MM 36,84,96
KR 84,103,36864
AD 95
WL 4
MN 88,56,40
TR 56,104,24576
TR 58,104,28672
MN 92,60,40
s_mov_b32 s48, 434176
s_add_u32 m0, s41, 16384
TR 60,105,24576
TR 62,105,28672
DM 112,8,0
v_max3_f32 v120, v0, v1, v2
MM 88,64,44
TR 64,106,24576
TR 66,106,28672
v_max3_f32 v121, v3, v4, v5
MM 92,68,44
TR 68,107,24576
TR 70,107,28672
v_max3_f32 v120, v120, v6, v7
WL 8
MM 88,72,48
TR 72,108,24576
TR 74,108,28672
v_max_f32 v120, v120, v121
MM 92,76,48
TR 76,109,24576
TR 78,109,28672
DM 113,8,1024
MM 88,80,52
TR 80,110,24576
TR 82,110,28672
MM 92,84,52
WL 12
TR 84,111,24576
TR 86,111,28672
v_cmp_lt_f32 vcc, s51, v120
s_cbranch_vccnz L_tramp0_49
L_back0_49:
EX 0
EX 1
EX 2
EX 3
EX 4
EX 5
EX 6
EX 7
CV 96,0
CV 97,2
CV 98,4
CV 99,6
WB 6
s_barrier
MM 8,56,96
s_mov_b32 s48, 425984
s_add_u32 m0, s41, 65536
KR 56,100,0
AD 0
DM 114,12,0
MM 12,60,96
KR 60,100,4096
AD 1
MM 16,64,96
KR 64,101,0
AD 2
MM 20,68,96
KR 68,101,4096
AD 3
MM 24,72,96
KR 72,102,0
AD 4
MM 28,76,96
KR 76,102,4096
AD 5
MM 32,80,96
KR 80,103,0
AD 6
DM 115,12,1024
MM 36,84,96
KR 84,103,4096
AD 7
WL 4
MN 0,56,40
TR 56,104,32768
TR 58,104,36864
MN 4,60,40
s_mov_b32 s48, 442368
s_add_u32 m0, s41, 24576
TR 60,105,32768
TR 62,105,36864
DM 112,8,0
v_max3_f32 v120, v88, v89, v90
MM 0,64,44
TR 64,106,32768
TR 66,106,36864
v_max3_f32 v121, v91, v92, v93
MM 4,68,44
TR 68,107,32768
TR 70,107,36864
v_max3_f32 v120, v120, v94, v95
WL 8
MM 0,72,48
TR 72,108,32768
TR 74,108,36864
v_max_f32 v120, v120, v121
MM 4,76,48
TR 76,109,32768
TR 78,109,36864
DM 113,8,1024
MM 0,80,52
TR 80,110,32768
TR 82,110,36864
MM 4,84,52
WL 12
TR 84,111,32768
TR 86,111,36864
v_cmp_lt_f32 vcc, s51, v120
s_cbranch_vccnz L_tramp0_50
L_back0_50:
EX 88
EX 89
EX 90
EX 91
EX 92
EX 93
EX 94
EX 95
CV 96,88
CV 97,90
CV 98,92
CV 99,94
WB 6
s_barrier
MM 8,56,96
s_mov_b32 s48, 434176
s_add_u32 m0, s41, 73728
KR 56,100,8192
AD 88
DM 114,12,0
MM 12,60,96
KR 60,100,12288
AD 89
MM 16,64,96
KR 64,101,8192
AD 90
MM 20,68,96
KR 68,101,12288
AD 91
MM 24,72,96
KR 72,102,8192
AD 92
MM 28,76,96
KR 76,102,12288
AD 93
MM 32,80,96
KR 80,103,8192
AD 94
DM 115,12,1024
MM 36,84,96
KR 84,103,12288
AD 95
WL 4
MN 88,56,40
TR 56,104,0
TR 58,104,4096
MN 92,60,40
s_mov_b32 s48, 450560
s_add_u32 m0, s41, 32768
TR 60,105,0
TR 62,105,4096
DM 112,8,0
v_max3_f32 v120, v0, v1, v2
MM 88,64,44
TR 64,106,0
TR 66,106,4096
v_max3_f32 v121, v3, v4, v5
MM 92,68,44
TR 68,107,0
TR 70,107,4096
v_max3_f32 v120, v120, v6, v7
WL 8
MM 88,72,48
TR 72,108,0
TR 74,108,4096
v_max_f32 v120, v120, v121
MM 92,76,48
TR 76,109,0
TR 78,109,4096
DM 113,8,1024
MM 88,80,52
TR 80,110,0
TR 82,110,4096
MM 92,84,52
WL 12
TR 84,111,0
TR 86,111,4096
v_cmp_lt_f32 vcc, s51, v120
s_cbranch_vccnz L_tramp0_51
L_back0_51:
EX 0
EX 1
EX 2
EX 3
EX 4
EX 5
EX 6
EX 7
CV 96,0
CV 97,2
CV 98,4
CV 99,6
WB 6
s_barrier
MM 8,56,96
s_mov_b32 s48, 442368
s_add_u32 m0, s41, 81920
KR 56,100,16384
AD 0
DM 114,12,0
MM 12,60,96
KR 60,100,20480
AD 1
MM 16,64,96
KR 64,101,16384
AD 2
MM 20,68,96
KR 68,101,20480
AD 3
MM 24,72,96
KR 72,102,16384
AD 4
MM 28,76,96
KR 76,102,20480
AD 5
MM 32,80,96
KR 80,103,16384
AD 6
DM 115,12,1024
MM 36,84,96
KR 84,103,20480
AD 7
WL 4
MN 0,56,40
TR 56,104,8192
TR 58,104,12288
MN 4,60,40
s_mov_b32 s48, 458752
s_add_u32 m0, s41, 0
TR 60,105,8192
TR 62,105,12288
DM 112,8,0
v_max3_f32 v120, v88, v89, v90
MM 0,64,44
TR 64,106,8192
TR 66,106,12288
v_max3_f32 v121, v91, v92, v93
MM 4,68,44
TR 68,107,8192
TR 70,107,12288
v_max3_f32 v120, v120, v94, v95
WL 8
MM 0,72,48
TR 72,108,8192
TR 74,108,12288
v_max_f32 v120, v120, v121
MM 4,76,48
TR 76,109,8192
TR 78,109,12288
DM 113,8,1024
MM 0,80,52
TR 80,110,8192
TR 82,110,12288
MM 4,84,52
WL 12
TR 84,111,8192
TR 86,111,12288
v_cmp_lt_f32 vcc, s51, v120
s_cbranch_vccnz L_tramp0_52
L_back0_52:
EX 88
EX 89
EX 90
EX 91
EX 92
EX 93
EX 94
EX 95
CV 96,88
CV 97,90
CV 98,92
CV 99,94
WB 6
s_barrier
MM 8,56,96
s_mov_b32 s48, 450560
s_add_u32 m0, s41, 90112
KR 56,100,24576
AD 88
DM 114,12,0
MM 12,60,96
KR 60,100,28672
AD 89
MM 16,64,96
KR 64,101,24576
AD 90
MM 20,68,96
KR 68,101,28672
AD 91
MM 24,72,96
KR 72,102,24576
AD 92
MM 28,76,96
KR 76,102,28672
AD 93
MM 32,80,96
KR 80,103,24576
AD 94
DM 115,12,1024
MM 36,84,96
KR 84,103,28672
AD 95
WL 4
MN 88,56,40
TR 56,104,16384
TR 58,104,20480
MN 92,60,40
s_mov_b32 s48, 466944
s_add_u32 m0, s41, 8192
TR 60,105,16384
TR 62,105,20480
DM 112,8,0
v_max3_f32 v120, v0, v1, v2
MM 88,64,44
TR 64,106,16384
TR 66,106,20480
v_max3_f32 v121, v3, v4, v5
MM 92,68,44
TR 68,107,16384
TR 70,107,20480
v_max3_f32 v120, v120, v6, v7
WL 8
MM 88,72,48
TR 72,108,16384
TR 74,108,20480
v_max_f32 v120, v120, v121
MM 92,76,48
TR 76,109,16384
TR 78,109,20480
DM 113,8,1024
MM 88,80,52
TR 80,110,16384
TR 82,110,20480
MM 92,84,52
WL 12
TR 84,111,16384
TR 86,111,20480
v_cmp_lt_f32 vcc, s51, v120
s_cbranch_vccnz L_tramp0_53
L_back0_53:
EX 0
EX 1
EX 2
EX 3
EX 4
EX 5
EX 6
EX 7
CV 96,0
CV 97,2
CV 98,4
CV 99,6
WB 6
s_barrier
MM 8,56,96
s_mov_b32 s48, 458752
s_add_u32 m0, s41, 57344
KR 56,100,32768
AD 0
DM 114,12,0
MM 12,60,96
KR 60,100,36864
AD 1
MM 16,64,96
KR 64,101,32768
AD 2
MM 20,68,96
KR 68,101,36864
AD 3
MM 24,72,96
KR 72,102,32768
AD 4
MM 28,76,96
KR 76,102,36864
AD 5
MM 32,80,96
KR 80,103,32768
AD 6
DM 115,12,1024
MM 36,84,96
KR 84,103,36864
AD 7
WL 4
MN 0,56,40
TR 56,104,24576
TR 58,104,28672
MN 4,60,40
s_mov_b32 s48, 475136
s_add_u32 m0, s41, 16384
TR 60,105,24576
TR 62,105,28672
DM 112,8,0
v_max3_f32 v120, v88, v89, v90
MM 0,64,44
TR 64,106,24576
TR 66,106,28672
v_max3_f32 v121, v91, v92, v93
MM 4,68,44
TR 68,107,24576
TR 70,107,28672
v_max3_f32 v120, v120, v94, v95
WL 8
MM 0,72,48
TR 72,108,24576
TR 74,108,28672
v_max_f32 v120, v120, v121
MM 4,76,48
TR 76,109,24576
TR 78,109,28672
DM 113,8,1024
MM 0,80,52
TR 80,110,24576
TR 82,110,28672
MM 4,84,52
WL 12
TR 84,111,24576
TR 86,111,28672
v_cmp_lt_f32 vcc, s51, v120
s_cbranch_vccnz L_tramp0_54
L_back0_54:
EX 88
EX 89
EX 90
EX 91
EX 92
EX 93
EX 94
EX 95
CV 96,88
CV 97,90
CV 98,92
CV 99,94
WB 6
s_barrier
MM 8,56,96
s_mov_b32 s48, 466944
s_add_u32 m0, s41, 65536
KR 56,100,0
AD 88
DM 114,12,0
MM 12,60,96
KR 60,100,4096
AD 89
MM 16,64,96
KR 64,101,0
AD 90
MM 20,68,96
KR 68,101,4096
AD 91
MM 24,72,96
KR 72,102,0
AD 92
MM 28,76,96
KR 76,102,4096
AD 93
MM 32,80,96
KR 80,103,0
AD 94
DM 115,12,1024
MM 36,84,96
KR 84,103,4096
AD 95
WL 4
MN 88,56,40
TR 56,104,32768
TR 58,104,36864
MN 92,60,40
s_mov_b32 s48, 483328
s_add_u32 m0, s41, 24576
TR 60,105,32768
TR 62,105,36864
DM 112,8,0
v_max3_f32 v120, v0, v1, v2
MM 88,64,44
TR 64,106,32768
TR 66,106,36864
v_max3_f32 v121, v3, v4, v5
MM 92,68,44
TR 68,107,32768
TR 70,107,36864
v_max3_f32 v120, v120, v6, v7
WL 8
MM 88,72,48
TR 72,108,32768
TR 74,108,36864
v_max_f32 v120, v120, v121
MM 92,76,48
TR 76,109,32768
TR 78,109,36864
DM 113,8,1024
MM 88,80,52
TR 80,110,32768
TR 82,110,36864
MM 92,84,52
WL 12
TR 84,111,32768
TR 86,111,36864
v_cmp_lt_f32 vcc, s51, v120
s_cbranch_vccnz L_tramp0_55
L_back0_55:
EX 0
EX 1
EX 2
EX 3
EX 4
EX 5
EX 6
EX 7
CV 96,0
CV 97,2
CV 98,4
CV 99,6
WB 6
s_barrier
MM 8,56,96
s_mov_b32 s48, 475136
s_add_u32 m0, s41, 73728
KR 56,100,8192
AD 0
DM 114,12,0
MM 12,60,96
KR 60,100,12288
AD 1
MM 16,64,96
KR 64,101,8192
AD 2
MM 20,68,96
KR 68,101,12288
AD 3
MM 24,72,96
KR 72,102,8192
AD 4
MM 28,76,96
KR 76,102,12288
AD 5
MM 32,80,96
KR 80,103,8192
AD 6
DM 115,12,1024
MM 36,84,96
KR 84,103,12288
AD 7
WL 4
MN 0,56,40
TR 56,104,0
TR 58,104,4096
MN 4,60,40
s_mov_b32 s48, 491520
s_add_u32 m0, s41, 32768
TR 60,105,0
TR 62,105,4096
DM 112,8,0
v_max3_f32 v120, v88, v89, v90
MM 0,64,44
TR 64,106,0
TR 66,106,4096
v_max3_f32 v121, v91, v92, v93
MM 4,68,44
TR 68,107,0
TR 70,107,4096
v_max3_f32 v120, v120, v94, v95
WL 8
MM 0,72,48
TR 72,108,0
TR 74,108,4096
v_max_f32 v120, v120, v121
MM 4,76,48
TR 76,109,0
TR 78,109,4096
DM 113,8,1024
MM 0,80,52
TR 80,110,0
TR 82,110,4096
MM 4,84,52
WL 12
TR 84,111,0
TR 86,111,4096
v_cmp_lt_f32 vcc, s51, v120
s_cbranch_vccnz L_tramp0_56
L_back0_56:
EX 88
EX 89
EX 90
EX 91
EX 92
EX 93
EX 94
EX 95
CV 96,88
CV 97,90
CV 98,92
CV 99,94
WB 6
s_barrier
MM 8,56,96
s_mov_b32 s48, 483328
s_add_u32 m0, s41, 81920
KR 56,100,16384
AD 88
DM 114,12,0
MM 12,60,96
KR 60,100,20480
AD 89
MM 16,64,96
KR 64,101,16384
AD 90
MM 20,68,96
KR 68,101,20480
AD 91
MM 24,72,96
KR 72,102,16384
AD 92
MM 28,76,96
KR 76,102,20480
AD 93
MM 32,80,96
KR 80,103,16384
AD 94
DM 115,12,1024
MM 36,84,96
KR 84,103,20480
AD 95
WL 4
MN 88,56,40
TR 56,104,8192
TR 58,104,12288
MN 92,60,40
s_mov_b32 s48, 499712
s_add_u32 m0, s41, 0
TR 60,105,8192
TR 62,105,12288
DM 112,8,0
v_max3_f32 v120, v0, v1, v2
MM 88,64,44
TR 64,106,8192
TR 66,106,12288
v_max3_f32 v121, v3, v4, v5
MM 92,68,44
TR 68,107,8192
TR 70,107,12288
v_max3_f32 v120, v120, v6, v7
WL 8
MM 88,72,48
TR 72,108,8192
TR 74,108,12288
v_max_f32 v120, v120, v121
MM 92,76,48
TR 76,109,8192
TR 78,109,12288
DM 113,8,1024
MM 88,80,52
TR 80,110,8192
TR 82,110,12288
MM 92,84,52
WL 12
TR 84,111,8192
TR 86,111,12288
v_cmp_lt_f32 vcc, s51, v120
s_cbranch_vccnz L_tramp0_57
L_back0_57:
EX 0
EX 1
EX 2
EX 3
EX 4
EX 5
EX 6
EX 7
CV 96,0
CV 97,2
CV 98,4
CV 99,6
WB 6
s_barrier
MM 8,56,96
s_mov_b32 s48, 491520
s_add_u32 m0, s41, 90112
KR 56,100,24576
AD 0
DM 114,12,0
MM 12,60,96
KR 60,100,28672
AD 1
MM 16,64,96
KR 64,101,24576
AD 2
MM 20,68,96
KR 68,101,28672
AD 3
MM 24,72,96
KR 72,102,24576
AD 4
MM 28,76,96
KR 76,102,28672
AD 5
MM 32,80,96
KR 80,103,24576
AD 6
DM 115,12,1024
MM 36,84,96
KR 84,103,28672
AD 7
WL 4
MN 0,56,40
TR 56,104,16384
TR 58,104,20480
MN 4,60,40
s_mov_b32 s48, 507904
s_add_u32 m0, s41, 8192
TR 60,105,16384
TR 62,105,20480
DM 112,8,0
v_max3_f32 v120, v88, v89, v90
MM 0,64,44
TR 64,106,16384
TR 66,106,20480
v_max3_f32 v121, v91, v92, v93
MM 4,68,44
TR 68,107,16384
TR 70,107,20480
v_max3_f32 v120, v120, v94, v95
WL 8
MM 0,72,48
TR 72,108,16384
TR 74,108,20480
v_max_f32 v120, v120, v121
MM 4,76,48
TR 76,109,16384
TR 78,109,20480
DM 113,8,1024
MM 0,80,52
TR 80,110,16384
TR 82,110,20480
MM 4,84,52
WL 12
TR 84,111,16384
TR 86,111,20480
v_cmp_lt_f32 vcc, s51, v120
s_cbranch_vccnz L_tramp0_58
L_back0_58:
EX 88
EX 89
EX 90
EX 91
EX 92
EX 93
EX 94
EX 95
CV 96,88
CV 97,90
CV 98,92
CV 99,94
WB 6
s_barrier
MM 8,56,96
s_mov_b32 s48, 499712
s_add_u32 m0, s41, 57344
KR 56,100,32768
AD 88
DM 114,12,0
MM 12,60,96
KR 60,100,36864
AD 89
MM 16,64,96
KR 64,101,32768
AD 90
MM 20,68,96
KR 68,101,36864
AD 91
MM 24,72,96
KR 72,102,32768
AD 92
MM 28,76,96
KR 76,102,36864
AD 93
MM 32,80,96
KR 80,103,32768
AD 94
DM 115,12,1024
MM 36,84,96
KR 84,103,36864
AD 95
WL 4
MN 88,56,40
TR 56,104,24576
TR 58,104,28672
MN 92,60,40
s_mov_b32 s48, 516096
s_add_u32 m0, s41, 16384
TR 60,105,24576
TR 62,105,28672
DM 112,8,0
v_max3_f32 v120, v0, v1, v2
MM 88,64,44
TR 64,106,24576
TR 66,106,28672
v_max3_f32 v121, v3, v4, v5
MM 92,68,44
TR 68,107,24576
TR 70,107,28672
v_max3_f32 v120, v120, v6, v7
WL 8
MM 88,72,48
TR 72,108,24576
TR 74,108,28672
v_max_f32 v120, v120, v121
MM 92,76,48
TR 76,109,24576
TR 78,109,28672
DM 113,8,1024
MM 88,80,52
TR 80,110,24576
TR 82,110,28672
MM 92,84,52
WL 12
TR 84,111,24576
TR 86,111,28672
v_cmp_lt_f32 vcc, s51, v120
s_cbranch_vccnz L_tramp0_59
L_back0_59:
EX 0
EX 1
EX 2
EX 3
EX 4
EX 5
EX 6
EX 7
CV 96,0
CV 97,2
CV 98,4
CV 99,6
WB 6
s_barrier
s_mov_b32 s48, 507904
s_add_u32 m0, s41, 65536
s_nop 0
DM 114,12,0
DM 115,12,1024
s_mov_b32 s48, 516096
s_add_u32 m0, s41, 73728
s_nop 0
DM 114,12,0
DM 115,12,1024
MM 8,56,96
KR 56,100,0
AD 0
MM 12,60,96
KR 60,100,4096
AD 1
MM 16,64,96
KR 64,101,0
AD 2
MM 20,68,96
KR 68,101,4096
AD 3
MM 24,72,96
KR 72,102,0
AD 4
MM 28,76,96
KR 76,102,4096
AD 5
MM 32,80,96
KR 80,103,0
AD 6
MM 36,84,96
KR 84,103,4096
AD 7
s_add_u32 s43, s52, 393216
s_and_b32 s43, s43, 0x7ffff
s_add_u32 m0, s42, 114688
s_nop 0
DH 116,24,0
s_add_u32 s43, s43, 3072
DH 117,24,1024
s_add_u32 s43, s43, 3072
DH 116,24,2048
s_add_u32 s43, s43, 3072
DH 117,24,3072
s_add_u32 s43, s52, 409600
s_and_b32 s43, s43, 0x7ffff
s_add_u32 m0, s42, 131072
s_nop 0
DH 116,24,0
s_add_u32 s43, s43, 3072
DH 117,24,1024
s_add_u32 s43, s43, 3072
DH 116,24,2048
s_add_u32 s43, s43, 3072
DH 117,24,3072
s_add_u32 s43, s52, 425984
s_and_b32 s43, s43, 0x7ffff
s_add_u32 m0, s42, 147456
s_nop 0
DH 116,24,0
s_add_u32 s43, s43, 3072
DH 117,24,1024
s_add_u32 s43, s43, 3072
DH 116,24,2048
s_add_u32 s43, s43, 3072
DH 117,24,3072
s_add_u32 s43, s52, 442368
s_and_b32 s43, s43, 0x7ffff
s_add_u32 m0, s42, 98304
s_nop 0
DH 116,24,0
s_add_u32 s43, s43, 3072
DH 117,24,1024
s_add_u32 s43, s43, 3072
DH 116,24,2048
s_add_u32 s43, s43, 3072
DH 117,24,3072
WL 4
MN 0,56,40
TR 56,104,32768
TR 58,104,36864
MN 4,60,40
TR 60,105,32768
TR 62,105,36864
v_max3_f32 v120, v88, v89, v90
MM 0,64,44
TR 64,106,32768
TR 66,106,36864
v_max3_f32 v121, v91, v92, v93
MM 4,68,44
TR 68,107,32768
TR 70,107,36864
v_max3_f32 v120, v120, v94, v95
WL 8
MM 0,72,48
TR 72,108,32768
TR 74,108,36864
v_max_f32 v120, v120, v121
MM 4,76,48
TR 76,109,32768
TR 78,109,36864
MM 0,80,52
TR 80,110,32768
TR 82,110,36864
MM 4,84,52
WL 12
TR 84,111,32768
TR 86,111,36864
v_cmp_lt_f32 vcc, s51, v120
s_cbranch_vccnz L_tramp0_60
L_back0_60:
EX 88
EX 89
EX 90
EX 91
EX 92
EX 93
EX 94
EX 95
CV 96,88
CV 97,90
CV 98,92
CV 99,94
WB 22
s_barrier
MM 8,56,96
KR 56,100,8192
AD 88
MM 12,60,96
KR 60,100,12288
AD 89
MM 16,64,96
KR 64,101,8192
AD 90
MM 20,68,96
KR 68,101,12288
AD 91
MM 24,72,96
KR 72,102,8192
AD 92
MM 28,76,96
KR 76,102,12288
AD 93
MM 32,80,96
KR 80,103,8192
AD 94
MM 36,84,96
KR 84,103,12288
AD 95
s_add_u32 s43, s52, 458752
s_and_b32 s43, s43, 0x7ffff
s_add_u32 m0, s42, 32768
s_nop 0
DH 116,24,0
s_add_u32 s43, s43, 3072
DH 117,24,1024
s_add_u32 s43, s43, 3072
DH 116,24,2048
s_add_u32 s43, s43, 3072
DH 117,24,3072
s_add_u32 s43, s52, 475136
s_and_b32 s43, s43, 0x7ffff
s_add_u32 m0, s42, 81920
s_nop 0
DH 116,24,0
s_add_u32 s43, s43, 3072
DH 117,24,1024
s_add_u32 s43, s43, 3072
DH 116,24,2048
s_add_u32 s43, s43, 3072
DH 117,24,3072
WL 4
MN 88,56,40
TR 56,104,0
TR 58,104,4096
MN 92,60,40
TR 60,105,0
TR 62,105,4096
v_max3_f32 v120, v0, v1, v2
MM 88,64,44
TR 64,106,0
TR 66,106,4096
v_max3_f32 v121, v3, v4, v5
MM 92,68,44
TR 68,107,0
TR 70,107,4096
v_max3_f32 v120, v120, v6, v7
WL 8
MM 88,72,48
TR 72,108,0
TR 74,108,4096
v_max_f32 v120, v120, v121
MM 92,76,48
TR 76,109,0
TR 78,109,4096
MM 88,80,52
TR 80,110,0
TR 82,110,4096
MM 92,84,52
WL 12
TR 84,111,0
TR 86,111,4096
v_cmp_lt_f32 vcc, s51, v120
s_cbranch_vccnz L_tramp0_61
L_back0_61:
EX 0
EX 1
EX 2
EX 3
EX 4
EX 5
EX 6
EX 7
CV 96,0
CV 97,2
CV 98,4
CV 99,6
WB 26
s_barrier
MM 8,56,96
KR 56,100,16384
AD 0
MM 12,60,96
KR 60,100,20480
AD 1
MM 16,64,96
KR 64,101,16384
AD 2
MM 20,68,96
KR 68,101,20480
AD 3
MM 24,72,96
KR 72,102,16384
AD 4
MM 28,76,96
KR 76,102,20480
AD 5
MM 32,80,96
KR 80,103,16384
AD 6
MM 36,84,96
KR 84,103,20480
AD 7
s_add_u32 s43, s52, 491520
s_and_b32 s43, s43, 0x7ffff
s_add_u32 m0, s42, 49152
s_nop 0
DH 116,24,0
s_add_u32 s43, s43, 3072
DH 117,24,1024
s_add_u32 s43, s43, 3072
DH 116,24,2048
s_add_u32 s43, s43, 3072
DH 117,24,3072
s_add_u32 s43, s52, 507904
s_and_b32 s43, s43, 0x7ffff
s_add_u32 m0, s42, 0
s_nop 0
DH 116,24,0
s_add_u32 s43, s43, 3072
DH 117,24,1024
s_add_u32 s43, s43, 3072
DH 116,24,2048
s_add_u32 s43, s43, 3072
DH 117,24,3072
WL 4
MN 0,56,40
TR 56,104,8192
TR 58,104,12288
MN 4,60,40
TR 60,105,8192
TR 62,105,12288
v_max3_f32 v120, v88, v89, v90
MM 0,64,44
TR 64,106,8192
TR 66,106,12288
v_max3_f32 v121, v91, v92, v93
MM 4,68,44
TR 68,107,8192
TR 70,107,12288
v_max3_f32 v120, v120, v94, v95
WL 8
MM 0,72,48
TR 72,108,8192
TR 74,108,12288
v_max_f32 v120, v120, v121
MM 4,76,48
TR 76,109,8192
TR 78,109,12288
MM 0,80,52
TR 80,110,8192
TR 82,110,12288
MM 4,84,52
WL 12
TR 84,111,8192
TR 86,111,12288
v_cmp_lt_f32 vcc, s51, v120
s_cbranch_vccnz L_tramp0_62
L_back0_62:
EX 88
EX 89
EX 90
EX 91
EX 92
EX 93
EX 94
EX 95
CV 96,88
CV 97,90
CV 98,92
CV 99,94
WL 0
s_nop 0
MM 8,56,96
AD 88
MM 12,60,96
AD 89
MM 16,64,96
AD 90
MM 20,68,96
AD 91
MM 24,72,96
AD 92
MM 28,76,96
AD 93
MM 32,80,96
AD 94
MM 36,84,96
AD 95
v_max3_f32 v120, v0, v1, v2
v_max3_f32 v121, v3, v4, v5
v_max3_f32 v120, v120, v6, v7
v_max_f32 v120, v120, v121
v_cmp_lt_f32 vcc, s51, v120
s_cbranch_vccnz L_tramp0_63
L_back0_63:
EX 0
EX 1
EX 2
EX 3
EX 4
EX 5
EX 6
EX 7
AD 0
AD 1
AD 2
AD 3
AD 4
AD 5
AD 6
AD 7
v_mov_b32 v121, v119
s_nop 1
v_permlane32_swap_b32 v119, v121
AD 121
v_mov_b32 v121, v119
s_nop 1
v_permlane16_swap_b32 v119, v121
AD 121
v_rcp_f32 v119, v119
v_add_u32 v112, s66, v118
v_add_u32 v113, s67, v118
v_add_u32 v114, s68, v118
v_add_u32 v115, s69, v118
v_mov_b32 v124, v118
v_pk_mul_f32 v[0:1], v[0:1], v[118:119] op_sel:[0,1] op_sel_hi:[1,1]
v_pk_mul_f32 v[2:3], v[2:3], v[118:119] op_sel:[0,1] op_sel_hi:[1,1]
v_pk_mul_f32 v[4:5], v[4:5], v[118:119] op_sel:[0,1] op_sel_hi:[1,1]
v_pk_mul_f32 v[6:7], v[6:7], v[118:119] op_sel:[0,1] op_sel_hi:[1,1]
CV 96,0
CV 97,2
CV 98,4
CV 99,6
v_pk_mul_f32 v[8:9], v[8:9], v[118:119] op_sel:[0,1] op_sel_hi:[1,1]
v_pk_mul_f32 v[10:11], v[10:11], v[118:119] op_sel:[0,1] op_sel_hi:[1,1]
v_pk_mul_f32 v[12:13], v[12:13], v[118:119] op_sel:[0,1] op_sel_hi:[1,1]
v_pk_mul_f32 v[14:15], v[14:15], v[118:119] op_sel:[0,1] op_sel_hi:[1,1]
v_pk_mul_f32 v[16:17], v[16:17], v[118:119] op_sel:[0,1] op_sel_hi:[1,1]
v_pk_mul_f32 v[18:19], v[18:19], v[118:119] op_sel:[0,1] op_sel_hi:[1,1]
v_pk_mul_f32 v[20:21], v[20:21], v[118:119] op_sel:[0,1] op_sel_hi:[1,1]
v_pk_mul_f32 v[22:23], v[22:23], v[118:119] op_sel:[0,1] op_sel_hi:[1,1]
v_pk_mul_f32 v[24:25], v[24:25], v[118:119] op_sel:[0,1] op_sel_hi:[1,1]
v_pk_mul_f32 v[26:27], v[26:27], v[118:119] op_sel:[0,1] op_sel_hi:[1,1]
v_pk_mul_f32 v[28:29], v[28:29], v[118:119] op_sel:[0,1] op_sel_hi:[1,1]
v_pk_mul_f32 v[30:31], v[30:31], v[118:119] op_sel:[0,1] op_sel_hi:[1,1]
v_pk_mul_f32 v[32:33], v[32:33], v[118:119] op_sel:[0,1] op_sel_hi:[1,1]
v_pk_mul_f32 v[34:35], v[34:35], v[118:119] op_sel:[0,1] op_sel_hi:[1,1]
v_pk_mul_f32 v[36:37], v[36:37], v[118:119] op_sel:[0,1] op_sel_hi:[1,1]
v_pk_mul_f32 v[38:39], v[38:39], v[118:119] op_sel:[0,1] op_sel_hi:[1,1]
WM 32
s_barrier
TR 56,104,16384
TR 58,104,20480
TR 60,105,16384
TR 62,105,20480
TR 64,106,16384
TR 66,106,20480
TR 68,107,16384
TR 70,107,20480
TR 72,108,16384
TR 74,108,20480
TR 76,109,16384
TR 78,109,20480
TR 80,110,16384
TR 82,110,20480
WL 12
TR 84,111,16384
TR 86,111,20480
MM 8,56,96
WL 12
MM 12,60,96
WL 10
MM 16,64,96
WL 8
MM 20,68,96
WL 6
MM 24,72,96
WL 4
MM 28,76,96
WL 2
MM 32,80,96
WL 0
MM 36,84,96
CV 72,8
CV 73,10
CV 74,12
CV 75,14
ds_write_b128 v112, v[72:75] offset:0
CV 76,16
CV 77,18
CV 78,20
CV 79,22
ds_write_b128 v112, v[76:79] offset:1024
CV 80,24
CV 81,26
CV 82,28
CV 83,30
ds_write_b128 v112, v[80:83] offset:2048
CV 84,32
CV 85,34
CV 86,36
CV 87,38
ds_write_b128 v112, v[84:87] offset:3072
MZ 8,128,72
v_add_u32 v104, s42, v104
MZ 12,132,72
v_add_u32 v105, s42, v105
MZ 16,136,72
v_add_u32 v106, s42, v106
MZ 20,140,72
v_add_u32 v107, s42, v107
MM 8,160,76
v_add_u32 v108, s42, v108
MM 12,164,76
v_add_u32 v109, s42, v109
MM 16,168,76
v_add_u32 v110, s42, v110
MM 20,172,76
v_add_u32 v111, s42, v111
WL 0
s_barrier
KR 40,113,0
KR 44,113,1024
KR 48,113,2048
KR 52,113,3072
KR 56,114,0
KR 60,114,1024
KR 64,114,2048
KR 68,114,3072
KR 88,115,0
KR 92,115,1024
KR 96,115,2048
KR 100,115,3072
MM 8,192,80
v_subrev_u32 v0, 57344, v104
MM 12,196,80
v_subrev_u32 v1, 57344, v105
MM 16,200,80
v_subrev_u32 v2, 57344, v106
MM 20,204,80
v_subrev_u32 v3, 57344, v107
MM 8,224,84
v_subrev_u32 v4, 57344, v108
MM 12,228,84
v_subrev_u32 v5, 57344, v109
MM 16,232,84
v_subrev_u32 v6, 57344, v110
MM 20,236,84
v_subrev_u32 v7, 57344, v111
MZ 24,144,72
v_add_u32 v116, 57344, v104
MZ 28,148,72
v_add_u32 v117, 57344, v105
MZ 32,152,72
v_add_u32 v118, 57344, v106
MZ 36,156,72
v_add_u32 v119, 57344, v107
MM 24,176,76
v_add_u32 v120, 57344, v108
MM 28,180,76
v_add_u32 v121, 57344, v109
MM 32,184,76
v_add_u32 v122, 57344, v110
MM 36,188,76
v_add_u32 v123, 57344, v111
MM 24,208,80
v_mov_b32 v112, s53
MM 28,212,80
v_and_b32 v113, 0xf0, v124
v_lshlrev_b32 v113, 6, v113
MM 32,216,80
v_lshrrev_b32 v114, 8, v124
v_lshl_add_u32 v113, v114, 3, v113
MM 36,220,80
v_cmp_eq_u32 vcc, 0, v124
v_mov_b32 v114, 0x20000000
s_nop 0
v_cndmask_b32 v115, v114, 0, vcc
MM 24,240,84
s_mov_b32 s55, 0
MM 28,244,84
s_mov_b32 s56, 0
MM 32,248,84
MM 36,252,84
WL 11
MA 8,0,40
WM 28
TR 128,116,0
MA 12,4,40
TR 132,117,0
MA 16,8,40
TR 136,118,0
MA 20,12,40
WL 13
TR 140,119,0
MA 8,32,44
WM 24
WL 13
TR 130,116,16384
MA 12,36,44
WL 13
TR 134,117,16384
MA 16,40,44
WL 13
TR 138,118,16384
MA 20,44,44
WL 13
TR 142,119,16384
MA 8,64,48
WM 20
WL 13
TR 160,116,32768
MA 12,68,48
WL 13
TR 164,117,32768
MA 16,72,48
WL 13
TR 168,118,32768
MA 20,76,48
WL 13
TR 172,119,32768
MA 8,96,52
WM 16
WL 13
TR 162,104,40960
MA 12,100,52
WL 13
TR 166,105,40960
MA 16,104,52
WL 13
TR 170,106,40960
MA 20,108,52
WL 13
TR 174,107,40960
MA 8,128,56
WM 12
WL 13
TR 192,0,32768
MA 12,132,56
WL 13
TR 196,1,32768
MA 16,136,56
WL 13
TR 200,2,32768
MA 20,140,56
WL 13
TR 204,3,32768
MA 8,160,60
WM 8
WL 13
TR 194,104,24576
MA 12,164,60
WL 13
TR 198,105,24576
MA 16,168,60
WL 13
TR 202,106,24576
MA 20,172,60
WL 13
TR 206,107,24576
MA 8,192,64
WM 4
WL 13
TR 224,0,49152
MA 12,196,64
WL 13
TR 228,1,49152
MA 16,200,64
WL 13
TR 232,2,49152
MA 20,204,64
WL 13
TR 236,3,49152
MA 8,224,68
WM 0
WL 13
TR 226,0,0
MA 12,228,68
WL 13
TR 230,1,0
MA 16,232,68
WL 13
TR 234,2,0
MA 20,236,68
WL 13
TR 238,3,0
MM 8,128,88
WL 13
TR 152,122,0
MM 12,132,88
WL 13
TR 156,123,0
MM 16,136,88
WL 13
TR 154,122,16384
MM 20,140,88
WL 13
TR 158,123,16384
MM 8,160,92
WL 13
TR 184,122,32768
MM 12,164,92
WL 13
TR 188,123,32768
MM 16,168,92
WL 13
TR 186,110,40960
MM 20,172,92
WL 13
TR 190,111,40960
MM 8,192,96
WL 13
TR 216,6,32768
MM 12,196,96
WL 13
TR 220,7,32768
MM 16,200,96
WL 13
TR 218,110,24576
MM 20,204,96
WL 13
TR 222,111,24576
MM 8,224,100
WL 13
TR 248,6,49152
MM 12,228,100
WL 13
TR 252,7,49152
MM 16,232,100
WL 13
TR 250,6,0
MM 20,236,100
WL 13
TR 254,7,0
MA 32,24,40
WL 13
TR 144,120,0
MA 36,28,40
WL 13
TR 148,121,0
MA 32,56,44
WL 13
TR 146,120,16384
MA 36,60,44
WL 13
TR 150,121,16384
MA 32,88,48
WL 13
TR 176,120,32768
MA 36,92,48
WL 13
TR 180,121,32768
CV 8,8
CV 9,10
CV 10,12
v_mov_b32 v11, v112
buffer_store_dwordx4 v[8:11], v124, s[28:31], s70 offen offset:0 sc1
MA 32,120,52
WL 13
TR 178,108,40960
MA 36,124,52
WL 13
TR 182,109,40960
MA 32,152,56
WL 13
TR 208,4,32768
CV 12,14
CV 13,16
CV 14,18
v_mov_b32 v15, v112
buffer_store_dwordx4 v[12:15], v124, s[28:31], s70 offen offset:1024 sc1
MA 36,156,56
WL 13
TR 212,5,32768
MA 32,184,60
WL 13
TR 210,108,24576
MA 36,188,60
WL 13
TR 214,109,24576
CV 16,20
CV 17,22
v_mov_b32 v18, v112
v_mov_b32 v19, v112
buffer_store_dwordx4 v[16:19], v124, s[28:31], s70 offen offset:2048 sc1
MA 32,216,64
WL 13
TR 240,4,49152
MA 36,220,64
WL 13
TR 244,5,49152
MA 32,248,68
WL 13
TR 242,4,0
MA 36,252,68
WL 13
TR 246,5,0
MM 32,152,88
MM 36,156,88
MM 32,184,92
MM 36,188,92
MM 32,216,96
MM 36,220,96
MM 32,248,100
MM 36,252,100
MA 24,16,40
MA 28,20,40
MA 24,48,44
MA 28,52,44
MA 24,80,48
MA 28,84,48
s_nop 3
CV 16,36
CV 17,38
buffer_store_dwordx4 v[16:19], v124, s[28:31], s71 offen offset:2048 sc1
MA 24,112,52
MA 28,116,52
MA 24,144,56
MA 28,148,56
MA 24,176,60
MA 28,180,60
MA 24,208,64
MA 28,212,64
MA 24,240,68
MA 28,244,68
WL 13
MM 24,144,88
WL 12
MM 28,148,88
WL 9
MM 24,176,92
WL 8
MM 28,180,92
WL 5
MM 24,208,96
WL 4
MM 28,212,96
WL 1
MM 24,240,100
WL 0
MM 28,244,100
s_nop 7
CV 8,24
CV 9,26
CV 10,28
buffer_store_dwordx4 v[8:11], v124, s[28:31], s71 offen offset:0 sc1
CV 12,30
CV 13,32
CV 14,34
buffer_store_dwordx4 v[12:15], v124, s[28:31], s71 offen offset:1024 sc1
s_cmp_eq_u32 s36, 3
s_cbranch_scc1 L_fin0
L_opoll0:
s_bitcmp1_b32 s56, 0
s_cbranch_scc1 L_sk0_0
s_add_u32 s47, s72, 0
buffer_load_dwordx4 v[56:59], v124, s[28:31], s47 offen sc1
L_sk0_0:
s_bitcmp1_b32 s56, 1
s_cbranch_scc1 L_sk0_1
s_add_u32 s47, s72, 4096
buffer_load_dwordx4 v[60:63], v124, s[28:31], s47 offen sc1
L_sk0_1:
s_bitcmp1_b32 s56, 2
s_cbranch_scc1 L_sk0_2
s_add_u32 s47, s72, 8192
buffer_load_dwordx4 v[64:67], v124, s[28:31], s47 offen sc1
L_sk0_2:
s_bitcmp1_b32 s56, 3
s_cbranch_scc1 L_sk0_3
s_add_u32 s47, s72, 12288
buffer_load_dwordx4 v[68:71], v124, s[28:31], s47 offen sc1
L_sk0_3:
s_bitcmp1_b32 s56, 4
s_cbranch_scc1 L_sk0_4
s_add_u32 s47, s72, 16384
buffer_load_dwordx4 v[72:75], v124, s[28:31], s47 offen sc1
L_sk0_4:
s_bitcmp1_b32 s56, 5
s_cbranch_scc1 L_sk0_5
s_add_u32 s47, s72, 20480
buffer_load_dwordx4 v[76:79], v124, s[28:31], s47 offen sc1
L_sk0_5:
s_bitcmp1_b32 s56, 6
s_cbranch_scc1 L_sk0_6
s_add_u32 s47, s72, 24576
buffer_load_dwordx4 v[80:83], v124, s[28:31], s47 offen sc1
L_sk0_6:
s_bitcmp1_b32 s56, 7
s_cbranch_scc1 L_sk0_7
s_add_u32 s47, s72, 28672
buffer_load_dwordx4 v[84:87], v124, s[28:31], s47 offen sc1
L_sk0_7:
WM 0
L_chk0:
v_cmp_ne_u32 vcc, s53, v59
s_cbranch_vccnz L_sc0_0
s_bitset1_b32 s56, 0
L_sc0_0:
v_cmp_ne_u32 vcc, s53, v63
s_cbranch_vccnz L_sc0_1
s_bitset1_b32 s56, 1
L_sc0_1:
v_cmp_ne_u32 vcc, s53, v67
s_cbranch_vccnz L_sc0_2
s_bitset1_b32 s56, 2
L_sc0_2:
v_cmp_ne_u32 vcc, s53, v71
s_cbranch_vccnz L_sc0_3
s_bitset1_b32 s56, 3
L_sc0_3:
v_cmp_ne_u32 vcc, s53, v75
s_cbranch_vccnz L_sc0_4
s_bitset1_b32 s56, 4
L_sc0_4:
v_cmp_ne_u32 vcc, s53, v79
s_cbranch_vccnz L_sc0_5
s_bitset1_b32 s56, 5
L_sc0_5:
v_cmp_ne_u32 vcc, s53, v83
s_cbranch_vccnz L_sc0_6
s_bitset1_b32 s56, 6
L_sc0_6:
v_cmp_ne_u32 vcc, s53, v87
s_cbranch_vccnz L_sc0_7
s_bitset1_b32 s56, 7
L_sc0_7:
s_cmp_lg_u32 s56, 0xff
s_cbranch_scc1 L_oretry0
L_ook0:
v_lshlrev_b32 v8, 16, v56
v_and_b32 v9, 0xffff0000, v56
v_lshlrev_b32 v18, 16, v60
v_and_b32 v19, 0xffff0000, v60
v_pk_add_f32 v[8:9], v[8:9], v[18:19]
v_lshlrev_b32 v16, 16, v64
v_and_b32 v17, 0xffff0000, v64
v_pk_add_f32 v[8:9], v[8:9], v[16:17]
v_lshlrev_b32 v18, 16, v68
v_and_b32 v19, 0xffff0000, v68
v_pk_add_f32 v[8:9], v[8:9], v[18:19]
v_lshlrev_b32 v16, 16, v72
v_and_b32 v17, 0xffff0000, v72
v_pk_add_f32 v[8:9], v[8:9], v[16:17]
v_lshlrev_b32 v18, 16, v76
v_and_b32 v19, 0xffff0000, v76
v_pk_add_f32 v[8:9], v[8:9], v[18:19]
v_lshlrev_b32 v16, 16, v80
v_and_b32 v17, 0xffff0000, v80
v_pk_add_f32 v[8:9], v[8:9], v[16:17]
v_lshlrev_b32 v18, 16, v84
v_and_b32 v19, 0xffff0000, v84
v_pk_add_f32 v[8:9], v[8:9], v[18:19]
CV 88,8
buffer_store_dword v88, v113, s[32:35], s73 offen
v_lshlrev_b32 v10, 16, v57
v_and_b32 v11, 0xffff0000, v57
v_lshlrev_b32 v18, 16, v61
v_and_b32 v19, 0xffff0000, v61
v_pk_add_f32 v[10:11], v[10:11], v[18:19]
v_lshlrev_b32 v16, 16, v65
v_and_b32 v17, 0xffff0000, v65
v_pk_add_f32 v[10:11], v[10:11], v[16:17]
v_lshlrev_b32 v18, 16, v69
v_and_b32 v19, 0xffff0000, v69
v_pk_add_f32 v[10:11], v[10:11], v[18:19]
v_lshlrev_b32 v16, 16, v73
v_and_b32 v17, 0xffff0000, v73
v_pk_add_f32 v[10:11], v[10:11], v[16:17]
v_lshlrev_b32 v18, 16, v77
v_and_b32 v19, 0xffff0000, v77
v_pk_add_f32 v[10:11], v[10:11], v[18:19]
v_lshlrev_b32 v16, 16, v81
v_and_b32 v17, 0xffff0000, v81
v_pk_add_f32 v[10:11], v[10:11], v[16:17]
v_lshlrev_b32 v18, 16, v85
v_and_b32 v19, 0xffff0000, v85
v_pk_add_f32 v[10:11], v[10:11], v[18:19]
CV 89,10
buffer_store_dword v89, v113, s[32:35], s74 offen
v_lshlrev_b32 v12, 16, v58
v_and_b32 v13, 0xffff0000, v58
v_lshlrev_b32 v18, 16, v62
v_and_b32 v19, 0xffff0000, v62
v_pk_add_f32 v[12:13], v[12:13], v[18:19]
v_lshlrev_b32 v16, 16, v66
v_and_b32 v17, 0xffff0000, v66
v_pk_add_f32 v[12:13], v[12:13], v[16:17]
v_lshlrev_b32 v18, 16, v70
v_and_b32 v19, 0xffff0000, v70
v_pk_add_f32 v[12:13], v[12:13], v[18:19]
v_lshlrev_b32 v16, 16, v74
v_and_b32 v17, 0xffff0000, v74
v_pk_add_f32 v[12:13], v[12:13], v[16:17]
v_lshlrev_b32 v18, 16, v78
v_and_b32 v19, 0xffff0000, v78
v_pk_add_f32 v[12:13], v[12:13], v[18:19]
v_lshlrev_b32 v16, 16, v82
v_and_b32 v17, 0xffff0000, v82
v_pk_add_f32 v[12:13], v[12:13], v[16:17]
v_lshlrev_b32 v18, 16, v86
v_and_b32 v19, 0xffff0000, v86
v_pk_add_f32 v[12:13], v[12:13], v[18:19]
CV 90,12
buffer_store_dword v90, v113, s[32:35], s75 offen
s_or_b32 s43, s37, s36
s_cmp_eq_u32 s43, 0
s_cselect_b32 s43, s57, 0x20000000
s_add_u32 s44, s49, 1
v_mov_b32 v114, s44
buffer_store_dword v114, v115, s[28:31], s43 offen sc1
L_fin0:
s_endpgm
L_oretry0:
s_add_u32 s55, s55, 1
s_cmp_gt_u32 s55, 0x40000
s_cbranch_scc1 L_ook0
s_branch L_opoll0
L_tramp0_1:
s_swappc_b64 s[60:61], s[64:65]
s_branch L_back0_1
L_tramp0_2:
s_swappc_b64 s[60:61], s[58:59]
s_branch L_back0_2
L_tramp0_3:
s_swappc_b64 s[60:61], s[64:65]
s_branch L_back0_3
L_tramp0_4:
s_swappc_b64 s[60:61], s[58:59]
s_branch L_back0_4
L_tramp0_5:
s_swappc_b64 s[60:61], s[64:65]
s_branch L_back0_5
L_tramp0_6:
s_swappc_b64 s[60:61], s[58:59]
s_branch L_back0_6
L_tramp0_7:
s_swappc_b64 s[60:61], s[64:65]
s_branch L_back0_7
L_tramp0_8:
s_swappc_b64 s[60:61], s[58:59]
s_branch L_back0_8
L_tramp0_9:
s_swappc_b64 s[60:61], s[64:65]
s_branch L_back0_9
L_tramp0_10:
s_swappc_b64 s[60:61], s[58:59]
s_branch L_back0_10
L_tramp0_11:
s_swappc_b64 s[60:61], s[64:65]
s_branch L_back0_11
L_tramp0_12:
s_swappc_b64 s[60:61], s[58:59]
s_branch L_back0_12
L_tramp0_13:
s_swappc_b64 s[60:61], s[64:65]
s_branch L_back0_13
L_tramp0_14:
s_swappc_b64 s[60:61], s[58:59]
s_branch L_back0_14
L_tramp0_15:
s_swappc_b64 s[60:61], s[64:65]
s_branch L_back0_15
L_tramp0_16:
s_swappc_b64 s[60:61], s[58:59]
s_branch L_back0_16
L_tramp0_17:
s_swappc_b64 s[60:61], s[64:65]
s_branch L_back0_17
L_tramp0_18:
s_swappc_b64 s[60:61], s[58:59]
s_branch L_back0_18
L_tramp0_19:
s_swappc_b64 s[60:61], s[64:65]
s_branch L_back0_19
L_tramp0_20:
s_swappc_b64 s[60:61], s[58:59]
s_branch L_back0_20
L_tramp0_21:
s_swappc_b64 s[60:61], s[64:65]
s_branch L_back0_21
L_tramp0_22:
s_swappc_b64 s[60:61], s[58:59]
s_branch L_back0_22
L_tramp0_23:
s_swappc_b64 s[60:61], s[64:65]
s_branch L_back0_23
L_tramp0_24:
s_swappc_b64 s[60:61], s[58:59]
s_branch L_back0_24
L_tramp0_25:
s_swappc_b64 s[60:61], s[64:65]
s_branch L_back0_25
L_tramp0_26:
s_swappc_b64 s[60:61], s[58:59]
s_branch L_back0_26
L_tramp0_27:
s_swappc_b64 s[60:61], s[64:65]
s_branch L_back0_27
L_tramp0_28:
s_swappc_b64 s[60:61], s[58:59]
s_branch L_back0_28
L_tramp0_29:
s_swappc_b64 s[60:61], s[64:65]
s_branch L_back0_29
L_tramp0_30:
s_swappc_b64 s[60:61], s[58:59]
s_branch L_back0_30
L_tramp0_31:
s_swappc_b64 s[60:61], s[64:65]
s_branch L_back0_31
L_tramp0_32:
s_swappc_b64 s[60:61], s[58:59]
s_branch L_back0_32
L_tramp0_33:
s_swappc_b64 s[60:61], s[64:65]
s_branch L_back0_33
L_tramp0_34:
s_swappc_b64 s[60:61], s[58:59]
s_branch L_back0_34
L_tramp0_35:
s_swappc_b64 s[60:61], s[64:65]
s_branch L_back0_35
L_tramp0_36:
s_swappc_b64 s[60:61], s[58:59]
s_branch L_back0_36
L_tramp0_37:
s_swappc_b64 s[60:61], s[64:65]
s_branch L_back0_37
L_tramp0_38:
s_swappc_b64 s[60:61], s[58:59]
s_branch L_back0_38
L_tramp0_39:
s_swappc_b64 s[60:61], s[64:65]
s_branch L_back0_39
L_tramp0_40:
s_swappc_b64 s[60:61], s[58:59]
s_branch L_back0_40
L_tramp0_41:
s_swappc_b64 s[60:61], s[64:65]
s_branch L_back0_41
L_tramp0_42:
s_swappc_b64 s[60:61], s[58:59]
s_branch L_back0_42
L_tramp0_43:
s_swappc_b64 s[60:61], s[64:65]
s_branch L_back0_43
L_tramp0_44:
s_swappc_b64 s[60:61], s[58:59]
s_branch L_back0_44
L_tramp0_45:
s_swappc_b64 s[60:61], s[64:65]
s_branch L_back0_45
L_tramp0_46:
s_swappc_b64 s[60:61], s[58:59]
s_branch L_back0_46
L_tramp0_47:
s_swappc_b64 s[60:61], s[64:65]
s_branch L_back0_47
L_tramp0_48:
s_swappc_b64 s[60:61], s[58:59]
s_branch L_back0_48
L_tramp0_49:
s_swappc_b64 s[60:61], s[64:65]
s_branch L_back0_49
L_tramp0_50:
s_swappc_b64 s[60:61], s[58:59]
s_branch L_back0_50
L_tramp0_51:
s_swappc_b64 s[60:61], s[64:65]
s_branch L_back0_51
L_tramp0_52:
s_swappc_b64 s[60:61], s[58:59]
s_branch L_back0_52
L_tramp0_53:
s_swappc_b64 s[60:61], s[64:65]
s_branch L_back0_53
L_tramp0_54:
s_swappc_b64 s[60:61], s[58:59]
s_branch L_back0_54
L_tramp0_55:
s_swappc_b64 s[60:61], s[64:65]
s_branch L_back0_55
L_tramp0_56:
s_swappc_b64 s[60:61], s[58:59]
s_branch L_back0_56
L_tramp0_57:
s_swappc_b64 s[60:61], s[64:65]
s_branch L_back0_57
L_tramp0_58:
s_swappc_b64 s[60:61], s[58:59]
s_branch L_back0_58
L_tramp0_59:
s_swappc_b64 s[60:61], s[64:65]
s_branch L_back0_59
L_tramp0_60:
s_swappc_b64 s[60:61], s[58:59]
s_branch L_back0_60
L_tramp0_61:
s_swappc_b64 s[60:61], s[64:65]
s_branch L_back0_61
L_tramp0_62:
s_swappc_b64 s[60:61], s[58:59]
s_branch L_back0_62
L_tramp0_63:
s_swappc_b64 s[60:61], s[64:65]
s_branch L_back0_63
L_btramp0_22_0:
s_swappc_b64 s[60:61], s[4:5]
s_branch L_bback0_22_0
L_btramp0_28_0:
s_swappc_b64 s[60:61], s[4:5]
s_branch L_bback0_28_0
L_btramp0_34_0:
s_swappc_b64 s[60:61], s[4:5]
s_branch L_bback0_34_0
L_role1:
s_sub_u32 s43, s38, 1
s_lshl_b32 s43, s43, 17
s_mul_i32 s44, s36, 32512
s_add_u32 s43, s43, s44
v_bfe_u32 v20, v0, 3, 2
v_and_b32 v21, 7, v0
v_lshlrev_b32 v21, 7, v21
v_lshl_add_u32 v20, v20, 13, v21
buffer_load_dword v23, v20, s[16:19], s43 offen
s_getpc_b64 s[60:61]
L_pcp1:
s_sub_u32 s60, s60, L_pcp1-standalone__gqa_block_cached__sampling_kernel
s_subb_u32 s61, s61, 0
s_mov_b32 s62, L_codeend-standalone__gqa_block_cached__sampling_kernel
s_mov_b32 s63, 0x20000
s_lshl_b32 s43, s38, 2
s_add_u32 s43, s43, s36
s_lshl_b32 s43, s43, 11
v_lshlrev_b32 v8, 7, v2
buffer_load_dword v9, v8, s[60:63], s43 offen
s_add_u32 m0, s42, 147456
s_nop 0
buffer_load_dwordx4 v226, s[20:23], s42 offen offset:0  lds
buffer_load_dwordx4 v227, s[20:23], s42 offen offset:1024  lds
buffer_load_dwordx4 v228, s[20:23], s42 offen offset:2048  lds
buffer_load_dwordx4 v229, s[20:23], s42 offen offset:3072  lds
s_mov_b32 s28, s78
s_mov_b32 s29, s79
s_mov_b32 s30, 0x20000000
s_mov_b32 s31, 0x20000
buffer_load_dword v6, off, s[28:31], s57 sc1
s_mov_b32 s48, 0
s_add_u32 m0, s41, 8192
s_nop 0
DM 112,8,0
DM 113,8,1024
s_mov_b32 s48, 8192
s_add_u32 m0, s41, 16384
s_nop 0
DM 112,8,0
DM 113,8,1024
s_mov_b32 s48, 0
s_add_u32 m0, s41, 65536
s_nop 0
DM 114,12,0
DM 115,12,1024
s_mov_b32 s48, 16384
s_add_u32 m0, s41, 24576
s_nop 0
DM 112,8,0
DM 113,8,1024
s_mov_b32 s48, 8192
s_add_u32 m0, s41, 73728
s_nop 0
DM 114,12,0
DM 115,12,1024
s_mov_b32 s48, 24576
s_add_u32 m0, s41, 32768
s_nop 0
DM 112,8,0
DM 113,8,1024
s_lshl_b32 s43, s37, 19
s_lshl_b32 s44, s36, 8
s_add_u32 s43, s43, s44
s_add_u32 s24, s72, s43
s_addc_u32 s25, s73, 0
s_mov_b32 s26, 523520
s_mov_b32 s27, 0x20000
s_xor_b32 s43, s38, 0
s_lshl_b32 s43, s43, 14
s_mul_i32 s44, s36, 3840
s_add_u32 s43, s43, s44
v_and_b32 v14, 0x1f0, v118
v_lshlrev_b32 v14, 3, v14
buffer_load_dword v15, v14, s[24:27], s43 offen
s_lshl_b32 s43, s38, 14
s_add_u32 s32, s74, s43
s_addc_u32 s33, s75, 0
s_mov_b32 s34, 16384
s_mov_b32 s35, 0x20000
s_mov_b32 s50, 0x3e0293ee
s_mov_b32 s51, 0x41000000
s_mov_b32 s54, 0xfffffc00
s_getpc_b64 s[58:59]
L_pc1:
s_add_u32 s4, s58, L_burst-L_pc1
s_addc_u32 s5, s59, 0
s_add_u32 s64, s58, L_slow1-L_pc1
s_addc_u32 s65, s59, 0
s_add_u32 s58, s58, L_slow0-L_pc1
s_addc_u32 s59, s59, 0
s_lshl_b32 s52, s36, 17
s_add_u32 s52, s52, 262144
s_add_u32 s43, s36, 0
s_and_b32 s44, s43, 1
s_lshl_b32 s44, s44, 12
s_bitcmp1_b32 s43, 1
s_cselect_b32 s43, 40960, 0
s_add_u32 s43, s43, s44
s_add_u32 s66, s43, 24576
s_add_u32 s43, s36, 2
s_and_b32 s44, s43, 1
s_lshl_b32 s44, s44, 12
s_bitcmp1_b32 s43, 1
s_cselect_b32 s43, 40960, 0
s_add_u32 s43, s43, s44
s_add_u32 s67, s43, 24576
s_add_u32 s43, s36, 3
s_and_b32 s44, s43, 1
s_lshl_b32 s44, s44, 12
s_bitcmp1_b32 s43, 1
s_cselect_b32 s43, 40960, 0
s_add_u32 s43, s43, s44
s_add_u32 s68, s43, 24576
s_add_u32 s43, s36, 1
s_and_b32 s44, s43, 1
s_lshl_b32 s44, s44, 12
s_bitcmp1_b32 s43, 1
s_cselect_b32 s43, 40960, 0
s_add_u32 s43, s43, s44
s_add_u32 s69, s43, 24576
s_lshl_b32 s43, s38, 3
s_lshl_b32 s44, s36, 1
s_add_u32 s43, s43, s44
s_lshl_b32 s43, s43, 3
s_add_u32 s43, s43, s37
s_lshl_b32 s43, s43, 12
s_add_u32 s70, s43, 8388608
s_add_u32 s71, s70, 32768
s_lshl_b32 s72, s2, 15
s_lshl_b32 s43, s36, 10
s_add_u32 s72, s72, s43
s_add_u32 s72, s72, 8388608
s_mul_i32 s43, s36, 3
s_add_u32 s43, s43, 0
s_lshr_b32 s44, s43, 1
s_lshl_b32 s44, s44, 5
s_and_b32 s45, s43, 1
s_lshl_b32 s45, s45, 2
s_add_u32 s44, s44, s45
s_lshl_b32 s45, s37, 7
s_add_u32 s44, s44, s45
s_cmp_lt_u32 s43, 8
s_cselect_b32 s73, s44, 0x40000000
s_mul_i32 s43, s36, 3
s_add_u32 s43, s43, 1
s_lshr_b32 s44, s43, 1
s_lshl_b32 s44, s44, 5
s_and_b32 s45, s43, 1
s_lshl_b32 s45, s45, 2
s_add_u32 s44, s44, s45
s_lshl_b32 s45, s37, 7
s_add_u32 s44, s44, s45
s_cmp_lt_u32 s43, 8
s_cselect_b32 s74, s44, 0x40000000
s_mul_i32 s43, s36, 3
s_add_u32 s43, s43, 2
s_lshr_b32 s44, s43, 1
s_lshl_b32 s44, s44, 5
s_and_b32 s45, s43, 1
s_lshl_b32 s45, s45, 2
s_add_u32 s44, s44, s45
s_lshl_b32 s45, s37, 7
s_add_u32 s44, s44, s45
s_cmp_lt_u32 s43, 8
s_cselect_b32 s75, s44, 0x40000000
s_mul_i32 s3, s47, 43
s_lshr_b32 s3, s3, 7
s_mul_i32 s3, s3, 3
s_sub_u32 s3, s47, s3
v_lshlrev_b32 v18, 4, v18
v_lshl_add_u32 v100, v2, 8, v18
v_xor_b32 v101, 64, v100
v_xor_b32 v102, 128, v100
v_xor_b32 v103, 192, v100
v_and_b32 v16, 1, v1
v_lshl_add_u32 v16, v16, 2, v3
v_lshlrev_b32 v16, 5, v16
v_lshl_add_u32 v16, v4, 3, v16
v_lshl_add_u32 v17, v1, 2, v3
v_lshl_add_u32 v16, v17, 8, v16
v_add_u32 v104, 57344, v16
v_xor_b32 v105, 32, v104
v_xor_b32 v106, 64, v104
v_xor_b32 v107, 96, v104
v_xor_b32 v108, 128, v104
v_xor_b32 v109, 160, v104
v_xor_b32 v110, 192, v104
v_xor_b32 v111, 224, v104
v_lshrrev_b32 v8, 1, v1
v_xor_b32 v8, v8, v2
v_lshlrev_b32 v8, 4, v8
v_and_b32 v10, 1, v1
v_lshl_add_u32 v8, v10, 3, v8
v_lshl_add_u32 v8, v2, 10, v8
s_lshl_b32 s43, s39, 6
v_xor_b32 v8, s43, v8
v_add_u32 v11, 147456, v8
s_add_u32 s43, s42, 57344
v_add_u32 v248, s43, v104
v_add_u32 v249, s43, v105
v_add_u32 v250, s43, v106
v_add_u32 v251, s43, v107
v_add_u32 v252, s43, v108
v_add_u32 v253, s43, v109
v_add_u32 v254, s43, v110
v_add_u32 v255, s43, v111
WM 14
s_barrier
ds_read_b64 v[128:129], v11
v_xor_b32 v13, 32, v11
ds_read_b64 v[130:131], v13
v_xor_b32 v12, 64, v11
ds_read_b64 v[132:133], v12
v_xor_b32 v13, 96, v11
ds_read_b64 v[134:135], v13
v_xor_b32 v12, 128, v11
ds_read_b64 v[136:137], v12
v_xor_b32 v13, 160, v11
ds_read_b64 v[138:139], v13
v_xor_b32 v12, 192, v11
ds_read_b64 v[140:141], v12
v_xor_b32 v13, 224, v11
ds_read_b64 v[142:143], v13
v_xor_b32 v12, 256, v11
ds_read_b64 v[144:145], v12
v_xor_b32 v13, 288, v11
ds_read_b64 v[146:147], v13
v_xor_b32 v12, 320, v11
ds_read_b64 v[148:149], v12
v_xor_b32 v13, 352, v11
ds_read_b64 v[150:151], v13
v_xor_b32 v12, 384, v11
ds_read_b64 v[152:153], v12
v_xor_b32 v13, 416, v11
ds_read_b64 v[154:155], v13
v_xor_b32 v12, 448, v11
WL 8
ds_read_b64 v[156:157], v12
v_xor_b32 v13, 480, v11
ds_read_b64 v[158:159], v13
v_xor_b32 v12, 512, v11
ds_read_b64 v[160:161], v12
v_xor_b32 v13, 544, v11
ds_read_b64 v[162:163], v13
v_xor_b32 v12, 576, v11
ds_read_b64 v[164:165], v12
v_xor_b32 v13, 608, v11
ds_read_b64 v[166:167], v13
v_xor_b32 v12, 640, v11
WL 8
ds_read_b64 v[168:169], v12
v_xor_b32 v13, 672, v11
ds_read_b64 v[170:171], v13
v_xor_b32 v12, 704, v11
ds_read_b64 v[172:173], v12
v_xor_b32 v13, 736, v11
ds_read_b64 v[174:175], v13
v_xor_b32 v12, 768, v11
ds_read_b64 v[176:177], v12
v_xor_b32 v13, 800, v11
ds_read_b64 v[178:179], v13
v_xor_b32 v12, 832, v11
WL 8
ds_read_b64 v[180:181], v12
v_xor_b32 v13, 864, v11
ds_read_b64 v[182:183], v13
v_xor_b32 v12, 896, v11
ds_read_b64 v[184:185], v12
v_xor_b32 v13, 928, v11
ds_read_b64 v[186:187], v13
v_xor_b32 v12, 960, v11
ds_read_b64 v[188:189], v12
v_xor_b32 v13, 992, v11
ds_read_b64 v[190:191], v13
WL 0
s_barrier
s_mov_b32 s48, 491520
buffer_load_dwordx4 a[0:3], v112, s[8:11], s48 offen offset:0 nt
buffer_load_dwordx4 a[4:7], v113, s[8:11], s48 offen offset:1024 nt
s_mov_b32 s48, 499712
buffer_load_dwordx4 a[16:19], v112, s[8:11], s48 offen offset:0 nt
buffer_load_dwordx4 a[20:23], v113, s[8:11], s48 offen offset:1024 nt
s_mov_b32 s48, 491520
buffer_load_dwordx4 a[8:11], v114, s[12:15], s48 offen offset:0 nt
buffer_load_dwordx4 a[12:15], v115, s[12:15], s48 offen offset:1024 nt
s_mov_b32 s48, 499712
buffer_load_dwordx4 a[24:27], v114, s[12:15], s48 offen offset:0 nt
buffer_load_dwordx4 a[28:31], v115, s[12:15], s48 offen offset:1024 nt
s_mov_b32 s48, 475136
buffer_load_dwordx4 a[32:35], v112, s[8:11], s48 offen offset:0 nt
buffer_load_dwordx4 a[36:39], v113, s[8:11], s48 offen offset:1024 nt
s_mov_b32 s48, 483328
buffer_load_dwordx4 a[48:51], v112, s[8:11], s48 offen offset:0 nt
buffer_load_dwordx4 a[52:55], v113, s[8:11], s48 offen offset:1024 nt
s_mov_b32 s48, 475136
buffer_load_dwordx4 a[40:43], v114, s[12:15], s48 offen offset:0 nt
buffer_load_dwordx4 a[44:47], v115, s[12:15], s48 offen offset:1024 nt
s_mov_b32 s48, 483328
buffer_load_dwordx4 a[56:59], v114, s[12:15], s48 offen offset:0 nt
buffer_load_dwordx4 a[60:63], v115, s[12:15], s48 offen offset:1024 nt
s_mov_b32 s48, 466944
buffer_load_dwordx4 a[64:67], v112, s[8:11], s48 offen offset:0 nt
buffer_load_dwordx4 a[68:71], v113, s[8:11], s48 offen offset:1024 nt
s_mov_b32 s48, 466944
buffer_load_dwordx4 a[72:75], v114, s[12:15], s48 offen offset:0 nt
buffer_load_dwordx4 a[76:79], v115, s[12:15], s48 offen offset:1024 nt
s_xor_b32 s43, s40, 0
s_lshl_b32 s43, s43, 17
s_add_u32 m0, s42, 114688
s_nop 0
DH 224,16,0
s_add_u32 s43, s43, 31744
DH 225,16,1024
s_add_u32 s43, s43, 31744
DH 224,16,2048
s_add_u32 s43, s43, 31744
DH 225,16,3072
s_xor_b32 s43, s40, 1
s_lshl_b32 s43, s43, 17
s_add_u32 m0, s42, 131072
s_nop 0
DH 224,16,0
s_add_u32 s43, s43, 31744
DH 225,16,1024
s_add_u32 s43, s43, 31744
DH 224,16,2048
s_add_u32 s43, s43, 31744
DH 225,16,3072
s_xor_b32 s43, s40, 2
s_lshl_b32 s43, s43, 17
s_add_u32 m0, s42, 147456
s_nop 0
DH 224,16,0
s_add_u32 s43, s43, 31744
DH 225,16,1024
s_add_u32 s43, s43, 31744
DH 224,16,2048
s_add_u32 s43, s43, 31744
DH 225,16,3072
WM 8
TR 56,248,0
TR 60,249,0
TR 64,250,0
TR 68,251,0
TR 72,252,0
TR 76,253,0
TR 80,254,0
TR 84,255,0
WL 0
s_xor_b32 s43, s40, 3
s_lshl_b32 s43, s43, 17
s_add_u32 m0, s42, 114688
s_nop 0
DH 224,16,0
s_add_u32 s43, s43, 31744
DH 225,16,1024
s_add_u32 s43, s43, 31744
DH 224,16,2048
s_add_u32 s43, s43, 31744
DH 225,16,3072
WM 8
TR 58,248,16384
TR 62,249,16384
TR 66,250,16384
TR 70,251,16384
TR 74,252,16384
TR 78,253,16384
TR 82,254,16384
TR 86,255,16384
WL 0
s_xor_b32 s43, s40, 4
s_lshl_b32 s43, s43, 17
s_add_u32 m0, s42, 131072
s_nop 0
DH 224,16,0
s_add_u32 s43, s43, 31744
DH 225,16,1024
s_add_u32 s43, s43, 31744
DH 224,16,2048
s_add_u32 s43, s43, 31744
DH 225,16,3072
WM 8
TR 192,248,32768
TR 196,249,32768
TR 200,250,32768
TR 204,251,32768
TR 208,252,32768
TR 212,253,32768
TR 216,254,32768
TR 220,255,32768
WL 0
s_xor_b32 s43, s40, 5
s_lshl_b32 s43, s43, 17
s_add_u32 m0, s42, 147456
s_nop 0
DH 224,16,0
s_add_u32 s43, s43, 31744
DH 225,16,1024
s_add_u32 s43, s43, 31744
DH 224,16,2048
s_add_u32 s43, s43, 31744
DH 225,16,3072
MZ 8,56,128
MZ 12,60,128
MZ 16,64,128
MZ 20,68,128
WM 8
TR 194,248,0
TR 198,249,0
TR 202,250,0
TR 206,251,0
TR 210,252,0
TR 214,253,0
TR 218,254,0
TR 222,255,0
WL 0
s_xor_b32 s43, s40, 6
s_lshl_b32 s43, s43, 17
s_add_u32 m0, s42, 114688
s_nop 0
DH 224,16,0
s_add_u32 s43, s43, 31744
DH 225,16,1024
s_add_u32 s43, s43, 31744
DH 224,16,2048
s_add_u32 s43, s43, 31744
DH 225,16,3072
MZ 24,72,128
MZ 28,76,128
MZ 32,80,128
MZ 36,84,128
WM 8
TR 56,248,16384
TR 60,249,16384
TR 64,250,16384
TR 68,251,16384
TR 72,252,16384
TR 76,253,16384
TR 80,254,16384
TR 84,255,16384
WL 0
s_xor_b32 s43, s40, 7
s_lshl_b32 s43, s43, 17
s_add_u32 m0, s42, 131072
s_nop 0
DH 224,16,0
s_add_u32 s43, s43, 31744
DH 225,16,1024
s_add_u32 s43, s43, 31744
DH 224,16,2048
s_add_u32 s43, s43, 31744
DH 225,16,3072
MM 8,192,132
MM 12,196,132
MM 16,200,132
MM 20,204,132
v_readfirstlane_b32 s49, v6
s_nop 0
s_mul_i32 s53, s49, 0x9e3779b1
s_add_u32 s53, s53, 0x7f4a7c15
WM 8
TR 58,248,32768
TR 62,249,32768
TR 66,250,32768
TR 70,251,32768
TR 74,252,32768
TR 78,253,32768
TR 82,254,32768
TR 86,255,32768
WL 0
s_xor_b32 s43, s40, 8
s_lshl_b32 s43, s43, 17
s_add_u32 m0, s42, 147456
s_nop 0
DH 224,16,0
s_add_u32 s43, s43, 31744
DH 225,16,1024
s_add_u32 s43, s43, 31744
DH 224,16,2048
s_add_u32 s43, s43, 31744
DH 225,16,3072
MM 24,208,132
MM 28,212,132
MM 32,216,132
MM 36,220,132
WM 8
TR 192,248,0
TR 196,249,0
TR 200,250,0
TR 204,251,0
TR 208,252,0
TR 212,253,0
TR 216,254,0
TR 220,255,0
WL 0
s_xor_b32 s43, s40, 9
s_lshl_b32 s43, s43, 17
s_add_u32 m0, s42, 114688
s_nop 0
DH 224,16,0
s_add_u32 s43, s43, 31744
DH 225,16,1024
s_add_u32 s43, s43, 31744
DH 224,16,2048
s_add_u32 s43, s43, 31744
DH 225,16,3072
MM 8,56,136
MM 12,60,136
MM 16,64,136
MM 20,68,136
WM 8
TR 194,248,16384
TR 198,249,16384
TR 202,250,16384
TR 206,251,16384
TR 210,252,16384
TR 214,253,16384
TR 218,254,16384
TR 222,255,16384
WL 0
s_xor_b32 s43, s40, 10
s_lshl_b32 s43, s43, 17
s_add_u32 m0, s42, 131072
s_nop 0
DH 224,16,0
s_add_u32 s43, s43, 31744
DH 225,16,1024
s_add_u32 s43, s43, 31744
DH 224,16,2048
s_add_u32 s43, s43, 31744
DH 225,16,3072
MM 24,72,136
MM 28,76,136
MM 32,80,136
MM 36,84,136
WM 8
TR 56,248,32768
TR 60,249,32768
TR 64,250,32768
TR 68,251,32768
TR 72,252,32768
TR 76,253,32768
TR 80,254,32768
TR 84,255,32768
WL 0
s_xor_b32 s43, s40, 11
s_lshl_b32 s43, s43, 17
s_add_u32 m0, s42, 147456
s_nop 0
DH 224,16,0
s_add_u32 s43, s43, 31744
DH 225,16,1024
s_add_u32 s43, s43, 31744
DH 224,16,2048
s_add_u32 s43, s43, 31744
DH 225,16,3072
MM 8,192,140
MM 12,196,140
MM 16,200,140
MM 20,204,140
WM 8
TR 58,248,0
TR 62,249,0
TR 66,250,0
TR 70,251,0
TR 74,252,0
TR 78,253,0
TR 82,254,0
TR 86,255,0
WL 0
s_xor_b32 s43, s40, 12
s_lshl_b32 s43, s43, 17
s_add_u32 m0, s42, 114688
s_nop 0
DH 224,16,0
s_add_u32 s43, s43, 31744
DH 225,16,1024
s_add_u32 s43, s43, 31744
DH 224,16,2048
s_add_u32 s43, s43, 31744
DH 225,16,3072
MM 24,208,140
MM 28,212,140
MM 32,216,140
MM 36,220,140
WM 8
TR 192,248,16384
TR 196,249,16384
TR 200,250,16384
TR 204,251,16384
TR 208,252,16384
TR 212,253,16384
TR 216,254,16384
TR 220,255,16384
WL 0
s_xor_b32 s43, s40, 13
s_lshl_b32 s43, s43, 17
s_add_u32 m0, s42, 131072
s_nop 0
DH 224,16,0
s_add_u32 s43, s43, 31744
DH 225,16,1024
s_add_u32 s43, s43, 31744
DH 224,16,2048
s_add_u32 s43, s43, 31744
DH 225,16,3072
MM 8,56,144
MM 12,60,144
MM 16,64,144
MM 20,68,144
WM 8
TR 194,248,32768
TR 198,249,32768
TR 202,250,32768
TR 206,251,32768
TR 210,252,32768
TR 214,253,32768
TR 218,254,32768
TR 222,255,32768
WL 0
s_xor_b32 s43, s40, 14
s_lshl_b32 s43, s43, 17
s_add_u32 m0, s42, 147456
s_nop 0
DH 224,16,0
s_add_u32 s43, s43, 31744
DH 225,16,1024
s_add_u32 s43, s43, 31744
DH 224,16,2048
s_add_u32 s43, s43, 31744
DH 225,16,3072
MM 24,72,144
MM 28,76,144
MM 32,80,144
MM 36,84,144
WM 8
TR 56,248,0
TR 60,249,0
TR 64,250,0
TR 68,251,0
TR 72,252,0
TR 76,253,0
TR 80,254,0
TR 84,255,0
WL 0
s_xor_b32 s43, s40, 15
s_lshl_b32 s43, s43, 17
s_add_u32 m0, s42, 114688
s_nop 0
DH 224,16,0
s_add_u32 s43, s43, 31744
DH 225,16,1024
s_add_u32 s43, s43, 31744
DH 224,16,2048
s_add_u32 s43, s43, 31744
DH 225,16,3072
MM 8,192,148
MM 12,196,148
MM 16,200,148
MM 20,204,148
WM 8
TR 58,248,16384
TR 62,249,16384
TR 66,250,16384
TR 70,251,16384
TR 74,252,16384
TR 78,253,16384
TR 82,254,16384
TR 86,255,16384
WL 0
s_xor_b32 s43, s40, 16
s_lshl_b32 s43, s43, 17
s_add_u32 m0, s42, 131072
s_nop 0
DH 224,16,0
s_add_u32 s43, s43, 31744
DH 225,16,1024
s_add_u32 s43, s43, 31744
DH 224,16,2048
s_add_u32 s43, s43, 31744
DH 225,16,3072
MM 24,208,148
MM 28,212,148
MM 32,216,148
MM 36,220,148
WM 8
TR 192,248,32768
TR 196,249,32768
TR 200,250,32768
TR 204,251,32768
TR 208,252,32768
TR 212,253,32768
TR 216,254,32768
TR 220,255,32768
WL 0
s_xor_b32 s43, s40, 17
s_lshl_b32 s43, s43, 17
s_add_u32 m0, s42, 147456
s_nop 0
DH 224,16,0
s_add_u32 s43, s43, 31744
DH 225,16,1024
s_add_u32 s43, s43, 31744
DH 224,16,2048
s_add_u32 s43, s43, 31744
DH 225,16,3072
MM 8,56,152
MM 12,60,152
MM 16,64,152
MM 20,68,152
WM 8
TR 194,248,0
TR 198,249,0
TR 202,250,0
TR 206,251,0
TR 210,252,0
TR 214,253,0
TR 218,254,0
TR 222,255,0
WL 0
s_xor_b32 s43, s40, 18
s_lshl_b32 s43, s43, 17
s_add_u32 m0, s42, 114688
s_nop 0
DH 224,16,0
s_add_u32 s43, s43, 31744
DH 225,16,1024
s_add_u32 s43, s43, 31744
DH 224,16,2048
s_add_u32 s43, s43, 31744
DH 225,16,3072
MM 24,72,152
MM 28,76,152
MM 32,80,152
MM 36,84,152
WM 8
TR 56,248,16384
TR 60,249,16384
TR 64,250,16384
TR 68,251,16384
TR 72,252,16384
TR 76,253,16384
TR 80,254,16384
TR 84,255,16384
WL 0
s_xor_b32 s43, s40, 19
s_lshl_b32 s43, s43, 17
s_add_u32 m0, s42, 131072
s_nop 0
DH 224,16,0
s_add_u32 s43, s43, 31744
DH 225,16,1024
s_add_u32 s43, s43, 31744
DH 224,16,2048
s_add_u32 s43, s43, 31744
DH 225,16,3072
MM 8,192,156
MM 12,196,156
MM 16,200,156
MM 20,204,156
WM 8
TR 58,248,32768
TR 62,249,32768
TR 66,250,32768
TR 70,251,32768
TR 74,252,32768
TR 78,253,32768
TR 82,254,32768
TR 86,255,32768
WL 0
s_xor_b32 s43, s40, 20
s_lshl_b32 s43, s43, 17
s_add_u32 m0, s42, 147456
s_nop 0
DH 224,16,0
s_add_u32 s43, s43, 31744
DH 225,16,1024
s_add_u32 s43, s43, 31744
DH 224,16,2048
s_add_u32 s43, s43, 31744
DH 225,16,3072
MM 24,208,156
MM 28,212,156
MM 32,216,156
MM 36,220,156
WM 8
TR 192,248,0
TR 196,249,0
TR 200,250,0
TR 204,251,0
TR 208,252,0
TR 212,253,0
TR 216,254,0
TR 220,255,0
WL 0
s_xor_b32 s43, s40, 21
s_lshl_b32 s43, s43, 17
s_add_u32 m0, s42, 114688
s_nop 0
DH 224,16,0
s_add_u32 s43, s43, 31744
DH 225,16,1024
s_add_u32 s43, s43, 31744
DH 224,16,2048
s_add_u32 s43, s43, 31744
DH 225,16,3072
MM 8,56,160
MM 12,60,160
MM 16,64,160
MM 20,68,160
WM 8
TR 194,248,16384
TR 198,249,16384
TR 202,250,16384
TR 206,251,16384
TR 210,252,16384
TR 214,253,16384
TR 218,254,16384
TR 222,255,16384
WL 0
s_xor_b32 s43, s40, 22
s_lshl_b32 s43, s43, 17
s_add_u32 m0, s42, 131072
s_nop 0
DH 224,16,0
s_add_u32 s43, s43, 31744
DH 225,16,1024
s_add_u32 s43, s43, 31744
DH 224,16,2048
s_add_u32 s43, s43, 31744
DH 225,16,3072
MM 24,72,160
MM 28,76,160
MM 32,80,160
MM 36,84,160
WM 8
TR 56,248,32768
TR 60,249,32768
TR 64,250,32768
TR 68,251,32768
TR 72,252,32768
TR 76,253,32768
TR 80,254,32768
TR 84,255,32768
WL 0
s_xor_b32 s43, s40, 23
s_lshl_b32 s43, s43, 17
s_add_u32 m0, s42, 147456
s_nop 0
DH 224,16,0
s_add_u32 s43, s43, 31744
DH 225,16,1024
s_add_u32 s43, s43, 31744
DH 224,16,2048
s_add_u32 s43, s43, 31744
DH 225,16,3072
MM 8,192,164
MM 12,196,164
MM 16,200,164
MM 20,204,164
WM 8
TR 58,248,0
TR 62,249,0
TR 66,250,0
TR 70,251,0
TR 74,252,0
TR 78,253,0
TR 82,254,0
TR 86,255,0
WL 0
s_xor_b32 s43, s40, 24
s_lshl_b32 s43, s43, 17
s_add_u32 m0, s42, 114688
s_nop 0
DH 224,16,0
s_add_u32 s43, s43, 31744
DH 225,16,1024
s_add_u32 s43, s43, 31744
DH 224,16,2048
s_add_u32 s43, s43, 31744
DH 225,16,3072
MM 24,208,164
MM 28,212,164
MM 32,216,164
MM 36,220,164
WM 8
TR 192,248,16384
TR 196,249,16384
TR 200,250,16384
TR 204,251,16384
TR 208,252,16384
TR 212,253,16384
TR 216,254,16384
TR 220,255,16384
WL 0
s_xor_b32 s43, s40, 25
s_lshl_b32 s43, s43, 17
s_add_u32 m0, s42, 131072
s_nop 0
DH 224,16,0
s_add_u32 s43, s43, 31744
DH 225,16,1024
s_add_u32 s43, s43, 31744
DH 224,16,2048
s_add_u32 s43, s43, 31744
DH 225,16,3072
MM 8,56,168
MM 12,60,168
MM 16,64,168
MM 20,68,168
WM 8
TR 194,248,32768
TR 198,249,32768
TR 202,250,32768
TR 206,251,32768
TR 210,252,32768
TR 214,253,32768
TR 218,254,32768
TR 222,255,32768
WL 0
s_xor_b32 s43, s40, 26
s_lshl_b32 s43, s43, 17
s_add_u32 m0, s42, 147456
s_nop 0
DH 224,16,0
s_add_u32 s43, s43, 31744
DH 225,16,1024
s_add_u32 s43, s43, 31744
DH 224,16,2048
s_add_u32 s43, s43, 31744
DH 225,16,3072
MM 24,72,168
MM 28,76,168
MM 32,80,168
MM 36,84,168
WM 8
TR 56,248,0
TR 60,249,0
TR 64,250,0
TR 68,251,0
TR 72,252,0
TR 76,253,0
TR 80,254,0
TR 84,255,0
WL 0
s_xor_b32 s43, s40, 27
s_lshl_b32 s43, s43, 17
s_add_u32 m0, s42, 114688
s_nop 0
DH 224,16,0
s_add_u32 s43, s43, 31744
DH 225,16,1024
s_add_u32 s43, s43, 31744
DH 224,16,2048
s_add_u32 s43, s43, 31744
DH 225,16,3072
MM 8,192,172
MM 12,196,172
MM 16,200,172
MM 20,204,172
WM 8
TR 58,248,16384
TR 62,249,16384
TR 66,250,16384
TR 70,251,16384
TR 74,252,16384
TR 78,253,16384
TR 82,254,16384
TR 86,255,16384
WL 0
s_xor_b32 s43, s40, 28
s_lshl_b32 s43, s43, 17
s_add_u32 m0, s42, 131072
s_nop 0
DH 224,16,0
s_add_u32 s43, s43, 31744
DH 225,16,1024
s_add_u32 s43, s43, 31744
DH 224,16,2048
s_add_u32 s43, s43, 31744
DH 225,16,3072
MM 24,208,172
MM 28,212,172
MM 32,216,172
MM 36,220,172
WM 8
TR 192,248,32768
TR 196,249,32768
TR 200,250,32768
TR 204,251,32768
TR 208,252,32768
TR 212,253,32768
TR 216,254,32768
TR 220,255,32768
WL 0
s_xor_b32 s43, s40, 29
s_lshl_b32 s43, s43, 17
s_add_u32 m0, s42, 147456
s_nop 0
DH 224,16,0
s_add_u32 s43, s43, 31744
DH 225,16,1024
s_add_u32 s43, s43, 31744
DH 224,16,2048
s_add_u32 s43, s43, 31744
DH 225,16,3072
MM 8,56,176
MM 12,60,176
MM 16,64,176
MM 20,68,176
WM 8
TR 194,248,0
TR 198,249,0
TR 202,250,0
TR 206,251,0
TR 210,252,0
TR 214,253,0
TR 218,254,0
TR 222,255,0
WL 0
s_xor_b32 s43, s40, 30
s_lshl_b32 s43, s43, 17
s_add_u32 m0, s42, 114688
s_nop 0
DH 224,16,0
s_add_u32 s43, s43, 31744
DH 225,16,1024
s_add_u32 s43, s43, 31744
DH 224,16,2048
s_add_u32 s43, s43, 31744
DH 225,16,3072
MM 24,72,176
MM 28,76,176
MM 32,80,176
MM 36,84,176
WM 8
TR 56,248,16384
TR 60,249,16384
TR 64,250,16384
TR 68,251,16384
TR 72,252,16384
TR 76,253,16384
TR 80,254,16384
TR 84,255,16384
WL 0
s_xor_b32 s43, s40, 31
s_lshl_b32 s43, s43, 17
s_add_u32 m0, s42, 131072
s_nop 0
DH 224,16,0
s_add_u32 s43, s43, 31744
DH 225,16,1024
s_add_u32 s43, s43, 31744
DH 224,16,2048
s_add_u32 s43, s43, 31744
DH 225,16,3072
MM 8,192,180
MM 12,196,180
MM 16,200,180
MM 20,204,180
WM 8
TR 58,248,32768
TR 62,249,32768
TR 66,250,32768
TR 70,251,32768
TR 74,252,32768
TR 78,253,32768
TR 82,254,32768
TR 86,255,32768
WL 0
MM 24,208,180
MM 28,212,180
MM 32,216,180
MM 36,220,180
s_mov_b32 s48, 16384
s_add_u32 m0, s41, 81920
s_nop 0
DM 114,12,0
DM 115,12,1024
s_mov_b32 s48, 32768
s_add_u32 m0, s41, 0
s_nop 0
DM 112,8,0
DM 113,8,1024
WM 8
TR 192,248,0
TR 196,249,0
TR 200,250,0
TR 204,251,0
TR 208,252,0
TR 212,253,0
TR 216,254,0
TR 220,255,0
WL 0
MM 8,56,184
MM 12,60,184
MM 16,64,184
MM 20,68,184
s_mov_b32 s48, 24576
s_add_u32 m0, s41, 90112
s_nop 0
DM 114,12,0
DM 115,12,1024
WM 6
TR 194,248,16384
TR 198,249,16384
TR 202,250,16384
TR 206,251,16384
TR 210,252,16384
TR 214,253,16384
TR 218,254,16384
TR 222,255,16384
WL 0
MM 24,72,184
MM 28,76,184
MM 32,80,184
MM 36,84,184
MM 8,192,188
MM 12,196,188
MM 16,200,188
MM 20,204,188
MM 24,208,188
MM 28,212,188
MM 32,216,188
MM 36,220,188
s_nop 2
v_mul_f32 v8, s50, v8
v_mul_f32 v9, s50, v9
v_mul_f32 v10, s50, v10
v_mul_f32 v11, s50, v11
v_mul_f32 v12, s50, v12
v_mul_f32 v13, s50, v13
v_mul_f32 v14, s50, v14
v_mul_f32 v15, s50, v15
v_mul_f32 v16, s50, v16
v_mul_f32 v17, s50, v17
v_mul_f32 v18, s50, v18
v_mul_f32 v19, s50, v19
v_mul_f32 v20, s50, v20
v_mul_f32 v21, s50, v21
v_mul_f32 v22, s50, v22
v_mul_f32 v23, s50, v23
v_mul_f32 v24, s50, v24
v_mul_f32 v25, s50, v25
v_mul_f32 v26, s50, v26
v_mul_f32 v27, s50, v27
v_mul_f32 v28, s50, v28
v_mul_f32 v29, s50, v29
v_mul_f32 v30, s50, v30
v_mul_f32 v31, s50, v31
v_mul_f32 v32, s50, v32
v_mul_f32 v33, s50, v33
v_mul_f32 v34, s50, v34
v_mul_f32 v35, s50, v35
v_mul_f32 v36, s50, v36
v_mul_f32 v37, s50, v37
v_mul_f32 v38, s50, v38
v_mul_f32 v39, s50, v39
CV 40,8
CV 42,12
CV 41,10
CV 43,14
CV 44,16
CV 46,20
CV 45,18
CV 47,22
CV 48,24
CV 50,28
CV 49,26
CV 51,30
CV 52,32
CV 54,36
CV 53,34
CV 55,38
v_permlane32_swap_b32 v40, v42
v_permlane32_swap_b32 v41, v43
v_permlane32_swap_b32 v44, v46
v_permlane32_swap_b32 v45, v47
v_permlane32_swap_b32 v48, v50
v_permlane32_swap_b32 v49, v51
v_permlane32_swap_b32 v52, v54
v_permlane32_swap_b32 v53, v55
v_permlane16_swap_b32 v40, v42
v_permlane16_swap_b32 v41, v43
v_permlane16_swap_b32 v44, v46
v_permlane16_swap_b32 v45, v47
v_permlane16_swap_b32 v48, v50
v_permlane16_swap_b32 v49, v51
v_permlane16_swap_b32 v52, v54
v_permlane16_swap_b32 v53, v55
WL 0
s_barrier
KR 56,100,8192
KR 60,100,12288
KR 64,101,8192
KR 68,101,12288
KR 72,102,8192
KR 76,102,12288
KR 80,103,8192
KR 84,103,12288
WL 4
MZ 88,56,40
MZ 92,60,40
MM 88,64,44
MM 92,68,44
WL 0
MM 88,72,48
MM 92,76,48
MM 88,80,52
MM 92,84,52
WL 0
s_barrier
KR 56,100,16384
KR 60,100,20480
KR 64,101,16384
KR 68,101,20480
KR 72,102,16384
KR 76,102,20480
KR 80,103,16384
KR 84,103,20480
WL 4
MZ 0,56,40
TR 56,104,8192
TR 58,104,12288
MZ 4,60,40
s_mov_b32 s48, 40960
s_add_u32 m0, s41, 8192
TR 60,105,8192
TR 62,105,12288
DM 112,8,0
DM 113,8,1024
MM 0,64,44
TR 64,106,8192
TR 66,106,12288
MM 4,68,44
TR 68,107,8192
TR 70,107,12288
WL 8
MM 0,72,48
TR 72,108,8192
TR 74,108,12288
MM 4,76,48
s_mov_b32 s48, 32768
s_add_u32 m0, s41, 57344
TR 76,109,8192
TR 78,109,12288
DM 114,12,0
DM 115,12,1024
MM 0,80,52
TR 80,110,8192
TR 82,110,12288
MM 4,84,52
WL 12
TR 84,111,8192
TR 86,111,12288
v_max3_f32 v120, v88, v89, v90
v_max3_f32 v121, v91, v92, v93
v_max3_f32 v120, v120, v94, v95
v_max_f32 v120, v120, v121
v_mov_b32 v121, v120
s_nop 1
v_permlane32_swap_b32 v120, v121
v_max_f32 v120, v120, v121
v_mov_b32 v121, v120
s_nop 1
v_permlane16_swap_b32 v120, v121
v_max_f32 v120, v120, v121
v_sub_f32 v124, 0, v120
v_sub_f32 v125, 0, v120
v_sub_f32 v126, 0, v120
v_sub_f32 v127, 0, v120
v_sub_f32 v88, v88, v120
v_sub_f32 v89, v89, v120
v_sub_f32 v90, v90, v120
v_sub_f32 v91, v91, v120
v_sub_f32 v92, v92, v120
v_sub_f32 v93, v93, v120
v_sub_f32 v94, v94, v120
v_sub_f32 v95, v95, v120
EX 88
EX 89
EX 90
EX 91
EX 92
EX 93
EX 94
EX 95
CV 96,88
CV 97,90
CV 98,92
CV 99,94
WL 0
s_barrier
MZ 8,56,96
s_mov_b32 s48, 49152
s_add_u32 m0, s41, 16384
KR 56,100,24576
v_mov_b32 v119, v88
DM 112,8,0
MZ 12,60,96
KR 60,100,28672
AD 89
MZ 16,64,96
KR 64,101,24576
AD 90
MZ 20,68,96
KR 68,101,28672
AD 91
MZ 24,72,96
KR 72,102,24576
AD 92
MZ 28,76,96
KR 76,102,28672
AD 93
MZ 32,80,96
KR 80,103,24576
AD 94
DM 113,8,1024
MZ 36,84,96
KR 84,103,28672
AD 95
WL 4
MN 88,56,40
TR 56,104,16384
TR 58,104,20480
MN 92,60,40
s_mov_b32 s48, 40960
s_add_u32 m0, s41, 65536
TR 60,105,16384
TR 62,105,20480
DM 114,12,0
MM 88,64,44
TR 64,106,16384
TR 66,106,20480
MM 92,68,44
TR 68,107,16384
TR 70,107,20480
WL 8
MM 88,72,48
TR 72,108,16384
TR 74,108,20480
MM 92,76,48
TR 76,109,16384
TR 78,109,20480
DM 115,12,1024
MM 88,80,52
TR 80,110,16384
TR 82,110,20480
MM 92,84,52
WL 12
TR 84,111,16384
TR 86,111,20480
v_add_f32 v0, v0, v124
v_add_f32 v1, v1, v124
v_add_f32 v2, v2, v124
v_add_f32 v3, v3, v124
v_add_f32 v4, v4, v124
v_add_f32 v5, v5, v124
v_add_f32 v6, v6, v124
v_add_f32 v7, v7, v124
v_max3_f32 v120, v0, v1, v2
v_max3_f32 v121, v3, v4, v5
v_max3_f32 v120, v120, v6, v7
v_max_f32 v120, v120, v121
v_cmp_lt_f32 vcc, s51, v120
s_cbranch_vccnz L_tramp1_1
L_back1_1:
EX 0
EX 1
EX 2
EX 3
EX 4
EX 5
EX 6
EX 7
CV 96,0
CV 97,2
CV 98,4
CV 99,6
WB 12
s_barrier
MM 8,56,96
s_mov_b32 s48, 57344
s_add_u32 m0, s41, 24576
KR 56,100,32768
AD 0
DM 112,8,0
MM 12,60,96
KR 60,100,36864
AD 1
MM 16,64,96
KR 64,101,32768
AD 2
MM 20,68,96
KR 68,101,36864
AD 3
MM 24,72,96
KR 72,102,32768
AD 4
MM 28,76,96
KR 76,102,36864
AD 5
MM 32,80,96
KR 80,103,32768
AD 6
DM 113,8,1024
MM 36,84,96
KR 84,103,36864
AD 7
WL 4
MN 0,56,40
TR 56,104,24576
TR 58,104,28672
MN 4,60,40
s_mov_b32 s48, 49152
s_add_u32 m0, s41, 73728
TR 60,105,24576
TR 62,105,28672
DM 114,12,0
v_max3_f32 v120, v88, v89, v90
MM 0,64,44
TR 64,106,24576
TR 66,106,28672
v_max3_f32 v121, v91, v92, v93
MM 4,68,44
TR 68,107,24576
TR 70,107,28672
v_max3_f32 v120, v120, v94, v95
WL 8
MM 0,72,48
TR 72,108,24576
TR 74,108,28672
v_max_f32 v120, v120, v121
MM 4,76,48
TR 76,109,24576
TR 78,109,28672
DM 115,12,1024
MM 0,80,52
TR 80,110,24576
TR 82,110,28672
MM 4,84,52
WL 12
TR 84,111,24576
TR 86,111,28672
v_cmp_lt_f32 vcc, s51, v120
s_cbranch_vccnz L_tramp1_2
L_back1_2:
EX 88
EX 89
EX 90
EX 91
EX 92
EX 93
EX 94
EX 95
CV 96,88
CV 97,90
CV 98,92
CV 99,94
WB 12
s_barrier
MM 8,56,96
s_mov_b32 s48, 65536
s_add_u32 m0, s41, 32768
KR 56,100,0
AD 88
DM 112,8,0
MM 12,60,96
KR 60,100,4096
AD 89
MM 16,64,96
KR 64,101,0
AD 90
MM 20,68,96
KR 68,101,4096
AD 91
MM 24,72,96
KR 72,102,0
AD 92
MM 28,76,96
KR 76,102,4096
AD 93
MM 32,80,96
KR 80,103,0
AD 94
DM 113,8,1024
MM 36,84,96
KR 84,103,4096
AD 95
WL 4
MN 88,56,40
TR 56,104,32768
TR 58,104,36864
MN 92,60,40
s_mov_b32 s48, 57344
s_add_u32 m0, s41, 81920
TR 60,105,32768
TR 62,105,36864
DM 114,12,0
v_max3_f32 v120, v0, v1, v2
MM 88,64,44
TR 64,106,32768
TR 66,106,36864
v_max3_f32 v121, v3, v4, v5
MM 92,68,44
TR 68,107,32768
TR 70,107,36864
v_max3_f32 v120, v120, v6, v7
WL 8
MM 88,72,48
TR 72,108,32768
TR 74,108,36864
v_max_f32 v120, v120, v121
MM 92,76,48
TR 76,109,32768
TR 78,109,36864
DM 115,12,1024
MM 88,80,52
TR 80,110,32768
TR 82,110,36864
MM 92,84,52
WL 12
TR 84,111,32768
TR 86,111,36864
v_cmp_lt_f32 vcc, s51, v120
s_cbranch_vccnz L_tramp1_3
L_back1_3:
EX 0
EX 1
EX 2
EX 3
EX 4
EX 5
EX 6
EX 7
CV 96,0
CV 97,2
CV 98,4
CV 99,6
WB 12
s_barrier
MM 8,56,96
s_mov_b32 s48, 73728
s_add_u32 m0, s41, 0
KR 56,100,8192
AD 0
DM 112,8,0
MM 12,60,96
KR 60,100,12288
AD 1
MM 16,64,96
KR 64,101,8192
AD 2
MM 20,68,96
KR 68,101,12288
AD 3
MM 24,72,96
KR 72,102,8192
AD 4
MM 28,76,96
KR 76,102,12288
AD 5
MM 32,80,96
KR 80,103,8192
AD 6
DM 113,8,1024
MM 36,84,96
KR 84,103,12288
AD 7
WL 4
MN 0,56,40
TR 56,104,0
TR 58,104,4096
MN 4,60,40
s_mov_b32 s48, 65536
s_add_u32 m0, s41, 90112
TR 60,105,0
TR 62,105,4096
DM 114,12,0
v_max3_f32 v120, v88, v89, v90
MM 0,64,44
TR 64,106,0
TR 66,106,4096
v_max3_f32 v121, v91, v92, v93
MM 4,68,44
TR 68,107,0
TR 70,107,4096
v_max3_f32 v120, v120, v94, v95
WL 8
MM 0,72,48
TR 72,108,0
TR 74,108,4096
v_max_f32 v120, v120, v121
MM 4,76,48
TR 76,109,0
TR 78,109,4096
DM 115,12,1024
MM 0,80,52
TR 80,110,0
TR 82,110,4096
MM 4,84,52
WL 12
TR 84,111,0
TR 86,111,4096
v_cmp_lt_f32 vcc, s51, v120
s_cbranch_vccnz L_tramp1_4
L_back1_4:
EX 88
EX 89
EX 90
EX 91
EX 92
EX 93
EX 94
EX 95
CV 96,88
CV 97,90
CV 98,92
CV 99,94
WB 12
s_barrier
MM 8,56,96
s_mov_b32 s48, 81920
s_add_u32 m0, s41, 8192
KR 56,100,16384
AD 88
DM 112,8,0
MM 12,60,96
KR 60,100,20480
AD 89
MM 16,64,96
KR 64,101,16384
AD 90
MM 20,68,96
KR 68,101,20480
AD 91
MM 24,72,96
KR 72,102,16384
AD 92
MM 28,76,96
KR 76,102,20480
AD 93
MM 32,80,96
KR 80,103,16384
AD 94
DM 113,8,1024
MM 36,84,96
KR 84,103,20480
AD 95
WL 4
MN 88,56,40
TR 56,104,8192
TR 58,104,12288
MN 92,60,40
s_mov_b32 s48, 73728
s_add_u32 m0, s41, 57344
TR 60,105,8192
TR 62,105,12288
DM 114,12,0
v_max3_f32 v120, v0, v1, v2
MM 88,64,44
TR 64,106,8192
TR 66,106,12288
v_max3_f32 v121, v3, v4, v5
MM 92,68,44
TR 68,107,8192
TR 70,107,12288
v_max3_f32 v120, v120, v6, v7
WL 8
MM 88,72,48
TR 72,108,8192
TR 74,108,12288
v_max_f32 v120, v120, v121
MM 92,76,48
TR 76,109,8192
TR 78,109,12288
DM 115,12,1024
MM 88,80,52
TR 80,110,8192
TR 82,110,12288
MM 92,84,52
WL 12
TR 84,111,8192
TR 86,111,12288
v_cmp_lt_f32 vcc, s51, v120
s_cbranch_vccnz L_tramp1_5
L_back1_5:
EX 0
EX 1
EX 2
EX 3
EX 4
EX 5
EX 6
EX 7
CV 96,0
CV 97,2
CV 98,4
CV 99,6
WB 12
s_barrier
MM 8,56,96
s_mov_b32 s48, 90112
s_add_u32 m0, s41, 16384
KR 56,100,24576
AD 0
DM 112,8,0
MM 12,60,96
KR 60,100,28672
AD 1
MM 16,64,96
KR 64,101,24576
AD 2
MM 20,68,96
KR 68,101,28672
AD 3
MM 24,72,96
KR 72,102,24576
AD 4
MM 28,76,96
KR 76,102,28672
AD 5
MM 32,80,96
KR 80,103,24576
AD 6
DM 113,8,1024
MM 36,84,96
KR 84,103,28672
AD 7
WL 4
MN 0,56,40
TR 56,104,16384
TR 58,104,20480
MN 4,60,40
s_mov_b32 s48, 81920
s_add_u32 m0, s41, 65536
TR 60,105,16384
TR 62,105,20480
DM 114,12,0
v_max3_f32 v120, v88, v89, v90
MM 0,64,44
TR 64,106,16384
TR 66,106,20480
v_max3_f32 v121, v91, v92, v93
MM 4,68,44
TR 68,107,16384
TR 70,107,20480
v_max3_f32 v120, v120, v94, v95
WL 8
MM 0,72,48
TR 72,108,16384
TR 74,108,20480
v_max_f32 v120, v120, v121
MM 4,76,48
TR 76,109,16384
TR 78,109,20480
DM 115,12,1024
MM 0,80,52
TR 80,110,16384
TR 82,110,20480
MM 4,84,52
WL 12
TR 84,111,16384
TR 86,111,20480
v_cmp_lt_f32 vcc, s51, v120
s_cbranch_vccnz L_tramp1_6
L_back1_6:
EX 88
EX 89
EX 90
EX 91
EX 92
EX 93
EX 94
EX 95
CV 96,88
CV 97,90
CV 98,92
CV 99,94
WB 12
s_barrier
MM 8,56,96
s_mov_b32 s48, 98304
s_add_u32 m0, s41, 24576
KR 56,100,32768
AD 88
DM 112,8,0
MM 12,60,96
KR 60,100,36864
AD 89
MM 16,64,96
KR 64,101,32768
AD 90
MM 20,68,96
KR 68,101,36864
AD 91
MM 24,72,96
KR 72,102,32768
AD 92
MM 28,76,96
KR 76,102,36864
AD 93
MM 32,80,96
KR 80,103,32768
AD 94
DM 113,8,1024
MM 36,84,96
KR 84,103,36864
AD 95
WL 4
MN 88,56,40
TR 56,104,24576
TR 58,104,28672
MN 92,60,40
s_mov_b32 s48, 90112
s_add_u32 m0, s41, 73728
TR 60,105,24576
TR 62,105,28672
DM 114,12,0
v_max3_f32 v120, v0, v1, v2
MM 88,64,44
TR 64,106,24576
TR 66,106,28672
v_max3_f32 v121, v3, v4, v5
MM 92,68,44
TR 68,107,24576
TR 70,107,28672
v_max3_f32 v120, v120, v6, v7
WL 8
MM 88,72,48
TR 72,108,24576
TR 74,108,28672
v_max_f32 v120, v120, v121
MM 92,76,48
TR 76,109,24576
TR 78,109,28672
DM 115,12,1024
MM 88,80,52
TR 80,110,24576
TR 82,110,28672
MM 92,84,52
WL 12
TR 84,111,24576
TR 86,111,28672
v_cmp_lt_f32 vcc, s51, v120
s_cbranch_vccnz L_tramp1_7
L_back1_7:
EX 0
EX 1
EX 2
EX 3
EX 4
EX 5
EX 6
EX 7
CV 96,0
CV 97,2
CV 98,4
CV 99,6
WB 12
s_barrier
MM 8,56,96
s_mov_b32 s48, 106496
s_add_u32 m0, s41, 32768
KR 56,100,0
AD 0
DM 112,8,0
MM 12,60,96
KR 60,100,4096
AD 1
MM 16,64,96
KR 64,101,0
AD 2
MM 20,68,96
KR 68,101,4096
AD 3
MM 24,72,96
KR 72,102,0
AD 4
MM 28,76,96
KR 76,102,4096
AD 5
MM 32,80,96
KR 80,103,0
AD 6
DM 113,8,1024
MM 36,84,96
KR 84,103,4096
AD 7
WL 4
MN 0,56,40
TR 56,104,32768
TR 58,104,36864
MN 4,60,40
s_mov_b32 s48, 98304
s_add_u32 m0, s41, 81920
TR 60,105,32768
TR 62,105,36864
DM 114,12,0
v_max3_f32 v120, v88, v89, v90
MM 0,64,44
TR 64,106,32768
TR 66,106,36864
v_max3_f32 v121, v91, v92, v93
MM 4,68,44
TR 68,107,32768
TR 70,107,36864
v_max3_f32 v120, v120, v94, v95
WL 8
MM 0,72,48
TR 72,108,32768
TR 74,108,36864
v_max_f32 v120, v120, v121
MM 4,76,48
TR 76,109,32768
TR 78,109,36864
DM 115,12,1024
MM 0,80,52
TR 80,110,32768
TR 82,110,36864
MM 4,84,52
WL 12
TR 84,111,32768
TR 86,111,36864
v_cmp_lt_f32 vcc, s51, v120
s_cbranch_vccnz L_tramp1_8
L_back1_8:
EX 88
EX 89
EX 90
EX 91
EX 92
EX 93
EX 94
EX 95
CV 96,88
CV 97,90
CV 98,92
CV 99,94
WB 12
s_barrier
MM 8,56,96
s_mov_b32 s48, 114688
s_add_u32 m0, s41, 0
KR 56,100,8192
AD 88
DM 112,8,0
MM 12,60,96
KR 60,100,12288
AD 89
MM 16,64,96
KR 64,101,8192
AD 90
MM 20,68,96
KR 68,101,12288
AD 91
MM 24,72,96
KR 72,102,8192
AD 92
MM 28,76,96
KR 76,102,12288
AD 93
MM 32,80,96
KR 80,103,8192
AD 94
DM 113,8,1024
MM 36,84,96
KR 84,103,12288
AD 95
WL 4
MN 88,56,40
TR 56,104,0
TR 58,104,4096
MN 92,60,40
s_mov_b32 s48, 106496
s_add_u32 m0, s41, 90112
TR 60,105,0
TR 62,105,4096
DM 114,12,0
v_max3_f32 v120, v0, v1, v2
MM 88,64,44
TR 64,106,0
TR 66,106,4096
v_max3_f32 v121, v3, v4, v5
MM 92,68,44
TR 68,107,0
TR 70,107,4096
v_max3_f32 v120, v120, v6, v7
WL 8
MM 88,72,48
TR 72,108,0
TR 74,108,4096
v_max_f32 v120, v120, v121
MM 92,76,48
TR 76,109,0
TR 78,109,4096
DM 115,12,1024
MM 88,80,52
TR 80,110,0
TR 82,110,4096
MM 92,84,52
WL 12
TR 84,111,0
TR 86,111,4096
v_cmp_lt_f32 vcc, s51, v120
s_cbranch_vccnz L_tramp1_9
L_back1_9:
EX 0
EX 1
EX 2
EX 3
EX 4
EX 5
EX 6
EX 7
CV 96,0
CV 97,2
CV 98,4
CV 99,6
WB 12
s_barrier
MM 8,56,96
s_mov_b32 s48, 122880
s_add_u32 m0, s41, 8192
KR 56,100,16384
AD 0
DM 112,8,0
MM 12,60,96
KR 60,100,20480
AD 1
MM 16,64,96
KR 64,101,16384
AD 2
MM 20,68,96
KR 68,101,20480
AD 3
MM 24,72,96
KR 72,102,16384
AD 4
MM 28,76,96
KR 76,102,20480
AD 5
MM 32,80,96
KR 80,103,16384
AD 6
DM 113,8,1024
MM 36,84,96
KR 84,103,20480
AD 7
WL 4
MN 0,56,40
TR 56,104,8192
TR 58,104,12288
MN 4,60,40
s_mov_b32 s48, 114688
s_add_u32 m0, s41, 57344
TR 60,105,8192
TR 62,105,12288
DM 114,12,0
v_max3_f32 v120, v88, v89, v90
MM 0,64,44
TR 64,106,8192
TR 66,106,12288
v_max3_f32 v121, v91, v92, v93
MM 4,68,44
TR 68,107,8192
TR 70,107,12288
v_max3_f32 v120, v120, v94, v95
WL 8
MM 0,72,48
TR 72,108,8192
TR 74,108,12288
v_max_f32 v120, v120, v121
MM 4,76,48
TR 76,109,8192
TR 78,109,12288
DM 115,12,1024
MM 0,80,52
TR 80,110,8192
TR 82,110,12288
MM 4,84,52
WL 12
TR 84,111,8192
TR 86,111,12288
v_cmp_lt_f32 vcc, s51, v120
s_cbranch_vccnz L_tramp1_10
L_back1_10:
EX 88
EX 89
EX 90
EX 91
EX 92
EX 93
EX 94
EX 95
CV 96,88
CV 97,90
CV 98,92
CV 99,94
WB 12
s_barrier
MM 8,56,96
s_mov_b32 s48, 131072
s_add_u32 m0, s41, 16384
KR 56,100,24576
AD 88
DM 112,8,0
MM 12,60,96
KR 60,100,28672
AD 89
MM 16,64,96
KR 64,101,24576
AD 90
MM 20,68,96
KR 68,101,28672
AD 91
MM 24,72,96
KR 72,102,24576
AD 92
MM 28,76,96
KR 76,102,28672
AD 93
MM 32,80,96
KR 80,103,24576
AD 94
DM 113,8,1024
MM 36,84,96
KR 84,103,28672
AD 95
WL 4
MN 88,56,40
TR 56,104,16384
TR 58,104,20480
MN 92,60,40
s_mov_b32 s48, 122880
s_add_u32 m0, s41, 65536
TR 60,105,16384
TR 62,105,20480
DM 114,12,0
v_max3_f32 v120, v0, v1, v2
MM 88,64,44
TR 64,106,16384
TR 66,106,20480
v_max3_f32 v121, v3, v4, v5
MM 92,68,44
TR 68,107,16384
TR 70,107,20480
v_max3_f32 v120, v120, v6, v7
WL 8
MM 88,72,48
TR 72,108,16384
TR 74,108,20480
v_max_f32 v120, v120, v121
MM 92,76,48
TR 76,109,16384
TR 78,109,20480
DM 115,12,1024
MM 88,80,52
TR 80,110,16384
TR 82,110,20480
MM 92,84,52
WL 12
TR 84,111,16384
TR 86,111,20480
v_cmp_lt_f32 vcc, s51, v120
s_cbranch_vccnz L_tramp1_11
L_back1_11:
EX 0
EX 1
EX 2
EX 3
EX 4
EX 5
EX 6
EX 7
CV 96,0
CV 97,2
CV 98,4
CV 99,6
WB 12
s_barrier
MM 8,56,96
s_mov_b32 s48, 139264
s_add_u32 m0, s41, 24576
KR 56,100,32768
AD 0
DM 112,8,0
MM 12,60,96
KR 60,100,36864
AD 1
MM 16,64,96
KR 64,101,32768
AD 2
MM 20,68,96
KR 68,101,36864
AD 3
MM 24,72,96
KR 72,102,32768
AD 4
MM 28,76,96
KR 76,102,36864
AD 5
MM 32,80,96
KR 80,103,32768
AD 6
DM 113,8,1024
MM 36,84,96
KR 84,103,36864
AD 7
WL 4
MN 0,56,40
TR 56,104,24576
TR 58,104,28672
MN 4,60,40
s_mov_b32 s48, 131072
s_add_u32 m0, s41, 73728
TR 60,105,24576
TR 62,105,28672
DM 114,12,0
v_max3_f32 v120, v88, v89, v90
MM 0,64,44
TR 64,106,24576
TR 66,106,28672
v_max3_f32 v121, v91, v92, v93
MM 4,68,44
TR 68,107,24576
TR 70,107,28672
v_max3_f32 v120, v120, v94, v95
WL 8
MM 0,72,48
TR 72,108,24576
TR 74,108,28672
v_max_f32 v120, v120, v121
MM 4,76,48
TR 76,109,24576
TR 78,109,28672
DM 115,12,1024
MM 0,80,52
TR 80,110,24576
TR 82,110,28672
MM 4,84,52
WL 12
TR 84,111,24576
TR 86,111,28672
v_cmp_lt_f32 vcc, s51, v120
s_cbranch_vccnz L_tramp1_12
L_back1_12:
EX 88
EX 89
EX 90
EX 91
EX 92
EX 93
EX 94
EX 95
CV 96,88
CV 97,90
CV 98,92
CV 99,94
WB 12
s_barrier
MM 8,56,96
s_mov_b32 s48, 147456
s_add_u32 m0, s41, 32768
KR 56,100,40960
AD 88
DM 112,8,0
MM 12,60,96
KR 60,100,45056
AD 89
MM 16,64,96
KR 64,101,40960
AD 90
MM 20,68,96
KR 68,101,45056
AD 91
MM 24,72,96
KR 72,102,40960
AD 92
MM 28,76,96
KR 76,102,45056
AD 93
MM 32,80,96
KR 80,103,40960
AD 94
DM 113,8,1024
MM 36,84,96
KR 84,103,45056
AD 95
WL 4
MN 88,56,40
TR 56,104,32768
TR 58,104,36864
MN 92,60,40
s_mov_b32 s48, 139264
s_add_u32 m0, s41, 81920
TR 60,105,32768
TR 62,105,36864
DM 114,12,0
v_max3_f32 v120, v0, v1, v2
MM 88,64,44
TR 64,106,32768
TR 66,106,36864
v_max3_f32 v121, v3, v4, v5
MM 92,68,44
TR 68,107,32768
TR 70,107,36864
v_max3_f32 v120, v120, v6, v7
WL 8
MM 88,72,48
TR 72,108,32768
TR 74,108,36864
v_max_f32 v120, v120, v121
MM 92,76,48
TR 76,109,32768
TR 78,109,36864
DM 115,12,1024
MM 88,80,52
TR 80,110,32768
TR 82,110,36864
MM 92,84,52
WL 12
TR 84,111,32768
TR 86,111,36864
v_cmp_lt_f32 vcc, s51, v120
s_cbranch_vccnz L_tramp1_13
L_back1_13:
EX 0
EX 1
EX 2
EX 3
EX 4
EX 5
EX 6
EX 7
CV 96,0
CV 97,2
CV 98,4
CV 99,6
WL 0
s_barrier
MM 8,56,96
KR 56,100,0
AD 0
MM 12,60,96
KR 60,100,4096
AD 1
MM 16,64,96
KR 64,101,0
AD 2
MM 20,68,96
KR 68,101,4096
AD 3
MM 24,72,96
KR 72,102,0
AD 4
MM 28,76,96
KR 76,102,4096
AD 5
MM 32,80,96
KR 80,103,0
AD 6
MM 36,84,96
KR 84,103,4096
AD 7
WL 4
MN 0,56,40
TR 56,104,40960
TR 58,104,45056
MN 4,60,40
TR 60,105,40960
TR 62,105,45056
v_max3_f32 v120, v88, v89, v90
MM 0,64,44
TR 64,106,40960
TR 66,106,45056
v_max3_f32 v121, v91, v92, v93
MM 4,68,44
TR 68,107,40960
TR 70,107,45056
v_max3_f32 v120, v120, v94, v95
WL 8
MM 0,72,48
TR 72,108,40960
TR 74,108,45056
v_max_f32 v120, v120, v121
MM 4,76,48
TR 76,109,40960
TR 78,109,45056
MM 0,80,52
TR 80,110,40960
TR 82,110,45056
MM 4,84,52
WL 12
TR 84,111,40960
TR 86,111,45056
v_cmp_lt_f32 vcc, s51, v120
s_cbranch_vccnz L_tramp1_14
L_back1_14:
EX 88
EX 89
EX 90
EX 91
EX 92
EX 93
EX 94
EX 95
CV 96,88
CV 97,90
CV 98,92
CV 99,94
WB 12
s_barrier
MM 8,56,96
s_mov_b32 s48, 155648
s_add_u32 m0, s41, 0
KR 56,100,8192
AD 88
DM 112,8,0
MM 12,60,96
KR 60,100,12288
AD 89
MM 16,64,96
KR 64,101,8192
AD 90
MM 20,68,96
KR 68,101,12288
AD 91
MM 24,72,96
KR 72,102,8192
AD 92
MM 28,76,96
KR 76,102,12288
AD 93
MM 32,80,96
KR 80,103,8192
AD 94
DM 113,8,1024
MM 36,84,96
KR 84,103,12288
AD 95
WL 4
MN 88,56,40
TR 56,104,0
TR 58,104,4096
MN 92,60,40
s_mov_b32 s48, 147456
s_add_u32 m0, s41, 90112
TR 60,105,0
TR 62,105,4096
DM 114,12,0
v_max3_f32 v120, v0, v1, v2
MM 88,64,44
TR 64,106,0
TR 66,106,4096
v_max3_f32 v121, v3, v4, v5
MM 92,68,44
TR 68,107,0
TR 70,107,4096
v_max3_f32 v120, v120, v6, v7
WL 8
MM 88,72,48
TR 72,108,0
TR 74,108,4096
v_max_f32 v120, v120, v121
MM 92,76,48
TR 76,109,0
TR 78,109,4096
DM 115,12,1024
MM 88,80,52
TR 80,110,0
TR 82,110,4096
MM 92,84,52
WL 12
TR 84,111,0
TR 86,111,4096
WL 8
s_add_u32 s43, s41, 40960
v_add_u32 v122, s43, v118
ds_write_b128 v122, a[0:3] offset:0
ds_write_b128 v122, a[4:7] offset:1024
ds_write_b128 v122, a[8:11] offset:57344
ds_write_b128 v122, a[12:15] offset:58368
v_cmp_lt_f32 vcc, s51, v120
s_cbranch_vccnz L_tramp1_15
L_back1_15:
EX 0
EX 1
EX 2
EX 3
EX 4
EX 5
EX 6
EX 7
CV 96,0
CV 97,2
CV 98,4
CV 99,6
WB 12
s_barrier
MM 8,56,96
s_mov_b32 s48, 163840
s_add_u32 m0, s41, 8192
KR 56,100,16384
AD 0
DM 112,8,0
MM 12,60,96
KR 60,100,20480
AD 1
MM 16,64,96
KR 64,101,16384
AD 2
MM 20,68,96
KR 68,101,20480
AD 3
MM 24,72,96
KR 72,102,16384
AD 4
MM 28,76,96
KR 76,102,20480
AD 5
MM 32,80,96
KR 80,103,16384
AD 6
DM 113,8,1024
MM 36,84,96
KR 84,103,20480
AD 7
WL 4
MN 0,56,40
TR 56,104,8192
TR 58,104,12288
MN 4,60,40
s_mov_b32 s48, 155648
s_add_u32 m0, s41, 57344
TR 60,105,8192
TR 62,105,12288
DM 114,12,0
v_max3_f32 v120, v88, v89, v90
MM 0,64,44
TR 64,106,8192
TR 66,106,12288
v_max3_f32 v121, v91, v92, v93
MM 4,68,44
TR 68,107,8192
TR 70,107,12288
v_max3_f32 v120, v120, v94, v95
WL 8
MM 0,72,48
TR 72,108,8192
TR 74,108,12288
v_max_f32 v120, v120, v121
MM 4,76,48
TR 76,109,8192
TR 78,109,12288
DM 115,12,1024
MM 0,80,52
TR 80,110,8192
TR 82,110,12288
MM 4,84,52
WL 12
TR 84,111,8192
TR 86,111,12288
v_cmp_lt_f32 vcc, s51, v120
s_cbranch_vccnz L_tramp1_16
L_back1_16:
EX 88
EX 89
EX 90
EX 91
EX 92
EX 93
EX 94
EX 95
CV 96,88
CV 97,90
CV 98,92
CV 99,94
WB 12
s_barrier
MM 8,56,96
s_mov_b32 s48, 172032
s_add_u32 m0, s41, 16384
KR 56,100,49152
AD 88
DM 112,8,0
MM 12,60,96
KR 60,100,53248
AD 89
MM 16,64,96
KR 64,101,49152
AD 90
MM 20,68,96
KR 68,101,53248
AD 91
MM 24,72,96
KR 72,102,49152
AD 92
MM 28,76,96
KR 76,102,53248
AD 93
MM 32,80,96
KR 80,103,49152
AD 94
DM 113,8,1024
MM 36,84,96
KR 84,103,53248
AD 95
WL 4
MN 88,56,40
TR 56,104,16384
TR 58,104,20480
MN 92,60,40
s_mov_b32 s48, 163840
s_add_u32 m0, s41, 65536
TR 60,105,16384
TR 62,105,20480
DM 114,12,0
v_max3_f32 v120, v0, v1, v2
MM 88,64,44
TR 64,106,16384
TR 66,106,20480
v_max3_f32 v121, v3, v4, v5
MM 92,68,44
TR 68,107,16384
TR 70,107,20480
v_max3_f32 v120, v120, v6, v7
WL 8
MM 88,72,48
TR 72,108,16384
TR 74,108,20480
v_max_f32 v120, v120, v121
MM 92,76,48
TR 76,109,16384
TR 78,109,20480
DM 115,12,1024
MM 88,80,52
TR 80,110,16384
TR 82,110,20480
MM 92,84,52
WL 12
TR 84,111,16384
TR 86,111,20480
v_cmp_lt_f32 vcc, s51, v120
s_cbranch_vccnz L_tramp1_17
L_back1_17:
EX 0
EX 1
EX 2
EX 3
EX 4
EX 5
EX 6
EX 7
CV 96,0
CV 97,2
CV 98,4
CV 99,6
WL 0
s_barrier
MM 8,56,96
KR 56,100,24576
AD 0
MM 12,60,96
KR 60,100,28672
AD 1
MM 16,64,96
KR 64,101,24576
AD 2
MM 20,68,96
KR 68,101,28672
AD 3
MM 24,72,96
KR 72,102,24576
AD 4
MM 28,76,96
KR 76,102,28672
AD 5
MM 32,80,96
KR 80,103,24576
AD 6
MM 36,84,96
KR 84,103,28672
AD 7
WL 4
MN 0,56,40
TR 56,104,49152
TR 58,104,53248
MN 4,60,40
TR 60,105,49152
TR 62,105,53248
v_max3_f32 v120, v88, v89, v90
MM 0,64,44
TR 64,106,49152
TR 66,106,53248
v_max3_f32 v121, v91, v92, v93
MM 4,68,44
TR 68,107,49152
TR 70,107,53248
v_max3_f32 v120, v120, v94, v95
WL 8
MM 0,72,48
TR 72,108,49152
TR 74,108,53248
v_max_f32 v120, v120, v121
MM 4,76,48
TR 76,109,49152
TR 78,109,53248
MM 0,80,52
TR 80,110,49152
TR 82,110,53248
MM 4,84,52
WL 12
TR 84,111,49152
TR 86,111,53248
v_cmp_lt_f32 vcc, s51, v120
s_cbranch_vccnz L_tramp1_18
L_back1_18:
EX 88
EX 89
EX 90
EX 91
EX 92
EX 93
EX 94
EX 95
CV 96,88
CV 97,90
CV 98,92
CV 99,94
WB 12
s_barrier
MM 8,56,96
s_mov_b32 s48, 180224
s_add_u32 m0, s41, 24576
KR 56,100,32768
AD 88
DM 112,8,0
MM 12,60,96
KR 60,100,36864
AD 89
MM 16,64,96
KR 64,101,32768
AD 90
MM 20,68,96
KR 68,101,36864
AD 91
MM 24,72,96
KR 72,102,32768
AD 92
MM 28,76,96
KR 76,102,36864
AD 93
MM 32,80,96
KR 80,103,32768
AD 94
DM 113,8,1024
MM 36,84,96
KR 84,103,36864
AD 95
WL 4
MN 88,56,40
TR 56,104,24576
TR 58,104,28672
MN 92,60,40
s_mov_b32 s48, 172032
s_add_u32 m0, s41, 73728
TR 60,105,24576
TR 62,105,28672
DM 114,12,0
v_max3_f32 v120, v0, v1, v2
MM 88,64,44
TR 64,106,24576
TR 66,106,28672
v_max3_f32 v121, v3, v4, v5
MM 92,68,44
TR 68,107,24576
TR 70,107,28672
v_max3_f32 v120, v120, v6, v7
WL 8
MM 88,72,48
TR 72,108,24576
TR 74,108,28672
v_max_f32 v120, v120, v121
MM 92,76,48
TR 76,109,24576
TR 78,109,28672
DM 115,12,1024
MM 88,80,52
TR 80,110,24576
TR 82,110,28672
MM 92,84,52
WL 12
TR 84,111,24576
TR 86,111,28672
WL 8
s_add_u32 s43, s41, 49152
v_add_u32 v122, s43, v118
ds_write_b128 v122, a[16:19] offset:0
ds_write_b128 v122, a[20:23] offset:1024
ds_write_b128 v122, a[24:27] offset:57344
ds_write_b128 v122, a[28:31] offset:58368
v_cmp_lt_f32 vcc, s51, v120
s_cbranch_vccnz L_tramp1_19
L_back1_19:
EX 0
EX 1
EX 2
EX 3
EX 4
EX 5
EX 6
EX 7
CV 96,0
CV 97,2
CV 98,4
CV 99,6
WB 12
s_barrier
MM 8,56,96
s_mov_b32 s48, 188416
s_add_u32 m0, s41, 32768
KR 56,100,0
AD 0
DM 112,8,0
MM 12,60,96
KR 60,100,4096
AD 1
MM 16,64,96
KR 64,101,0
AD 2
MM 20,68,96
KR 68,101,4096
AD 3
MM 24,72,96
KR 72,102,0
AD 4
MM 28,76,96
KR 76,102,4096
AD 5
MM 32,80,96
KR 80,103,0
AD 6
DM 113,8,1024
MM 36,84,96
KR 84,103,4096
AD 7
WL 4
MN 0,56,40
TR 56,104,32768
TR 58,104,36864
MN 4,60,40
s_mov_b32 s48, 180224
s_add_u32 m0, s41, 81920
TR 60,105,32768
TR 62,105,36864
DM 114,12,0
v_max3_f32 v120, v88, v89, v90
MM 0,64,44
TR 64,106,32768
TR 66,106,36864
v_max3_f32 v121, v91, v92, v93
MM 4,68,44
TR 68,107,32768
TR 70,107,36864
v_max3_f32 v120, v120, v94, v95
WL 8
MM 0,72,48
TR 72,108,32768
TR 74,108,36864
v_max_f32 v120, v120, v121
MM 4,76,48
TR 76,109,32768
TR 78,109,36864
DM 115,12,1024
MM 0,80,52
TR 80,110,32768
TR 82,110,36864
MM 4,84,52
WL 12
TR 84,111,32768
TR 86,111,36864
v_cmp_lt_f32 vcc, s51, v120
s_cbranch_vccnz L_tramp1_20
L_back1_20:
EX 88
EX 89
EX 90
EX 91
EX 92
EX 93
EX 94
EX 95
CV 96,88
CV 97,90
CV 98,92
CV 99,94
WB 12
s_barrier
MM 8,56,96
s_mov_b32 s48, 196608
s_add_u32 m0, s41, 0
KR 56,100,40960
AD 88
DM 112,8,0
MM 12,60,96
KR 60,100,45056
AD 89
MM 16,64,96
KR 64,101,40960
AD 90
MM 20,68,96
KR 68,101,45056
AD 91
MM 24,72,96
KR 72,102,40960
AD 92
MM 28,76,96
KR 76,102,45056
AD 93
MM 32,80,96
KR 80,103,40960
AD 94
DM 113,8,1024
MM 36,84,96
KR 84,103,45056
AD 95
WL 4
MN 88,56,40
TR 56,104,0
TR 58,104,4096
MN 92,60,40
s_mov_b32 s48, 188416
s_add_u32 m0, s41, 90112
TR 60,105,0
TR 62,105,4096
DM 114,12,0
v_max3_f32 v120, v0, v1, v2
MM 88,64,44
TR 64,106,0
TR 66,106,4096
v_max3_f32 v121, v3, v4, v5
MM 92,68,44
TR 68,107,0
TR 70,107,4096
v_max3_f32 v120, v120, v6, v7
WL 8
MM 88,72,48
TR 72,108,0
TR 74,108,4096
v_max_f32 v120, v120, v121
MM 92,76,48
TR 76,109,0
TR 78,109,4096
DM 115,12,1024
MM 88,80,52
TR 80,110,0
TR 82,110,4096
MM 92,84,52
WL 12
TR 84,111,0
TR 86,111,4096
v_cmp_lt_f32 vcc, s51, v120
s_cbranch_vccnz L_tramp1_21
L_back1_21:
EX 0
EX 1
EX 2
EX 3
EX 4
EX 5
EX 6
EX 7
CV 96,0
CV 97,2
CV 98,4
CV 99,6
WL 0
s_barrier
MM 8,56,96
KR 56,100,8192
AD 0
MM 12,60,96
KR 60,100,12288
AD 1
MM 16,64,96
KR 64,101,8192
AD 2
MM 20,68,96
KR 68,101,12288
AD 3
MM 24,72,96
KR 72,102,8192
AD 4
MM 28,76,96
KR 76,102,12288
AD 5
MM 32,80,96
KR 80,103,8192
AD 6
MM 36,84,96
KR 84,103,12288
AD 7
WL 4
MN 0,56,40
TR 56,104,40960
TR 58,104,45056
MN 4,60,40
TR 60,105,40960
TR 62,105,45056
v_max3_f32 v120, v88, v89, v90
MM 0,64,44
TR 64,106,40960
TR 66,106,45056
v_max3_f32 v121, v91, v92, v93
MM 4,68,44
TR 68,107,40960
TR 70,107,45056
v_max3_f32 v120, v120, v94, v95
WL 8
MM 0,72,48
TR 72,108,40960
TR 74,108,45056
v_max_f32 v120, v120, v121
MM 4,76,48
TR 76,109,40960
TR 78,109,45056
MM 0,80,52
TR 80,110,40960
TR 82,110,45056
MM 4,84,52
WL 12
TR 84,111,40960
TR 86,111,45056
v_cmp_lt_f32 vcc, s51, v120
s_cbranch_vccnz L_tramp1_22
L_back1_22:
EX 88
EX 89
EX 90
EX 91
EX 92
EX 93
EX 94
EX 95
CV 96,88
CV 97,90
CV 98,92
CV 99,94
WB 12
s_barrier
MM 8,56,96
s_mov_b32 s48, 204800
s_add_u32 m0, s41, 8192
KR 56,100,16384
AD 88
DM 112,8,0
MM 12,60,96
KR 60,100,20480
AD 89
MM 16,64,96
KR 64,101,16384
AD 90
MM 20,68,96
KR 68,101,20480
AD 91
MM 24,72,96
KR 72,102,16384
AD 92
MM 28,76,96
KR 76,102,20480
AD 93
MM 32,80,96
KR 80,103,16384
AD 94
DM 113,8,1024
MM 36,84,96
KR 84,103,20480
AD 95
WL 4
MN 88,56,40
TR 56,104,8192
TR 58,104,12288
MN 92,60,40
s_mov_b32 s48, 196608
s_add_u32 m0, s41, 57344
TR 60,105,8192
TR 62,105,12288
DM 114,12,0
v_max3_f32 v120, v0, v1, v2
MM 88,64,44
TR 64,106,8192
TR 66,106,12288
v_max3_f32 v121, v3, v4, v5
MM 92,68,44
TR 68,107,8192
TR 70,107,12288
v_max3_f32 v120, v120, v6, v7
WL 8
MM 88,72,48
TR 72,108,8192
TR 74,108,12288
v_max_f32 v120, v120, v121
MM 92,76,48
TR 76,109,8192
TR 78,109,12288
DM 115,12,1024
MM 88,80,52
TR 80,110,8192
TR 82,110,12288
MM 92,84,52
WL 12
TR 84,111,8192
TR 86,111,12288
WL 8
s_add_u32 s43, s41, 40960
v_add_u32 v122, s43, v118
ds_write_b128 v122, a[32:35] offset:0
ds_write_b128 v122, a[36:39] offset:1024
ds_write_b128 v122, a[40:43] offset:57344
ds_write_b128 v122, a[44:47] offset:58368
v_cmp_lt_f32 vcc, s51, v120
s_cbranch_vccnz L_tramp1_23
L_back1_23:
EX 0
EX 1
EX 2
EX 3
EX 4
EX 5
EX 6
EX 7
CV 96,0
CV 97,2
CV 98,4
CV 99,6
WB 12
s_barrier
MM 8,56,96
s_mov_b32 s48, 212992
s_add_u32 m0, s41, 16384
KR 56,100,24576
AD 0
DM 112,8,0
MM 12,60,96
KR 60,100,28672
AD 1
MM 16,64,96
KR 64,101,24576
AD 2
MM 20,68,96
KR 68,101,28672
AD 3
MM 24,72,96
KR 72,102,24576
AD 4
MM 28,76,96
KR 76,102,28672
AD 5
MM 32,80,96
KR 80,103,24576
AD 6
DM 113,8,1024
MM 36,84,96
KR 84,103,28672
AD 7
WL 4
MN 0,56,40
TR 56,104,16384
TR 58,104,20480
MN 4,60,40
s_mov_b32 s48, 204800
s_add_u32 m0, s41, 65536
TR 60,105,16384
TR 62,105,20480
DM 114,12,0
v_max3_f32 v120, v88, v89, v90
MM 0,64,44
TR 64,106,16384
TR 66,106,20480
v_max3_f32 v121, v91, v92, v93
MM 4,68,44
TR 68,107,16384
TR 70,107,20480
v_max3_f32 v120, v120, v94, v95
WL 8
MM 0,72,48
TR 72,108,16384
TR 74,108,20480
v_max_f32 v120, v120, v121
MM 4,76,48
TR 76,109,16384
TR 78,109,20480
DM 115,12,1024
MM 0,80,52
TR 80,110,16384
TR 82,110,20480
MM 4,84,52
WL 12
TR 84,111,16384
TR 86,111,20480
v_cmp_lt_f32 vcc, s51, v120
s_cbranch_vccnz L_tramp1_24
L_back1_24:
EX 88
EX 89
EX 90
EX 91
EX 92
EX 93
EX 94
EX 95
CV 96,88
CV 97,90
CV 98,92
CV 99,94
WB 12
s_barrier
MM 8,56,96
s_mov_b32 s48, 221184
s_add_u32 m0, s41, 24576
KR 56,100,49152
AD 88
DM 112,8,0
MM 12,60,96
KR 60,100,53248
AD 89
MM 16,64,96
KR 64,101,49152
AD 90
MM 20,68,96
KR 68,101,53248
AD 91
MM 24,72,96
KR 72,102,49152
AD 92
MM 28,76,96
KR 76,102,53248
AD 93
MM 32,80,96
KR 80,103,49152
AD 94
DM 113,8,1024
MM 36,84,96
KR 84,103,53248
AD 95
WL 4
MN 88,56,40
TR 56,104,24576
TR 58,104,28672
MN 92,60,40
s_mov_b32 s48, 212992
s_add_u32 m0, s41, 73728
TR 60,105,24576
TR 62,105,28672
DM 114,12,0
v_max3_f32 v120, v0, v1, v2
MM 88,64,44
TR 64,106,24576
TR 66,106,28672
v_max3_f32 v121, v3, v4, v5
MM 92,68,44
TR 68,107,24576
TR 70,107,28672
v_max3_f32 v120, v120, v6, v7
WL 8
MM 88,72,48
TR 72,108,24576
TR 74,108,28672
v_max_f32 v120, v120, v121
MM 92,76,48
TR 76,109,24576
TR 78,109,28672
DM 115,12,1024
MM 88,80,52
TR 80,110,24576
TR 82,110,28672
MM 92,84,52
WL 12
TR 84,111,24576
TR 86,111,28672
v_cmp_lt_f32 vcc, s51, v120
s_cbranch_vccnz L_tramp1_25
L_back1_25:
EX 0
EX 1
EX 2
EX 3
EX 4
EX 5
EX 6
EX 7
CV 96,0
CV 97,2
CV 98,4
CV 99,6
WL 0
s_barrier
MM 8,56,96
KR 56,100,32768
AD 0
MM 12,60,96
KR 60,100,36864
AD 1
MM 16,64,96
KR 64,101,32768
AD 2
MM 20,68,96
KR 68,101,36864
AD 3
MM 24,72,96
KR 72,102,32768
AD 4
MM 28,76,96
KR 76,102,36864
AD 5
MM 32,80,96
KR 80,103,32768
AD 6
MM 36,84,96
KR 84,103,36864
AD 7
WL 4
MN 0,56,40
TR 56,104,49152
TR 58,104,53248
MN 4,60,40
TR 60,105,49152
TR 62,105,53248
v_max3_f32 v120, v88, v89, v90
MM 0,64,44
TR 64,106,49152
TR 66,106,53248
v_max3_f32 v121, v91, v92, v93
MM 4,68,44
TR 68,107,49152
TR 70,107,53248
v_max3_f32 v120, v120, v94, v95
WL 8
MM 0,72,48
TR 72,108,49152
TR 74,108,53248
v_max_f32 v120, v120, v121
MM 4,76,48
TR 76,109,49152
TR 78,109,53248
MM 0,80,52
TR 80,110,49152
TR 82,110,53248
MM 4,84,52
WL 12
TR 84,111,49152
TR 86,111,53248
v_cmp_lt_f32 vcc, s51, v120
s_cbranch_vccnz L_tramp1_26
L_back1_26:
EX 88
EX 89
EX 90
EX 91
EX 92
EX 93
EX 94
EX 95
CV 96,88
CV 97,90
CV 98,92
CV 99,94
WB 12
s_barrier
MM 8,56,96
s_mov_b32 s48, 229376
s_add_u32 m0, s41, 32768
KR 56,100,0
AD 88
DM 112,8,0
MM 12,60,96
KR 60,100,4096
AD 89
MM 16,64,96
KR 64,101,0
AD 90
MM 20,68,96
KR 68,101,4096
AD 91
MM 24,72,96
KR 72,102,0
AD 92
MM 28,76,96
KR 76,102,4096
AD 93
MM 32,80,96
KR 80,103,0
AD 94
DM 113,8,1024
MM 36,84,96
KR 84,103,4096
AD 95
WL 4
MN 88,56,40
TR 56,104,32768
TR 58,104,36864
MN 92,60,40
s_mov_b32 s48, 221184
s_add_u32 m0, s41, 81920
TR 60,105,32768
TR 62,105,36864
DM 114,12,0
v_max3_f32 v120, v0, v1, v2
MM 88,64,44
TR 64,106,32768
TR 66,106,36864
v_max3_f32 v121, v3, v4, v5
MM 92,68,44
TR 68,107,32768
TR 70,107,36864
v_max3_f32 v120, v120, v6, v7
WL 8
MM 88,72,48
TR 72,108,32768
TR 74,108,36864
v_max_f32 v120, v120, v121
MM 92,76,48
TR 76,109,32768
TR 78,109,36864
DM 115,12,1024
MM 88,80,52
TR 80,110,32768
TR 82,110,36864
MM 92,84,52
WL 12
TR 84,111,32768
TR 86,111,36864
WL 8
s_add_u32 s43, s41, 49152
v_add_u32 v122, s43, v118
ds_write_b128 v122, a[48:51] offset:0
ds_write_b128 v122, a[52:55] offset:1024
ds_write_b128 v122, a[56:59] offset:57344
ds_write_b128 v122, a[60:63] offset:58368
v_cmp_lt_f32 vcc, s51, v120
s_cbranch_vccnz L_tramp1_27
L_back1_27:
EX 0
EX 1
EX 2
EX 3
EX 4
EX 5
EX 6
EX 7
CV 96,0
CV 97,2
CV 98,4
CV 99,6
WB 12
s_barrier
MM 8,56,96
s_mov_b32 s48, 237568
s_add_u32 m0, s41, 0
KR 56,100,8192
AD 0
DM 112,8,0
MM 12,60,96
KR 60,100,12288
AD 1
MM 16,64,96
KR 64,101,8192
AD 2
MM 20,68,96
KR 68,101,12288
AD 3
MM 24,72,96
KR 72,102,8192
AD 4
MM 28,76,96
KR 76,102,12288
AD 5
MM 32,80,96
KR 80,103,8192
AD 6
DM 113,8,1024
MM 36,84,96
KR 84,103,12288
AD 7
WL 4
MN 0,56,40
TR 56,104,0
TR 58,104,4096
MN 4,60,40
s_mov_b32 s48, 229376
s_add_u32 m0, s41, 90112
TR 60,105,0
TR 62,105,4096
DM 114,12,0
v_max3_f32 v120, v88, v89, v90
MM 0,64,44
TR 64,106,0
TR 66,106,4096
v_max3_f32 v121, v91, v92, v93
MM 4,68,44
TR 68,107,0
TR 70,107,4096
v_max3_f32 v120, v120, v94, v95
WL 8
MM 0,72,48
TR 72,108,0
TR 74,108,4096
v_max_f32 v120, v120, v121
MM 4,76,48
TR 76,109,0
TR 78,109,4096
DM 115,12,1024
MM 0,80,52
TR 80,110,0
TR 82,110,4096
MM 4,84,52
WL 12
TR 84,111,0
TR 86,111,4096
v_cmp_lt_f32 vcc, s51, v120
s_cbranch_vccnz L_tramp1_28
L_back1_28:
EX 88
EX 89
EX 90
EX 91
EX 92
EX 93
EX 94
EX 95
CV 96,88
CV 97,90
CV 98,92
CV 99,94
WB 12
s_barrier
MM 8,56,96
s_mov_b32 s48, 245760
s_add_u32 m0, s41, 8192
KR 56,100,40960
AD 88
DM 112,8,0
MM 12,60,96
KR 60,100,45056
AD 89
MM 16,64,96
KR 64,101,40960
AD 90
MM 20,68,96
KR 68,101,45056
AD 91
MM 24,72,96
KR 72,102,40960
AD 92
MM 28,76,96
KR 76,102,45056
AD 93
MM 32,80,96
KR 80,103,40960
AD 94
DM 113,8,1024
MM 36,84,96
KR 84,103,45056
AD 95
WL 4
MN 88,56,40
TR 56,104,8192
TR 58,104,12288
MN 92,60,40
s_mov_b32 s48, 237568
s_add_u32 m0, s41, 57344
TR 60,105,8192
TR 62,105,12288
DM 114,12,0
v_max3_f32 v120, v0, v1, v2
MM 88,64,44
TR 64,106,8192
TR 66,106,12288
v_max3_f32 v121, v3, v4, v5
MM 92,68,44
TR 68,107,8192
TR 70,107,12288
v_max3_f32 v120, v120, v6, v7
WL 8
MM 88,72,48
TR 72,108,8192
TR 74,108,12288
v_max_f32 v120, v120, v121
MM 92,76,48
TR 76,109,8192
TR 78,109,12288
DM 115,12,1024
MM 88,80,52
TR 80,110,8192
TR 82,110,12288
MM 92,84,52
WL 12
TR 84,111,8192
TR 86,111,12288
v_cmp_lt_f32 vcc, s51, v120
s_cbranch_vccnz L_tramp1_29
L_back1_29:
EX 0
EX 1
EX 2
EX 3
EX 4
EX 5
EX 6
EX 7
CV 96,0
CV 97,2
CV 98,4
CV 99,6
WL 0
s_barrier
MM 8,56,96
KR 56,100,16384
AD 0
MM 12,60,96
KR 60,100,20480
AD 1
MM 16,64,96
KR 64,101,16384
AD 2
MM 20,68,96
KR 68,101,20480
AD 3
MM 24,72,96
KR 72,102,16384
AD 4
MM 28,76,96
KR 76,102,20480
AD 5
MM 32,80,96
KR 80,103,16384
AD 6
MM 36,84,96
KR 84,103,20480
AD 7
WL 4
MN 0,56,40
TR 56,104,40960
TR 58,104,45056
MN 4,60,40
TR 60,105,40960
TR 62,105,45056
v_max3_f32 v120, v88, v89, v90
MM 0,64,44
TR 64,106,40960
TR 66,106,45056
v_max3_f32 v121, v91, v92, v93
MM 4,68,44
TR 68,107,40960
TR 70,107,45056
v_max3_f32 v120, v120, v94, v95
WL 8
MM 0,72,48
TR 72,108,40960
TR 74,108,45056
v_max_f32 v120, v120, v121
MM 4,76,48
TR 76,109,40960
TR 78,109,45056
MM 0,80,52
TR 80,110,40960
TR 82,110,45056
MM 4,84,52
WL 12
TR 84,111,40960
TR 86,111,45056
v_cmp_lt_f32 vcc, s51, v120
s_cbranch_vccnz L_tramp1_30
L_back1_30:
EX 88
EX 89
EX 90
EX 91
EX 92
EX 93
EX 94
EX 95
CV 96,88
CV 97,90
CV 98,92
CV 99,94
WB 12
s_barrier
MM 8,56,96
s_mov_b32 s48, 253952
s_add_u32 m0, s41, 16384
KR 56,100,24576
AD 88
DM 112,8,0
MM 12,60,96
KR 60,100,28672
AD 89
MM 16,64,96
KR 64,101,24576
AD 90
MM 20,68,96
KR 68,101,28672
AD 91
MM 24,72,96
KR 72,102,24576
AD 92
MM 28,76,96
KR 76,102,28672
AD 93
MM 32,80,96
KR 80,103,24576
AD 94
DM 113,8,1024
MM 36,84,96
KR 84,103,28672
AD 95
WL 4
MN 88,56,40
TR 56,104,16384
TR 58,104,20480
MN 92,60,40
s_mov_b32 s48, 245760
s_add_u32 m0, s41, 65536
TR 60,105,16384
TR 62,105,20480
DM 114,12,0
v_max3_f32 v120, v0, v1, v2
MM 88,64,44
TR 64,106,16384
TR 66,106,20480
v_max3_f32 v121, v3, v4, v5
MM 92,68,44
TR 68,107,16384
TR 70,107,20480
v_max3_f32 v120, v120, v6, v7
WL 8
MM 88,72,48
TR 72,108,16384
TR 74,108,20480
v_max_f32 v120, v120, v121
MM 92,76,48
TR 76,109,16384
TR 78,109,20480
DM 115,12,1024
MM 88,80,52
TR 80,110,16384
TR 82,110,20480
MM 92,84,52
WL 12
TR 84,111,16384
TR 86,111,20480
WL 8
s_add_u32 s43, s41, 40960
v_add_u32 v122, s43, v118
ds_write_b128 v122, a[64:67] offset:0
ds_write_b128 v122, a[68:71] offset:1024
ds_write_b128 v122, a[72:75] offset:57344
ds_write_b128 v122, a[76:79] offset:58368
v_cmp_lt_f32 vcc, s51, v120
s_cbranch_vccnz L_tramp1_31
L_back1_31:
EX 0
EX 1
EX 2
EX 3
EX 4
EX 5
EX 6
EX 7
CV 96,0
CV 97,2
CV 98,4
CV 99,6
WB 12
s_barrier
MM 8,56,96
s_mov_b32 s48, 262144
s_add_u32 m0, s41, 24576
KR 56,100,32768
AD 0
DM 112,8,0
MM 12,60,96
KR 60,100,36864
AD 1
MM 16,64,96
KR 64,101,32768
AD 2
MM 20,68,96
KR 68,101,36864
AD 3
MM 24,72,96
KR 72,102,32768
AD 4
MM 28,76,96
KR 76,102,36864
AD 5
MM 32,80,96
KR 80,103,32768
AD 6
DM 113,8,1024
MM 36,84,96
KR 84,103,36864
AD 7
WL 4
MN 0,56,40
TR 56,104,24576
TR 58,104,28672
MN 4,60,40
s_mov_b32 s48, 253952
s_add_u32 m0, s41, 73728
TR 60,105,24576
TR 62,105,28672
DM 114,12,0
v_max3_f32 v120, v88, v89, v90
MM 0,64,44
TR 64,106,24576
TR 66,106,28672
v_max3_f32 v121, v91, v92, v93
MM 4,68,44
TR 68,107,24576
TR 70,107,28672
v_max3_f32 v120, v120, v94, v95
WL 8
MM 0,72,48
TR 72,108,24576
TR 74,108,28672
v_max_f32 v120, v120, v121
MM 4,76,48
TR 76,109,24576
TR 78,109,28672
DM 115,12,1024
MM 0,80,52
TR 80,110,24576
TR 82,110,28672
MM 4,84,52
WL 12
TR 84,111,24576
TR 86,111,28672
v_cmp_lt_f32 vcc, s51, v120
s_cbranch_vccnz L_tramp1_32
L_back1_32:
EX 88
EX 89
EX 90
EX 91
EX 92
EX 93
EX 94
EX 95
CV 96,88
CV 97,90
CV 98,92
CV 99,94
WB 12
s_barrier
MM 8,56,96
KR 56,100,49152
AD 88
MM 12,60,96
KR 60,100,53248
AD 89
MM 16,64,96
KR 64,101,49152
AD 90
MM 20,68,96
KR 68,101,53248
AD 91
MM 24,72,96
KR 72,102,49152
AD 92
MM 28,76,96
KR 76,102,53248
AD 93
MM 32,80,96
KR 80,103,49152
AD 94
MM 36,84,96
KR 84,103,53248
AD 95
WL 4
MN 88,56,40
TR 56,104,32768
TR 58,104,36864
MN 92,60,40
TR 60,105,32768
TR 62,105,36864
v_max3_f32 v120, v0, v1, v2
MM 88,64,44
TR 64,106,32768
TR 66,106,36864
v_max3_f32 v121, v3, v4, v5
MM 92,68,44
TR 68,107,32768
TR 70,107,36864
v_max3_f32 v120, v120, v6, v7
WL 8
MM 88,72,48
TR 72,108,32768
TR 74,108,36864
v_max_f32 v120, v120, v121
MM 92,76,48
TR 76,109,32768
TR 78,109,36864
MM 88,80,52
TR 80,110,32768
TR 82,110,36864
MM 92,84,52
WL 12
TR 84,111,32768
TR 86,111,36864
v_cmp_lt_f32 vcc, s51, v120
s_cbranch_vccnz L_tramp1_33
L_back1_33:
EX 0
EX 1
EX 2
EX 3
EX 4
EX 5
EX 6
EX 7
CV 96,0
CV 97,2
CV 98,4
CV 99,6
WL 0
s_barrier
MM 8,56,96
KR 56,100,0
AD 0
MM 12,60,96
KR 60,100,4096
AD 1
MM 16,64,96
KR 64,101,0
AD 2
MM 20,68,96
KR 68,101,4096
AD 3
MM 24,72,96
KR 72,102,0
AD 4
MM 28,76,96
KR 76,102,4096
AD 5
MM 32,80,96
KR 80,103,0
AD 6
MM 36,84,96
KR 84,103,4096
AD 7
WL 4
MN 0,56,40
TR 56,104,49152
TR 58,104,53248
MN 4,60,40
TR 60,105,49152
TR 62,105,53248
v_max3_f32 v120, v88, v89, v90
MM 0,64,44
TR 64,106,49152
TR 66,106,53248
v_max3_f32 v121, v91, v92, v93
MM 4,68,44
TR 68,107,49152
TR 70,107,53248
v_max3_f32 v120, v120, v94, v95
WL 8
MM 0,72,48
TR 72,108,49152
TR 74,108,53248
v_max_f32 v120, v120, v121
MM 4,76,48
TR 76,109,49152
TR 78,109,53248
MM 0,80,52
TR 80,110,49152
TR 82,110,53248
MM 4,84,52
WL 12
TR 84,111,49152
TR 86,111,53248
v_cmp_lt_f32 vcc, s51, v120
s_cbranch_vccnz L_tramp1_34
L_back1_34:
EX 88
EX 89
EX 90
EX 91
EX 92
EX 93
EX 94
EX 95
CV 96,88
CV 97,90
CV 98,92
CV 99,94
WB 8
s_barrier
MM 8,56,96
s_mov_b32 s48, 270336
s_add_u32 m0, s41, 32768
KR 56,100,8192
AD 88
DM 112,8,0
MM 12,60,96
KR 60,100,12288
AD 89
MM 16,64,96
KR 64,101,8192
AD 90
MM 20,68,96
KR 68,101,12288
AD 91
MM 24,72,96
KR 72,102,8192
AD 92
MM 28,76,96
KR 76,102,12288
AD 93
MM 32,80,96
KR 80,103,8192
AD 94
DM 113,8,1024
MM 36,84,96
KR 84,103,12288
AD 95
WL 4
MN 88,56,40
TR 56,104,0
TR 58,104,4096
MN 92,60,40
TR 60,105,0
TR 62,105,4096
v_max3_f32 v120, v0, v1, v2
MM 88,64,44
TR 64,106,0
TR 66,106,4096
v_max3_f32 v121, v3, v4, v5
MM 92,68,44
TR 68,107,0
TR 70,107,4096
v_max3_f32 v120, v120, v6, v7
WL 8
MM 88,72,48
TR 72,108,0
TR 74,108,4096
v_max_f32 v120, v120, v121
MM 92,76,48
TR 76,109,0
TR 78,109,4096
MM 88,80,52
TR 80,110,0
TR 82,110,4096
MM 92,84,52
WL 12
TR 84,111,0
TR 86,111,4096
v_cmp_lt_f32 vcc, s51, v120
s_cbranch_vccnz L_tramp1_35
L_back1_35:
EX 0
EX 1
EX 2
EX 3
EX 4
EX 5
EX 6
EX 7
CV 96,0
CV 97,2
CV 98,4
CV 99,6
WB 6
s_barrier
MM 8,56,96
s_mov_b32 s48, 262144
s_add_u32 m0, s41, 81920
KR 56,100,16384
AD 0
DM 114,12,0
MM 12,60,96
KR 60,100,20480
AD 1
MM 16,64,96
KR 64,101,16384
AD 2
MM 20,68,96
KR 68,101,20480
AD 3
MM 24,72,96
KR 72,102,16384
AD 4
MM 28,76,96
KR 76,102,20480
AD 5
MM 32,80,96
KR 80,103,16384
AD 6
DM 115,12,1024
MM 36,84,96
KR 84,103,20480
AD 7
WL 4
MN 0,56,40
TR 56,104,8192
TR 58,104,12288
MN 4,60,40
s_mov_b32 s48, 278528
s_add_u32 m0, s41, 0
TR 60,105,8192
TR 62,105,12288
DM 112,8,0
v_max3_f32 v120, v88, v89, v90
MM 0,64,44
TR 64,106,8192
TR 66,106,12288
v_max3_f32 v121, v91, v92, v93
MM 4,68,44
TR 68,107,8192
TR 70,107,12288
v_max3_f32 v120, v120, v94, v95
WL 8
MM 0,72,48
TR 72,108,8192
TR 74,108,12288
v_max_f32 v120, v120, v121
MM 4,76,48
TR 76,109,8192
TR 78,109,12288
DM 113,8,1024
MM 0,80,52
TR 80,110,8192
TR 82,110,12288
MM 4,84,52
WL 12
TR 84,111,8192
TR 86,111,12288
v_cmp_lt_f32 vcc, s51, v120
s_cbranch_vccnz L_tramp1_36
L_back1_36:
EX 88
EX 89
EX 90
EX 91
EX 92
EX 93
EX 94
EX 95
CV 96,88
CV 97,90
CV 98,92
CV 99,94
WB 6
s_barrier
MM 8,56,96
s_mov_b32 s48, 270336
s_add_u32 m0, s41, 90112
KR 56,100,40960
AD 88
DM 114,12,0
MM 12,60,96
KR 60,100,45056
AD 89
MM 16,64,96
KR 64,101,40960
AD 90
MM 20,68,96
KR 68,101,45056
AD 91
MM 24,72,96
KR 72,102,40960
AD 92
MM 28,76,96
KR 76,102,45056
AD 93
MM 32,80,96
KR 80,103,40960
AD 94
DM 115,12,1024
MM 36,84,96
KR 84,103,45056
AD 95
WL 4
MN 88,56,40
TR 56,104,16384
TR 58,104,20480
MN 92,60,40
s_mov_b32 s48, 286720
s_add_u32 m0, s41, 8192
TR 60,105,16384
TR 62,105,20480
DM 112,8,0
v_max3_f32 v120, v0, v1, v2
MM 88,64,44
TR 64,106,16384
TR 66,106,20480
v_max3_f32 v121, v3, v4, v5
MM 92,68,44
TR 68,107,16384
TR 70,107,20480
v_max3_f32 v120, v120, v6, v7
WL 8
MM 88,72,48
TR 72,108,16384
TR 74,108,20480
v_max_f32 v120, v120, v121
MM 92,76,48
TR 76,109,16384
TR 78,109,20480
DM 113,8,1024
MM 88,80,52
TR 80,110,16384
TR 82,110,20480
MM 92,84,52
WL 12
TR 84,111,16384
TR 86,111,20480
v_cmp_lt_f32 vcc, s51, v120
s_cbranch_vccnz L_tramp1_37
L_back1_37:
EX 0
EX 1
EX 2
EX 3
EX 4
EX 5
EX 6
EX 7
CV 96,0
CV 97,2
CV 98,4
CV 99,6
WL 0
s_barrier
MM 8,56,96
KR 56,100,24576
AD 0
MM 12,60,96
KR 60,100,28672
AD 1
MM 16,64,96
KR 64,101,24576
AD 2
MM 20,68,96
KR 68,101,28672
AD 3
MM 24,72,96
KR 72,102,24576
AD 4
MM 28,76,96
KR 76,102,28672
AD 5
MM 32,80,96
KR 80,103,24576
AD 6
MM 36,84,96
KR 84,103,28672
AD 7
WL 4
MN 0,56,40
TR 56,104,40960
TR 58,104,45056
MN 4,60,40
TR 60,105,40960
TR 62,105,45056
v_max3_f32 v120, v88, v89, v90
MM 0,64,44
TR 64,106,40960
TR 66,106,45056
v_max3_f32 v121, v91, v92, v93
MM 4,68,44
TR 68,107,40960
TR 70,107,45056
v_max3_f32 v120, v120, v94, v95
WL 8
MM 0,72,48
TR 72,108,40960
TR 74,108,45056
v_max_f32 v120, v120, v121
MM 4,76,48
TR 76,109,40960
TR 78,109,45056
MM 0,80,52
TR 80,110,40960
TR 82,110,45056
MM 4,84,52
WL 12
TR 84,111,40960
TR 86,111,45056
v_cmp_lt_f32 vcc, s51, v120
s_cbranch_vccnz L_tramp1_38
L_back1_38:
EX 88
EX 89
EX 90
EX 91
EX 92
EX 93
EX 94
EX 95
CV 96,88
CV 97,90
CV 98,92
CV 99,94
WB 6
s_barrier
MM 8,56,96
s_mov_b32 s48, 278528
s_add_u32 m0, s41, 57344
KR 56,100,32768
AD 88
DM 114,12,0
MM 12,60,96
KR 60,100,36864
AD 89
MM 16,64,96
KR 64,101,32768
AD 90
MM 20,68,96
KR 68,101,36864
AD 91
MM 24,72,96
KR 72,102,32768
AD 92
MM 28,76,96
KR 76,102,36864
AD 93
MM 32,80,96
KR 80,103,32768
AD 94
DM 115,12,1024
MM 36,84,96
KR 84,103,36864
AD 95
WL 4
MN 88,56,40
TR 56,104,24576
TR 58,104,28672
MN 92,60,40
s_mov_b32 s48, 294912
s_add_u32 m0, s41, 16384
TR 60,105,24576
TR 62,105,28672
DM 112,8,0
v_max3_f32 v120, v0, v1, v2
MM 88,64,44
TR 64,106,24576
TR 66,106,28672
v_max3_f32 v121, v3, v4, v5
MM 92,68,44
TR 68,107,24576
TR 70,107,28672
v_max3_f32 v120, v120, v6, v7
WL 8
MM 88,72,48
TR 72,108,24576
TR 74,108,28672
v_max_f32 v120, v120, v121
MM 92,76,48
TR 76,109,24576
TR 78,109,28672
DM 113,8,1024
MM 88,80,52
TR 80,110,24576
TR 82,110,28672
MM 92,84,52
WL 12
TR 84,111,24576
TR 86,111,28672
v_cmp_lt_f32 vcc, s51, v120
s_cbranch_vccnz L_tramp1_39
L_back1_39:
EX 0
EX 1
EX 2
EX 3
EX 4
EX 5
EX 6
EX 7
CV 96,0
CV 97,2
CV 98,4
CV 99,6
WB 6
s_barrier
MM 8,56,96
s_mov_b32 s48, 286720
s_add_u32 m0, s41, 65536
KR 56,100,0
AD 0
DM 114,12,0
MM 12,60,96
KR 60,100,4096
AD 1
MM 16,64,96
KR 64,101,0
AD 2
MM 20,68,96
KR 68,101,4096
AD 3
MM 24,72,96
KR 72,102,0
AD 4
MM 28,76,96
KR 76,102,4096
AD 5
MM 32,80,96
KR 80,103,0
AD 6
DM 115,12,1024
MM 36,84,96
KR 84,103,4096
AD 7
s_cmp_eq_u32 s3, 0
s_cbranch_scc1 L_btramp1_39_0
L_bback1_39_0:
WL 4
MN 0,56,40
TR 56,104,32768
TR 58,104,36864
MN 4,60,40
s_mov_b32 s48, 303104
s_add_u32 m0, s41, 24576
TR 60,105,32768
TR 62,105,36864
DM 112,8,0
v_max3_f32 v120, v88, v89, v90
MM 0,64,44
TR 64,106,32768
TR 66,106,36864
v_max3_f32 v121, v91, v92, v93
MM 4,68,44
TR 68,107,32768
TR 70,107,36864
v_max3_f32 v120, v120, v94, v95
WL 8
MM 0,72,48
TR 72,108,32768
TR 74,108,36864
v_max_f32 v120, v120, v121
MM 4,76,48
TR 76,109,32768
TR 78,109,36864
DM 113,8,1024
MM 0,80,52
TR 80,110,32768
TR 82,110,36864
MM 4,84,52
WL 12
TR 84,111,32768
TR 86,111,36864
v_cmp_lt_f32 vcc, s51, v120
s_cbranch_vccnz L_tramp1_40
L_back1_40:
EX 88
EX 89
EX 90
EX 91
EX 92
EX 93
EX 94
EX 95
CV 96,88
CV 97,90
CV 98,92
CV 99,94
WB 6
s_barrier
MM 8,56,96
s_mov_b32 s48, 294912
s_add_u32 m0, s41, 73728
KR 56,100,8192
AD 88
DM 114,12,0
MM 12,60,96
KR 60,100,12288
AD 89
MM 16,64,96
KR 64,101,8192
AD 90
MM 20,68,96
KR 68,101,12288
AD 91
MM 24,72,96
KR 72,102,8192
AD 92
MM 28,76,96
KR 76,102,12288
AD 93
MM 32,80,96
KR 80,103,8192
AD 94
DM 115,12,1024
MM 36,84,96
KR 84,103,12288
AD 95
WL 4
MN 88,56,40
TR 56,104,0
TR 58,104,4096
MN 92,60,40
s_mov_b32 s48, 311296
s_add_u32 m0, s41, 32768
TR 60,105,0
TR 62,105,4096
DM 112,8,0
v_max3_f32 v120, v0, v1, v2
MM 88,64,44
TR 64,106,0
TR 66,106,4096
v_max3_f32 v121, v3, v4, v5
MM 92,68,44
TR 68,107,0
TR 70,107,4096
v_max3_f32 v120, v120, v6, v7
WL 8
MM 88,72,48
TR 72,108,0
TR 74,108,4096
v_max_f32 v120, v120, v121
MM 92,76,48
TR 76,109,0
TR 78,109,4096
DM 113,8,1024
MM 88,80,52
TR 80,110,0
TR 82,110,4096
MM 92,84,52
WL 12
TR 84,111,0
TR 86,111,4096
v_cmp_lt_f32 vcc, s51, v120
s_cbranch_vccnz L_tramp1_41
L_back1_41:
EX 0
EX 1
EX 2
EX 3
EX 4
EX 5
EX 6
EX 7
CV 96,0
CV 97,2
CV 98,4
CV 99,6
WB 6
s_barrier
MM 8,56,96
s_mov_b32 s48, 303104
s_add_u32 m0, s41, 81920
KR 56,100,16384
AD 0
DM 114,12,0
MM 12,60,96
KR 60,100,20480
AD 1
MM 16,64,96
KR 64,101,16384
AD 2
MM 20,68,96
KR 68,101,20480
AD 3
MM 24,72,96
KR 72,102,16384
AD 4
MM 28,76,96
KR 76,102,20480
AD 5
MM 32,80,96
KR 80,103,16384
AD 6
DM 115,12,1024
MM 36,84,96
KR 84,103,20480
AD 7
WL 4
MN 0,56,40
TR 56,104,8192
TR 58,104,12288
MN 4,60,40
s_mov_b32 s48, 319488
s_add_u32 m0, s41, 0
TR 60,105,8192
TR 62,105,12288
DM 112,8,0
v_max3_f32 v120, v88, v89, v90
MM 0,64,44
TR 64,106,8192
TR 66,106,12288
v_max3_f32 v121, v91, v92, v93
MM 4,68,44
TR 68,107,8192
TR 70,107,12288
v_max3_f32 v120, v120, v94, v95
WL 8
MM 0,72,48
TR 72,108,8192
TR 74,108,12288
v_max_f32 v120, v120, v121
MM 4,76,48
TR 76,109,8192
TR 78,109,12288
DM 113,8,1024
MM 0,80,52
TR 80,110,8192
TR 82,110,12288
MM 4,84,52
WL 12
TR 84,111,8192
TR 86,111,12288
v_cmp_lt_f32 vcc, s51, v120
s_cbranch_vccnz L_tramp1_42
L_back1_42:
EX 88
EX 89
EX 90
EX 91
EX 92
EX 93
EX 94
EX 95
CV 96,88
CV 97,90
CV 98,92
CV 99,94
WB 6
s_barrier
MM 8,56,96
s_mov_b32 s48, 311296
s_add_u32 m0, s41, 90112
KR 56,100,24576
AD 88
DM 114,12,0
MM 12,60,96
KR 60,100,28672
AD 89
MM 16,64,96
KR 64,101,24576
AD 90
MM 20,68,96
KR 68,101,28672
AD 91
MM 24,72,96
KR 72,102,24576
AD 92
MM 28,76,96
KR 76,102,28672
AD 93
MM 32,80,96
KR 80,103,24576
AD 94
DM 115,12,1024
MM 36,84,96
KR 84,103,28672
AD 95
WL 4
MN 88,56,40
TR 56,104,16384
TR 58,104,20480
MN 92,60,40
s_mov_b32 s48, 327680
s_add_u32 m0, s41, 8192
TR 60,105,16384
TR 62,105,20480
DM 112,8,0
v_max3_f32 v120, v0, v1, v2
MM 88,64,44
TR 64,106,16384
TR 66,106,20480
v_max3_f32 v121, v3, v4, v5
MM 92,68,44
TR 68,107,16384
TR 70,107,20480
v_max3_f32 v120, v120, v6, v7
WL 8
MM 88,72,48
TR 72,108,16384
TR 74,108,20480
v_max_f32 v120, v120, v121
MM 92,76,48
TR 76,109,16384
TR 78,109,20480
DM 113,8,1024
MM 88,80,52
TR 80,110,16384
TR 82,110,20480
MM 92,84,52
WL 12
TR 84,111,16384
TR 86,111,20480
v_cmp_lt_f32 vcc, s51, v120
s_cbranch_vccnz L_tramp1_43
L_back1_43:
EX 0
EX 1
EX 2
EX 3
EX 4
EX 5
EX 6
EX 7
CV 96,0
CV 97,2
CV 98,4
CV 99,6
WB 6
s_barrier
MM 8,56,96
s_mov_b32 s48, 319488
s_add_u32 m0, s41, 57344
KR 56,100,32768
AD 0
DM 114,12,0
MM 12,60,96
KR 60,100,36864
AD 1
MM 16,64,96
KR 64,101,32768
AD 2
MM 20,68,96
KR 68,101,36864
AD 3
MM 24,72,96
KR 72,102,32768
AD 4
MM 28,76,96
KR 76,102,36864
AD 5
MM 32,80,96
KR 80,103,32768
AD 6
DM 115,12,1024
MM 36,84,96
KR 84,103,36864
AD 7
WL 4
MN 0,56,40
TR 56,104,24576
TR 58,104,28672
MN 4,60,40
s_mov_b32 s48, 335872
s_add_u32 m0, s41, 16384
TR 60,105,24576
TR 62,105,28672
DM 112,8,0
v_max3_f32 v120, v88, v89, v90
MM 0,64,44
TR 64,106,24576
TR 66,106,28672
v_max3_f32 v121, v91, v92, v93
MM 4,68,44
TR 68,107,24576
TR 70,107,28672
v_max3_f32 v120, v120, v94, v95
WL 8
MM 0,72,48
TR 72,108,24576
TR 74,108,28672
v_max_f32 v120, v120, v121
MM 4,76,48
TR 76,109,24576
TR 78,109,28672
DM 113,8,1024
MM 0,80,52
TR 80,110,24576
TR 82,110,28672
MM 4,84,52
WL 12
TR 84,111,24576
TR 86,111,28672
v_cmp_lt_f32 vcc, s51, v120
s_cbranch_vccnz L_tramp1_44
L_back1_44:
EX 88
EX 89
EX 90
EX 91
EX 92
EX 93
EX 94
EX 95
CV 96,88
CV 97,90
CV 98,92
CV 99,94
WB 6
s_barrier
MM 8,56,96
s_mov_b32 s48, 327680
s_add_u32 m0, s41, 65536
KR 56,100,0
AD 88
DM 114,12,0
MM 12,60,96
KR 60,100,4096
AD 89
MM 16,64,96
KR 64,101,0
AD 90
MM 20,68,96
KR 68,101,4096
AD 91
MM 24,72,96
KR 72,102,0
AD 92
MM 28,76,96
KR 76,102,4096
AD 93
MM 32,80,96
KR 80,103,0
AD 94
DM 115,12,1024
MM 36,84,96
KR 84,103,4096
AD 95
s_cmp_eq_u32 s3, 1
s_cbranch_scc1 L_btramp1_44_0
L_bback1_44_0:
WL 4
MN 88,56,40
TR 56,104,32768
TR 58,104,36864
MN 92,60,40
s_mov_b32 s48, 344064
s_add_u32 m0, s41, 24576
TR 60,105,32768
TR 62,105,36864
DM 112,8,0
v_max3_f32 v120, v0, v1, v2
MM 88,64,44
TR 64,106,32768
TR 66,106,36864
v_max3_f32 v121, v3, v4, v5
MM 92,68,44
TR 68,107,32768
TR 70,107,36864
v_max3_f32 v120, v120, v6, v7
WL 8
MM 88,72,48
TR 72,108,32768
TR 74,108,36864
v_max_f32 v120, v120, v121
MM 92,76,48
TR 76,109,32768
TR 78,109,36864
DM 113,8,1024
MM 88,80,52
TR 80,110,32768
TR 82,110,36864
MM 92,84,52
WL 12
TR 84,111,32768
TR 86,111,36864
v_cmp_lt_f32 vcc, s51, v120
s_cbranch_vccnz L_tramp1_45
L_back1_45:
EX 0
EX 1
EX 2
EX 3
EX 4
EX 5
EX 6
EX 7
CV 96,0
CV 97,2
CV 98,4
CV 99,6
WB 6
s_barrier
MM 8,56,96
s_mov_b32 s48, 335872
s_add_u32 m0, s41, 73728
KR 56,100,8192
AD 0
DM 114,12,0
MM 12,60,96
KR 60,100,12288
AD 1
MM 16,64,96
KR 64,101,8192
AD 2
MM 20,68,96
KR 68,101,12288
AD 3
MM 24,72,96
KR 72,102,8192
AD 4
MM 28,76,96
KR 76,102,12288
AD 5
MM 32,80,96
KR 80,103,8192
AD 6
DM 115,12,1024
MM 36,84,96
KR 84,103,12288
AD 7
WL 4
MN 0,56,40
TR 56,104,0
TR 58,104,4096
MN 4,60,40
s_mov_b32 s48, 352256
s_add_u32 m0, s41, 32768
TR 60,105,0
TR 62,105,4096
DM 112,8,0
v_max3_f32 v120, v88, v89, v90
MM 0,64,44
TR 64,106,0
TR 66,106,4096
v_max3_f32 v121, v91, v92, v93
MM 4,68,44
TR 68,107,0
TR 70,107,4096
v_max3_f32 v120, v120, v94, v95
WL 8
MM 0,72,48
TR 72,108,0
TR 74,108,4096
v_max_f32 v120, v120, v121
MM 4,76,48
TR 76,109,0
TR 78,109,4096
DM 113,8,1024
MM 0,80,52
TR 80,110,0
TR 82,110,4096
MM 4,84,52
WL 12
TR 84,111,0
TR 86,111,4096
v_cmp_lt_f32 vcc, s51, v120
s_cbranch_vccnz L_tramp1_46
L_back1_46:
EX 88
EX 89
EX 90
EX 91
EX 92
EX 93
EX 94
EX 95
CV 96,88
CV 97,90
CV 98,92
CV 99,94
WB 6
s_barrier
MM 8,56,96
s_mov_b32 s48, 344064
s_add_u32 m0, s41, 81920
KR 56,100,16384
AD 88
DM 114,12,0
MM 12,60,96
KR 60,100,20480
AD 89
MM 16,64,96
KR 64,101,16384
AD 90
MM 20,68,96
KR 68,101,20480
AD 91
MM 24,72,96
KR 72,102,16384
AD 92
MM 28,76,96
KR 76,102,20480
AD 93
MM 32,80,96
KR 80,103,16384
AD 94
DM 115,12,1024
MM 36,84,96
KR 84,103,20480
AD 95
WL 4
MN 88,56,40
TR 56,104,8192
TR 58,104,12288
MN 92,60,40
s_mov_b32 s48, 360448
s_add_u32 m0, s41, 0
TR 60,105,8192
TR 62,105,12288
DM 112,8,0
v_max3_f32 v120, v0, v1, v2
MM 88,64,44
TR 64,106,8192
TR 66,106,12288
v_max3_f32 v121, v3, v4, v5
MM 92,68,44
TR 68,107,8192
TR 70,107,12288
v_max3_f32 v120, v120, v6, v7
WL 8
MM 88,72,48
TR 72,108,8192
TR 74,108,12288
v_max_f32 v120, v120, v121
MM 92,76,48
TR 76,109,8192
TR 78,109,12288
DM 113,8,1024
MM 88,80,52
TR 80,110,8192
TR 82,110,12288
MM 92,84,52
WL 12
TR 84,111,8192
TR 86,111,12288
v_cmp_lt_f32 vcc, s51, v120
s_cbranch_vccnz L_tramp1_47
L_back1_47:
EX 0
EX 1
EX 2
EX 3
EX 4
EX 5
EX 6
EX 7
CV 96,0
CV 97,2
CV 98,4
CV 99,6
WB 6
s_barrier
MM 8,56,96
s_mov_b32 s48, 352256
s_add_u32 m0, s41, 90112
KR 56,100,24576
AD 0
DM 114,12,0
MM 12,60,96
KR 60,100,28672
AD 1
MM 16,64,96
KR 64,101,24576
AD 2
MM 20,68,96
KR 68,101,28672
AD 3
MM 24,72,96
KR 72,102,24576
AD 4
MM 28,76,96
KR 76,102,28672
AD 5
MM 32,80,96
KR 80,103,24576
AD 6
DM 115,12,1024
MM 36,84,96
KR 84,103,28672
AD 7
WL 4
MN 0,56,40
TR 56,104,16384
TR 58,104,20480
MN 4,60,40
s_mov_b32 s48, 368640
s_add_u32 m0, s41, 8192
TR 60,105,16384
TR 62,105,20480
DM 112,8,0
v_max3_f32 v120, v88, v89, v90
MM 0,64,44
TR 64,106,16384
TR 66,106,20480
v_max3_f32 v121, v91, v92, v93
MM 4,68,44
TR 68,107,16384
TR 70,107,20480
v_max3_f32 v120, v120, v94, v95
WL 8
MM 0,72,48
TR 72,108,16384
TR 74,108,20480
v_max_f32 v120, v120, v121
MM 4,76,48
TR 76,109,16384
TR 78,109,20480
DM 113,8,1024
MM 0,80,52
TR 80,110,16384
TR 82,110,20480
MM 4,84,52
WL 12
TR 84,111,16384
TR 86,111,20480
v_cmp_lt_f32 vcc, s51, v120
s_cbranch_vccnz L_tramp1_48
L_back1_48:
EX 88
EX 89
EX 90
EX 91
EX 92
EX 93
EX 94
EX 95
CV 96,88
CV 97,90
CV 98,92
CV 99,94
WB 6
s_barrier
MM 8,56,96
s_mov_b32 s48, 360448
s_add_u32 m0, s41, 57344
KR 56,100,32768
AD 88
DM 114,12,0
MM 12,60,96
KR 60,100,36864
AD 89
MM 16,64,96
KR 64,101,32768
AD 90
MM 20,68,96
KR 68,101,36864
AD 91
MM 24,72,96
KR 72,102,32768
AD 92
MM 28,76,96
KR 76,102,36864
AD 93
MM 32,80,96
KR 80,103,32768
AD 94
DM 115,12,1024
MM 36,84,96
KR 84,103,36864
AD 95
WL 4
MN 88,56,40
TR 56,104,24576
TR 58,104,28672
MN 92,60,40
s_mov_b32 s48, 376832
s_add_u32 m0, s41, 16384
TR 60,105,24576
TR 62,105,28672
DM 112,8,0
v_max3_f32 v120, v0, v1, v2
MM 88,64,44
TR 64,106,24576
TR 66,106,28672
v_max3_f32 v121, v3, v4, v5
MM 92,68,44
TR 68,107,24576
TR 70,107,28672
v_max3_f32 v120, v120, v6, v7
WL 8
MM 88,72,48
TR 72,108,24576
TR 74,108,28672
v_max_f32 v120, v120, v121
MM 92,76,48
TR 76,109,24576
TR 78,109,28672
DM 113,8,1024
MM 88,80,52
TR 80,110,24576
TR 82,110,28672
MM 92,84,52
WL 12
TR 84,111,24576
TR 86,111,28672
v_cmp_lt_f32 vcc, s51, v120
s_cbranch_vccnz L_tramp1_49
L_back1_49:
EX 0
EX 1
EX 2
EX 3
EX 4
EX 5
EX 6
EX 7
CV 96,0
CV 97,2
CV 98,4
CV 99,6
WB 6
s_barrier
MM 8,56,96
s_mov_b32 s48, 368640
s_add_u32 m0, s41, 65536
KR 56,100,0
AD 0
DM 114,12,0
MM 12,60,96
KR 60,100,4096
AD 1
MM 16,64,96
KR 64,101,0
AD 2
MM 20,68,96
KR 68,101,4096
AD 3
MM 24,72,96
KR 72,102,0
AD 4
MM 28,76,96
KR 76,102,4096
AD 5
MM 32,80,96
KR 80,103,0
AD 6
DM 115,12,1024
MM 36,84,96
KR 84,103,4096
AD 7
s_cmp_eq_u32 s3, 2
s_cbranch_scc1 L_btramp1_49_0
L_bback1_49_0:
WL 4
MN 0,56,40
TR 56,104,32768
TR 58,104,36864
MN 4,60,40
s_mov_b32 s48, 385024
s_add_u32 m0, s41, 24576
TR 60,105,32768
TR 62,105,36864
DM 112,8,0
v_max3_f32 v120, v88, v89, v90
MM 0,64,44
TR 64,106,32768
TR 66,106,36864
v_max3_f32 v121, v91, v92, v93
MM 4,68,44
TR 68,107,32768
TR 70,107,36864
v_max3_f32 v120, v120, v94, v95
WL 8
MM 0,72,48
TR 72,108,32768
TR 74,108,36864
v_max_f32 v120, v120, v121
MM 4,76,48
TR 76,109,32768
TR 78,109,36864
DM 113,8,1024
MM 0,80,52
TR 80,110,32768
TR 82,110,36864
MM 4,84,52
WL 12
TR 84,111,32768
TR 86,111,36864
v_cmp_lt_f32 vcc, s51, v120
s_cbranch_vccnz L_tramp1_50
L_back1_50:
EX 88
EX 89
EX 90
EX 91
EX 92
EX 93
EX 94
EX 95
CV 96,88
CV 97,90
CV 98,92
CV 99,94
WB 6
s_barrier
MM 8,56,96
s_mov_b32 s48, 376832
s_add_u32 m0, s41, 73728
KR 56,100,8192
AD 88
DM 114,12,0
MM 12,60,96
KR 60,100,12288
AD 89
MM 16,64,96
KR 64,101,8192
AD 90
MM 20,68,96
KR 68,101,12288
AD 91
MM 24,72,96
KR 72,102,8192
AD 92
MM 28,76,96
KR 76,102,12288
AD 93
MM 32,80,96
KR 80,103,8192
AD 94
DM 115,12,1024
MM 36,84,96
KR 84,103,12288
AD 95
WL 4
MN 88,56,40
TR 56,104,0
TR 58,104,4096
MN 92,60,40
s_mov_b32 s48, 393216
s_add_u32 m0, s41, 32768
TR 60,105,0
TR 62,105,4096
DM 112,8,0
v_max3_f32 v120, v0, v1, v2
MM 88,64,44
TR 64,106,0
TR 66,106,4096
v_max3_f32 v121, v3, v4, v5
MM 92,68,44
TR 68,107,0
TR 70,107,4096
v_max3_f32 v120, v120, v6, v7
WL 8
MM 88,72,48
TR 72,108,0
TR 74,108,4096
v_max_f32 v120, v120, v121
MM 92,76,48
TR 76,109,0
TR 78,109,4096
DM 113,8,1024
MM 88,80,52
TR 80,110,0
TR 82,110,4096
MM 92,84,52
WL 12
TR 84,111,0
TR 86,111,4096
v_cmp_lt_f32 vcc, s51, v120
s_cbranch_vccnz L_tramp1_51
L_back1_51:
EX 0
EX 1
EX 2
EX 3
EX 4
EX 5
EX 6
EX 7
CV 96,0
CV 97,2
CV 98,4
CV 99,6
WB 6
s_barrier
MM 8,56,96
s_mov_b32 s48, 385024
s_add_u32 m0, s41, 81920
KR 56,100,16384
AD 0
DM 114,12,0
MM 12,60,96
KR 60,100,20480
AD 1
MM 16,64,96
KR 64,101,16384
AD 2
MM 20,68,96
KR 68,101,20480
AD 3
MM 24,72,96
KR 72,102,16384
AD 4
MM 28,76,96
KR 76,102,20480
AD 5
MM 32,80,96
KR 80,103,16384
AD 6
DM 115,12,1024
MM 36,84,96
KR 84,103,20480
AD 7
WL 4
MN 0,56,40
TR 56,104,8192
TR 58,104,12288
MN 4,60,40
s_mov_b32 s48, 401408
s_add_u32 m0, s41, 0
TR 60,105,8192
TR 62,105,12288
DM 112,8,0
v_max3_f32 v120, v88, v89, v90
MM 0,64,44
TR 64,106,8192
TR 66,106,12288
v_max3_f32 v121, v91, v92, v93
MM 4,68,44
TR 68,107,8192
TR 70,107,12288
v_max3_f32 v120, v120, v94, v95
WL 8
MM 0,72,48
TR 72,108,8192
TR 74,108,12288
v_max_f32 v120, v120, v121
MM 4,76,48
TR 76,109,8192
TR 78,109,12288
DM 113,8,1024
MM 0,80,52
TR 80,110,8192
TR 82,110,12288
MM 4,84,52
WL 12
TR 84,111,8192
TR 86,111,12288
v_cmp_lt_f32 vcc, s51, v120
s_cbranch_vccnz L_tramp1_52
L_back1_52:
EX 88
EX 89
EX 90
EX 91
EX 92
EX 93
EX 94
EX 95
CV 96,88
CV 97,90
CV 98,92
CV 99,94
WB 6
s_barrier
MM 8,56,96
s_mov_b32 s48, 393216
s_add_u32 m0, s41, 90112
KR 56,100,24576
AD 88
DM 114,12,0
MM 12,60,96
KR 60,100,28672
AD 89
MM 16,64,96
KR 64,101,24576
AD 90
MM 20,68,96
KR 68,101,28672
AD 91
MM 24,72,96
KR 72,102,24576
AD 92
MM 28,76,96
KR 76,102,28672
AD 93
MM 32,80,96
KR 80,103,24576
AD 94
DM 115,12,1024
MM 36,84,96
KR 84,103,28672
AD 95
WL 4
MN 88,56,40
TR 56,104,16384
TR 58,104,20480
MN 92,60,40
s_mov_b32 s48, 409600
s_add_u32 m0, s41, 8192
TR 60,105,16384
TR 62,105,20480
DM 112,8,0
v_max3_f32 v120, v0, v1, v2
MM 88,64,44
TR 64,106,16384
TR 66,106,20480
v_max3_f32 v121, v3, v4, v5
MM 92,68,44
TR 68,107,16384
TR 70,107,20480
v_max3_f32 v120, v120, v6, v7
WL 8
MM 88,72,48
TR 72,108,16384
TR 74,108,20480
v_max_f32 v120, v120, v121
MM 92,76,48
TR 76,109,16384
TR 78,109,20480
DM 113,8,1024
MM 88,80,52
TR 80,110,16384
TR 82,110,20480
MM 92,84,52
WL 12
TR 84,111,16384
TR 86,111,20480
v_cmp_lt_f32 vcc, s51, v120
s_cbranch_vccnz L_tramp1_53
L_back1_53:
EX 0
EX 1
EX 2
EX 3
EX 4
EX 5
EX 6
EX 7
CV 96,0
CV 97,2
CV 98,4
CV 99,6
WB 6
s_barrier
MM 8,56,96
s_mov_b32 s48, 401408
s_add_u32 m0, s41, 57344
KR 56,100,32768
AD 0
DM 114,12,0
MM 12,60,96
KR 60,100,36864
AD 1
MM 16,64,96
KR 64,101,32768
AD 2
MM 20,68,96
KR 68,101,36864
AD 3
MM 24,72,96
KR 72,102,32768
AD 4
MM 28,76,96
KR 76,102,36864
AD 5
MM 32,80,96
KR 80,103,32768
AD 6
DM 115,12,1024
MM 36,84,96
KR 84,103,36864
AD 7
WL 4
MN 0,56,40
TR 56,104,24576
TR 58,104,28672
MN 4,60,40
s_mov_b32 s48, 417792
s_add_u32 m0, s41, 16384
TR 60,105,24576
TR 62,105,28672
DM 112,8,0
v_max3_f32 v120, v88, v89, v90
MM 0,64,44
TR 64,106,24576
TR 66,106,28672
v_max3_f32 v121, v91, v92, v93
MM 4,68,44
TR 68,107,24576
TR 70,107,28672
v_max3_f32 v120, v120, v94, v95
WL 8
MM 0,72,48
TR 72,108,24576
TR 74,108,28672
v_max_f32 v120, v120, v121
MM 4,76,48
TR 76,109,24576
TR 78,109,28672
DM 113,8,1024
MM 0,80,52
TR 80,110,24576
TR 82,110,28672
MM 4,84,52
WL 12
TR 84,111,24576
TR 86,111,28672
v_cmp_lt_f32 vcc, s51, v120
s_cbranch_vccnz L_tramp1_54
L_back1_54:
EX 88
EX 89
EX 90
EX 91
EX 92
EX 93
EX 94
EX 95
CV 96,88
CV 97,90
CV 98,92
CV 99,94
WB 6
s_barrier
MM 8,56,96
s_mov_b32 s48, 409600
s_add_u32 m0, s41, 65536
KR 56,100,0
AD 88
DM 114,12,0
MM 12,60,96
KR 60,100,4096
AD 89
MM 16,64,96
KR 64,101,0
AD 90
MM 20,68,96
KR 68,101,4096
AD 91
MM 24,72,96
KR 72,102,0
AD 92
MM 28,76,96
KR 76,102,4096
AD 93
MM 32,80,96
KR 80,103,0
AD 94
DM 115,12,1024
MM 36,84,96
KR 84,103,4096
AD 95
WL 4
MN 88,56,40
TR 56,104,32768
TR 58,104,36864
MN 92,60,40
s_mov_b32 s48, 425984
s_add_u32 m0, s41, 24576
TR 60,105,32768
TR 62,105,36864
DM 112,8,0
v_max3_f32 v120, v0, v1, v2
MM 88,64,44
TR 64,106,32768
TR 66,106,36864
v_max3_f32 v121, v3, v4, v5
MM 92,68,44
TR 68,107,32768
TR 70,107,36864
v_max3_f32 v120, v120, v6, v7
WL 8
MM 88,72,48
TR 72,108,32768
TR 74,108,36864
v_max_f32 v120, v120, v121
MM 92,76,48
TR 76,109,32768
TR 78,109,36864
DM 113,8,1024
MM 88,80,52
TR 80,110,32768
TR 82,110,36864
MM 92,84,52
WL 12
TR 84,111,32768
TR 86,111,36864
v_cmp_lt_f32 vcc, s51, v120
s_cbranch_vccnz L_tramp1_55
L_back1_55:
EX 0
EX 1
EX 2
EX 3
EX 4
EX 5
EX 6
EX 7
CV 96,0
CV 97,2
CV 98,4
CV 99,6
WB 6
s_barrier
MM 8,56,96
s_mov_b32 s48, 417792
s_add_u32 m0, s41, 73728
KR 56,100,8192
AD 0
DM 114,12,0
MM 12,60,96
KR 60,100,12288
AD 1
MM 16,64,96
KR 64,101,8192
AD 2
MM 20,68,96
KR 68,101,12288
AD 3
MM 24,72,96
KR 72,102,8192
AD 4
MM 28,76,96
KR 76,102,12288
AD 5
MM 32,80,96
KR 80,103,8192
AD 6
DM 115,12,1024
MM 36,84,96
KR 84,103,12288
AD 7
WL 4
MN 0,56,40
TR 56,104,0
TR 58,104,4096
MN 4,60,40
s_mov_b32 s48, 434176
s_add_u32 m0, s41, 32768
TR 60,105,0
TR 62,105,4096
DM 112,8,0
v_max3_f32 v120, v88, v89, v90
MM 0,64,44
TR 64,106,0
TR 66,106,4096
v_max3_f32 v121, v91, v92, v93
MM 4,68,44
TR 68,107,0
TR 70,107,4096
v_max3_f32 v120, v120, v94, v95
WL 8
MM 0,72,48
TR 72,108,0
TR 74,108,4096
v_max_f32 v120, v120, v121
MM 4,76,48
TR 76,109,0
TR 78,109,4096
DM 113,8,1024
MM 0,80,52
TR 80,110,0
TR 82,110,4096
MM 4,84,52
WL 12
TR 84,111,0
TR 86,111,4096
v_cmp_lt_f32 vcc, s51, v120
s_cbranch_vccnz L_tramp1_56
L_back1_56:
EX 88
EX 89
EX 90
EX 91
EX 92
EX 93
EX 94
EX 95
CV 96,88
CV 97,90
CV 98,92
CV 99,94
WB 6
s_barrier
MM 8,56,96
s_mov_b32 s48, 425984
s_add_u32 m0, s41, 81920
KR 56,100,16384
AD 88
DM 114,12,0
MM 12,60,96
KR 60,100,20480
AD 89
MM 16,64,96
KR 64,101,16384
AD 90
MM 20,68,96
KR 68,101,20480
AD 91
MM 24,72,96
KR 72,102,16384
AD 92
MM 28,76,96
KR 76,102,20480
AD 93
MM 32,80,96
KR 80,103,16384
AD 94
DM 115,12,1024
MM 36,84,96
KR 84,103,20480
AD 95
WL 4
MN 88,56,40
TR 56,104,8192
TR 58,104,12288
MN 92,60,40
s_mov_b32 s48, 442368
s_add_u32 m0, s41, 0
TR 60,105,8192
TR 62,105,12288
DM 112,8,0
v_max3_f32 v120, v0, v1, v2
MM 88,64,44
TR 64,106,8192
TR 66,106,12288
v_max3_f32 v121, v3, v4, v5
MM 92,68,44
TR 68,107,8192
TR 70,107,12288
v_max3_f32 v120, v120, v6, v7
WL 8
MM 88,72,48
TR 72,108,8192
TR 74,108,12288
v_max_f32 v120, v120, v121
MM 92,76,48
TR 76,109,8192
TR 78,109,12288
DM 113,8,1024
MM 88,80,52
TR 80,110,8192
TR 82,110,12288
MM 92,84,52
WL 12
TR 84,111,8192
TR 86,111,12288
v_cmp_lt_f32 vcc, s51, v120
s_cbranch_vccnz L_tramp1_57
L_back1_57:
EX 0
EX 1
EX 2
EX 3
EX 4
EX 5
EX 6
EX 7
CV 96,0
CV 97,2
CV 98,4
CV 99,6
WB 6
s_barrier
MM 8,56,96
s_mov_b32 s48, 434176
s_add_u32 m0, s41, 90112
KR 56,100,24576
AD 0
DM 114,12,0
MM 12,60,96
KR 60,100,28672
AD 1
MM 16,64,96
KR 64,101,24576
AD 2
MM 20,68,96
KR 68,101,28672
AD 3
MM 24,72,96
KR 72,102,24576
AD 4
MM 28,76,96
KR 76,102,28672
AD 5
MM 32,80,96
KR 80,103,24576
AD 6
DM 115,12,1024
MM 36,84,96
KR 84,103,28672
AD 7
WL 4
MN 0,56,40
TR 56,104,16384
TR 58,104,20480
MN 4,60,40
s_mov_b32 s48, 450560
s_add_u32 m0, s41, 8192
TR 60,105,16384
TR 62,105,20480
DM 112,8,0
v_max3_f32 v120, v88, v89, v90
MM 0,64,44
TR 64,106,16384
TR 66,106,20480
v_max3_f32 v121, v91, v92, v93
MM 4,68,44
TR 68,107,16384
TR 70,107,20480
v_max3_f32 v120, v120, v94, v95
WL 8
MM 0,72,48
TR 72,108,16384
TR 74,108,20480
v_max_f32 v120, v120, v121
MM 4,76,48
TR 76,109,16384
TR 78,109,20480
DM 113,8,1024
MM 0,80,52
TR 80,110,16384
TR 82,110,20480
MM 4,84,52
WL 12
TR 84,111,16384
TR 86,111,20480
v_cmp_lt_f32 vcc, s51, v120
s_cbranch_vccnz L_tramp1_58
L_back1_58:
EX 88
EX 89
EX 90
EX 91
EX 92
EX 93
EX 94
EX 95
CV 96,88
CV 97,90
CV 98,92
CV 99,94
WB 6
s_barrier
MM 8,56,96
s_mov_b32 s48, 442368
s_add_u32 m0, s41, 57344
KR 56,100,32768
AD 88
DM 114,12,0
MM 12,60,96
KR 60,100,36864
AD 89
MM 16,64,96
KR 64,101,32768
AD 90
MM 20,68,96
KR 68,101,36864
AD 91
MM 24,72,96
KR 72,102,32768
AD 92
MM 28,76,96
KR 76,102,36864
AD 93
MM 32,80,96
KR 80,103,32768
AD 94
DM 115,12,1024
MM 36,84,96
KR 84,103,36864
AD 95
WL 4
MN 88,56,40
TR 56,104,24576
TR 58,104,28672
MN 92,60,40
s_mov_b32 s48, 458752
s_add_u32 m0, s41, 16384
TR 60,105,24576
TR 62,105,28672
DM 112,8,0
v_max3_f32 v120, v0, v1, v2
MM 88,64,44
TR 64,106,24576
TR 66,106,28672
v_max3_f32 v121, v3, v4, v5
MM 92,68,44
TR 68,107,24576
TR 70,107,28672
v_max3_f32 v120, v120, v6, v7
WL 8
MM 88,72,48
TR 72,108,24576
TR 74,108,28672
v_max_f32 v120, v120, v121
MM 92,76,48
TR 76,109,24576
TR 78,109,28672
DM 113,8,1024
MM 88,80,52
TR 80,110,24576
TR 82,110,28672
MM 92,84,52
WL 12
TR 84,111,24576
TR 86,111,28672
v_cmp_lt_f32 vcc, s51, v120
s_cbranch_vccnz L_tramp1_59
L_back1_59:
EX 0
EX 1
EX 2
EX 3
EX 4
EX 5
EX 6
EX 7
CV 96,0
CV 97,2
CV 98,4
CV 99,6
WB 6
s_barrier
s_mov_b32 s48, 450560
s_add_u32 m0, s41, 65536
s_nop 0
DM 114,12,0
DM 115,12,1024
s_mov_b32 s48, 458752
s_add_u32 m0, s41, 73728
s_nop 0
DM 114,12,0
DM 115,12,1024
MM 8,56,96
KR 56,100,0
AD 0
MM 12,60,96
KR 60,100,4096
AD 1
MM 16,64,96
KR 64,101,0
AD 2
MM 20,68,96
KR 68,101,4096
AD 3
MM 24,72,96
KR 72,102,0
AD 4
MM 28,76,96
KR 76,102,4096
AD 5
MM 32,80,96
KR 80,103,0
AD 6
MM 36,84,96
KR 84,103,4096
AD 7
s_add_u32 s43, s52, 393216
s_and_b32 s43, s43, 0x7ffff
s_add_u32 m0, s42, 114688
s_nop 0
DH 116,24,0
s_add_u32 s43, s43, 3072
DH 117,24,1024
s_add_u32 s43, s43, 3072
DH 116,24,2048
s_add_u32 s43, s43, 3072
DH 117,24,3072
s_add_u32 s43, s52, 409600
s_and_b32 s43, s43, 0x7ffff
s_add_u32 m0, s42, 131072
s_nop 0
DH 116,24,0
s_add_u32 s43, s43, 3072
DH 117,24,1024
s_add_u32 s43, s43, 3072
DH 116,24,2048
s_add_u32 s43, s43, 3072
DH 117,24,3072
s_add_u32 s43, s52, 425984
s_and_b32 s43, s43, 0x7ffff
s_add_u32 m0, s42, 147456
s_nop 0
DH 116,24,0
s_add_u32 s43, s43, 3072
DH 117,24,1024
s_add_u32 s43, s43, 3072
DH 116,24,2048
s_add_u32 s43, s43, 3072
DH 117,24,3072
s_add_u32 s43, s52, 442368
s_and_b32 s43, s43, 0x7ffff
s_add_u32 m0, s42, 98304
s_nop 0
DH 116,24,0
s_add_u32 s43, s43, 3072
DH 117,24,1024
s_add_u32 s43, s43, 3072
DH 116,24,2048
s_add_u32 s43, s43, 3072
DH 117,24,3072
WL 4
MN 0,56,40
TR 56,104,32768
TR 58,104,36864
MN 4,60,40
TR 60,105,32768
TR 62,105,36864
v_max3_f32 v120, v88, v89, v90
MM 0,64,44
TR 64,106,32768
TR 66,106,36864
v_max3_f32 v121, v91, v92, v93
MM 4,68,44
TR 68,107,32768
TR 70,107,36864
v_max3_f32 v120, v120, v94, v95
WL 8
MM 0,72,48
TR 72,108,32768
TR 74,108,36864
v_max_f32 v120, v120, v121
MM 4,76,48
TR 76,109,32768
TR 78,109,36864
MM 0,80,52
TR 80,110,32768
TR 82,110,36864
MM 4,84,52
WL 12
TR 84,111,32768
TR 86,111,36864
v_cmp_lt_f32 vcc, s51, v120
s_cbranch_vccnz L_tramp1_60
L_back1_60:
EX 88
EX 89
EX 90
EX 91
EX 92
EX 93
EX 94
EX 95
CV 96,88
CV 97,90
CV 98,92
CV 99,94
WB 22
s_barrier
MM 8,56,96
KR 56,100,8192
AD 88
MM 12,60,96
KR 60,100,12288
AD 89
MM 16,64,96
KR 64,101,8192
AD 90
MM 20,68,96
KR 68,101,12288
AD 91
MM 24,72,96
KR 72,102,8192
AD 92
MM 28,76,96
KR 76,102,12288
AD 93
MM 32,80,96
KR 80,103,8192
AD 94
MM 36,84,96
KR 84,103,12288
AD 95
s_add_u32 s43, s52, 458752
s_and_b32 s43, s43, 0x7ffff
s_add_u32 m0, s42, 32768
s_nop 0
DH 116,24,0
s_add_u32 s43, s43, 3072
DH 117,24,1024
s_add_u32 s43, s43, 3072
DH 116,24,2048
s_add_u32 s43, s43, 3072
DH 117,24,3072
s_add_u32 s43, s52, 475136
s_and_b32 s43, s43, 0x7ffff
s_add_u32 m0, s42, 81920
s_nop 0
DH 116,24,0
s_add_u32 s43, s43, 3072
DH 117,24,1024
s_add_u32 s43, s43, 3072
DH 116,24,2048
s_add_u32 s43, s43, 3072
DH 117,24,3072
WL 4
MN 88,56,40
TR 56,104,0
TR 58,104,4096
MN 92,60,40
TR 60,105,0
TR 62,105,4096
v_max3_f32 v120, v0, v1, v2
MM 88,64,44
TR 64,106,0
TR 66,106,4096
v_max3_f32 v121, v3, v4, v5
MM 92,68,44
TR 68,107,0
TR 70,107,4096
v_max3_f32 v120, v120, v6, v7
WL 8
MM 88,72,48
TR 72,108,0
TR 74,108,4096
v_max_f32 v120, v120, v121
MM 92,76,48
TR 76,109,0
TR 78,109,4096
MM 88,80,52
TR 80,110,0
TR 82,110,4096
MM 92,84,52
WL 12
TR 84,111,0
TR 86,111,4096
v_cmp_lt_f32 vcc, s51, v120
s_cbranch_vccnz L_tramp1_61
L_back1_61:
EX 0
EX 1
EX 2
EX 3
EX 4
EX 5
EX 6
EX 7
CV 96,0
CV 97,2
CV 98,4
CV 99,6
WB 26
s_barrier
MM 8,56,96
KR 56,100,16384
AD 0
MM 12,60,96
KR 60,100,20480
AD 1
MM 16,64,96
KR 64,101,16384
AD 2
MM 20,68,96
KR 68,101,20480
AD 3
MM 24,72,96
KR 72,102,16384
AD 4
MM 28,76,96
KR 76,102,20480
AD 5
MM 32,80,96
KR 80,103,16384
AD 6
MM 36,84,96
KR 84,103,20480
AD 7
s_add_u32 s43, s52, 491520
s_and_b32 s43, s43, 0x7ffff
s_add_u32 m0, s42, 49152
s_nop 0
DH 116,24,0
s_add_u32 s43, s43, 3072
DH 117,24,1024
s_add_u32 s43, s43, 3072
DH 116,24,2048
s_add_u32 s43, s43, 3072
DH 117,24,3072
s_add_u32 s43, s52, 507904
s_and_b32 s43, s43, 0x7ffff
s_add_u32 m0, s42, 0
s_nop 0
DH 116,24,0
s_add_u32 s43, s43, 3072
DH 117,24,1024
s_add_u32 s43, s43, 3072
DH 116,24,2048
s_add_u32 s43, s43, 3072
DH 117,24,3072
WL 4
MN 0,56,40
TR 56,104,8192
TR 58,104,12288
MN 4,60,40
TR 60,105,8192
TR 62,105,12288
v_max3_f32 v120, v88, v89, v90
MM 0,64,44
TR 64,106,8192
TR 66,106,12288
v_max3_f32 v121, v91, v92, v93
MM 4,68,44
TR 68,107,8192
TR 70,107,12288
v_max3_f32 v120, v120, v94, v95
WL 8
MM 0,72,48
TR 72,108,8192
TR 74,108,12288
v_max_f32 v120, v120, v121
MM 4,76,48
TR 76,109,8192
TR 78,109,12288
MM 0,80,52
TR 80,110,8192
TR 82,110,12288
MM 4,84,52
WL 12
TR 84,111,8192
TR 86,111,12288
v_cmp_lt_f32 vcc, s51, v120
s_cbranch_vccnz L_tramp1_62
L_back1_62:
EX 88
EX 89
EX 90
EX 91
EX 92
EX 93
EX 94
EX 95
CV 96,88
CV 97,90
CV 98,92
CV 99,94
WL 0
s_nop 0
MM 8,56,96
AD 88
MM 12,60,96
AD 89
MM 16,64,96
AD 90
MM 20,68,96
AD 91
MM 24,72,96
AD 92
MM 28,76,96
AD 93
MM 32,80,96
AD 94
MM 36,84,96
AD 95
v_max3_f32 v120, v0, v1, v2
v_max3_f32 v121, v3, v4, v5
v_max3_f32 v120, v120, v6, v7
v_max_f32 v120, v120, v121
v_cmp_lt_f32 vcc, s51, v120
s_cbranch_vccnz L_tramp1_63
L_back1_63:
EX 0
EX 1
EX 2
EX 3
EX 4
EX 5
EX 6
EX 7
AD 0
AD 1
AD 2
AD 3
AD 4
AD 5
AD 6
AD 7
v_mov_b32 v121, v119
s_nop 1
v_permlane32_swap_b32 v119, v121
AD 121
v_mov_b32 v121, v119
s_nop 1
v_permlane16_swap_b32 v119, v121
AD 121
v_rcp_f32 v119, v119
v_add_u32 v112, s66, v118
v_add_u32 v113, s67, v118
v_add_u32 v114, s68, v118
v_add_u32 v115, s69, v118
v_mov_b32 v124, v118
v_pk_mul_f32 v[0:1], v[0:1], v[118:119] op_sel:[0,1] op_sel_hi:[1,1]
v_pk_mul_f32 v[2:3], v[2:3], v[118:119] op_sel:[0,1] op_sel_hi:[1,1]
v_pk_mul_f32 v[4:5], v[4:5], v[118:119] op_sel:[0,1] op_sel_hi:[1,1]
v_pk_mul_f32 v[6:7], v[6:7], v[118:119] op_sel:[0,1] op_sel_hi:[1,1]
CV 96,0
CV 97,2
CV 98,4
CV 99,6
v_pk_mul_f32 v[8:9], v[8:9], v[118:119] op_sel:[0,1] op_sel_hi:[1,1]
v_pk_mul_f32 v[10:11], v[10:11], v[118:119] op_sel:[0,1] op_sel_hi:[1,1]
v_pk_mul_f32 v[12:13], v[12:13], v[118:119] op_sel:[0,1] op_sel_hi:[1,1]
v_pk_mul_f32 v[14:15], v[14:15], v[118:119] op_sel:[0,1] op_sel_hi:[1,1]
v_pk_mul_f32 v[16:17], v[16:17], v[118:119] op_sel:[0,1] op_sel_hi:[1,1]
v_pk_mul_f32 v[18:19], v[18:19], v[118:119] op_sel:[0,1] op_sel_hi:[1,1]
v_pk_mul_f32 v[20:21], v[20:21], v[118:119] op_sel:[0,1] op_sel_hi:[1,1]
v_pk_mul_f32 v[22:23], v[22:23], v[118:119] op_sel:[0,1] op_sel_hi:[1,1]
v_pk_mul_f32 v[24:25], v[24:25], v[118:119] op_sel:[0,1] op_sel_hi:[1,1]
v_pk_mul_f32 v[26:27], v[26:27], v[118:119] op_sel:[0,1] op_sel_hi:[1,1]
v_pk_mul_f32 v[28:29], v[28:29], v[118:119] op_sel:[0,1] op_sel_hi:[1,1]
v_pk_mul_f32 v[30:31], v[30:31], v[118:119] op_sel:[0,1] op_sel_hi:[1,1]
v_pk_mul_f32 v[32:33], v[32:33], v[118:119] op_sel:[0,1] op_sel_hi:[1,1]
v_pk_mul_f32 v[34:35], v[34:35], v[118:119] op_sel:[0,1] op_sel_hi:[1,1]
v_pk_mul_f32 v[36:37], v[36:37], v[118:119] op_sel:[0,1] op_sel_hi:[1,1]
v_pk_mul_f32 v[38:39], v[38:39], v[118:119] op_sel:[0,1] op_sel_hi:[1,1]
WM 32
s_barrier
TR 56,104,16384
TR 58,104,20480
TR 60,105,16384
TR 62,105,20480
TR 64,106,16384
TR 66,106,20480
TR 68,107,16384
TR 70,107,20480
TR 72,108,16384
TR 74,108,20480
TR 76,109,16384
TR 78,109,20480
TR 80,110,16384
TR 82,110,20480
WL 12
TR 84,111,16384
TR 86,111,20480
MM 8,56,96
WL 12
MM 12,60,96
WL 10
MM 16,64,96
WL 8
MM 20,68,96
WL 6
MM 24,72,96
WL 4
MM 28,76,96
WL 2
MM 32,80,96
WL 0
MM 36,84,96
CV 72,8
CV 73,10
CV 74,12
CV 75,14
ds_write_b128 v112, v[72:75] offset:0
CV 76,16
CV 77,18
CV 78,20
CV 79,22
ds_write_b128 v112, v[76:79] offset:1024
CV 80,24
CV 81,26
CV 82,28
CV 83,30
ds_write_b128 v112, v[80:83] offset:2048
CV 84,32
CV 85,34
CV 86,36
CV 87,38
ds_write_b128 v112, v[84:87] offset:3072
MZ 8,128,72
v_add_u32 v104, s42, v104
MZ 12,132,72
v_add_u32 v105, s42, v105
MZ 16,136,72
v_add_u32 v106, s42, v106
MZ 20,140,72
v_add_u32 v107, s42, v107
MM 8,160,76
v_add_u32 v108, s42, v108
MM 12,164,76
v_add_u32 v109, s42, v109
MM 16,168,76
v_add_u32 v110, s42, v110
MM 20,172,76
v_add_u32 v111, s42, v111
WL 0
s_barrier
KR 40,113,0
KR 44,113,1024
KR 48,113,2048
KR 52,113,3072
KR 56,114,0
KR 60,114,1024
KR 64,114,2048
KR 68,114,3072
KR 88,115,0
KR 92,115,1024
KR 96,115,2048
KR 100,115,3072
MM 8,192,80
v_subrev_u32 v0, 57344, v104
MM 12,196,80
v_subrev_u32 v1, 57344, v105
MM 16,200,80
v_subrev_u32 v2, 57344, v106
MM 20,204,80
v_subrev_u32 v3, 57344, v107
MM 8,224,84
v_subrev_u32 v4, 57344, v108
MM 12,228,84
v_subrev_u32 v5, 57344, v109
MM 16,232,84
v_subrev_u32 v6, 57344, v110
MM 20,236,84
v_subrev_u32 v7, 57344, v111
MZ 24,144,72
v_add_u32 v116, 57344, v104
MZ 28,148,72
v_add_u32 v117, 57344, v105
MZ 32,152,72
v_add_u32 v118, 57344, v106
MZ 36,156,72
v_add_u32 v119, 57344, v107
MM 24,176,76
v_add_u32 v120, 57344, v108
MM 28,180,76
v_add_u32 v121, 57344, v109
MM 32,184,76
v_add_u32 v122, 57344, v110
MM 36,188,76
v_add_u32 v123, 57344, v111
MM 24,208,80
v_mov_b32 v112, s53
MM 28,212,80
v_and_b32 v113, 0xf0, v124
v_lshlrev_b32 v113, 6, v113
MM 32,216,80
v_lshrrev_b32 v114, 8, v124
v_lshl_add_u32 v113, v114, 3, v113
MM 36,220,80
v_cmp_eq_u32 vcc, 0, v124
v_mov_b32 v114, 0x20000000
s_nop 0
v_cndmask_b32 v115, v114, 0, vcc
MM 24,240,84
s_mov_b32 s55, 0
MM 28,244,84
s_mov_b32 s56, 0
MM 32,248,84
MM 36,252,84
WL 11
MA 8,0,40
WM 28
TR 128,116,0
MA 12,4,40
TR 132,117,0
MA 16,8,40
TR 136,118,0
MA 20,12,40
WL 13
TR 140,119,0
MA 8,32,44
WM 24
WL 13
TR 130,116,16384
MA 12,36,44
WL 13
TR 134,117,16384
MA 16,40,44
WL 13
TR 138,118,16384
MA 20,44,44
WL 13
TR 142,119,16384
MA 8,64,48
WM 20
WL 13
TR 160,116,32768
MA 12,68,48
WL 13
TR 164,117,32768
MA 16,72,48
WL 13
TR 168,118,32768
MA 20,76,48
WL 13
TR 172,119,32768
MA 8,96,52
WM 16
WL 13
TR 162,104,40960
MA 12,100,52
WL 13
TR 166,105,40960
MA 16,104,52
WL 13
TR 170,106,40960
MA 20,108,52
WL 13
TR 174,107,40960
MA 8,128,56
WM 12
WL 13
TR 192,0,32768
MA 12,132,56
WL 13
TR 196,1,32768
MA 16,136,56
WL 13
TR 200,2,32768
MA 20,140,56
WL 13
TR 204,3,32768
MA 8,160,60
WM 8
WL 13
TR 194,104,24576
MA 12,164,60
WL 13
TR 198,105,24576
MA 16,168,60
WL 13
TR 202,106,24576
MA 20,172,60
WL 13
TR 206,107,24576
MA 8,192,64
WM 4
WL 13
TR 224,0,49152
MA 12,196,64
WL 13
TR 228,1,49152
MA 16,200,64
WL 13
TR 232,2,49152
MA 20,204,64
WL 13
TR 236,3,49152
MA 8,224,68
WM 0
WL 13
TR 226,0,0
MA 12,228,68
WL 13
TR 230,1,0
MA 16,232,68
WL 13
TR 234,2,0
MA 20,236,68
WL 13
TR 238,3,0
MM 8,128,88
WL 13
TR 152,122,0
MM 12,132,88
WL 13
TR 156,123,0
MM 16,136,88
WL 13
TR 154,122,16384
MM 20,140,88
WL 13
TR 158,123,16384
MM 8,160,92
WL 13
TR 184,122,32768
MM 12,164,92
WL 13
TR 188,123,32768
MM 16,168,92
WL 13
TR 186,110,40960
MM 20,172,92
WL 13
TR 190,111,40960
MM 8,192,96
WL 13
TR 216,6,32768
MM 12,196,96
WL 13
TR 220,7,32768
MM 16,200,96
WL 13
TR 218,110,24576
MM 20,204,96
WL 13
TR 222,111,24576
MM 8,224,100
WL 13
TR 248,6,49152
MM 12,228,100
WL 13
TR 252,7,49152
MM 16,232,100
WL 13
TR 250,6,0
MM 20,236,100
WL 13
TR 254,7,0
MA 32,24,40
WL 13
TR 144,120,0
MA 36,28,40
WL 13
TR 148,121,0
MA 32,56,44
WL 13
TR 146,120,16384
MA 36,60,44
WL 13
TR 150,121,16384
MA 32,88,48
WL 13
TR 176,120,32768
MA 36,92,48
WL 13
TR 180,121,32768
CV 8,8
CV 9,10
CV 10,12
v_mov_b32 v11, v112
buffer_store_dwordx4 v[8:11], v124, s[28:31], s70 offen offset:0 sc1
MA 32,120,52
WL 13
TR 178,108,40960
MA 36,124,52
WL 13
TR 182,109,40960
MA 32,152,56
WL 13
TR 208,4,32768
CV 12,14
CV 13,16
CV 14,18
v_mov_b32 v15, v112
buffer_store_dwordx4 v[12:15], v124, s[28:31], s70 offen offset:1024 sc1
MA 36,156,56
WL 13
TR 212,5,32768
MA 32,184,60
WL 13
TR 210,108,24576
MA 36,188,60
WL 13
TR 214,109,24576
CV 16,20
CV 17,22
v_mov_b32 v18, v112
v_mov_b32 v19, v112
buffer_store_dwordx4 v[16:19], v124, s[28:31], s70 offen offset:2048 sc1
MA 32,216,64
WL 13
TR 240,4,49152
MA 36,220,64
WL 13
TR 244,5,49152
MA 32,248,68
WL 13
TR 242,4,0
MA 36,252,68
WL 13
TR 246,5,0
MM 32,152,88
MM 36,156,88
MM 32,184,92
MM 36,188,92
MM 32,216,96
MM 36,220,96
MM 32,248,100
MM 36,252,100
MA 24,16,40
MA 28,20,40
MA 24,48,44
MA 28,52,44
MA 24,80,48
MA 28,84,48
s_nop 3
CV 16,36
CV 17,38
buffer_store_dwordx4 v[16:19], v124, s[28:31], s71 offen offset:2048 sc1
MA 24,112,52
MA 28,116,52
MA 24,144,56
MA 28,148,56
MA 24,176,60
MA 28,180,60
MA 24,208,64
MA 28,212,64
MA 24,240,68
MA 28,244,68
WL 13
MM 24,144,88
WL 12
MM 28,148,88
WL 9
MM 24,176,92
WL 8
MM 28,180,92
WL 5
MM 24,208,96
WL 4
MM 28,212,96
WL 1
MM 24,240,100
WL 0
MM 28,244,100
s_nop 7
CV 8,24
CV 9,26
CV 10,28
buffer_store_dwordx4 v[8:11], v124, s[28:31], s71 offen offset:0 sc1
CV 12,30
CV 13,32
CV 14,34
buffer_store_dwordx4 v[12:15], v124, s[28:31], s71 offen offset:1024 sc1
s_cmp_eq_u32 s36, 3
s_cbranch_scc1 L_fin1
L_opoll1:
s_bitcmp1_b32 s56, 0
s_cbranch_scc1 L_sk1_0
s_add_u32 s47, s72, 0
buffer_load_dwordx4 v[56:59], v124, s[28:31], s47 offen sc1
L_sk1_0:
s_bitcmp1_b32 s56, 1
s_cbranch_scc1 L_sk1_1
s_add_u32 s47, s72, 4096
buffer_load_dwordx4 v[60:63], v124, s[28:31], s47 offen sc1
L_sk1_1:
s_bitcmp1_b32 s56, 2
s_cbranch_scc1 L_sk1_2
s_add_u32 s47, s72, 8192
buffer_load_dwordx4 v[64:67], v124, s[28:31], s47 offen sc1
L_sk1_2:
s_bitcmp1_b32 s56, 3
s_cbranch_scc1 L_sk1_3
s_add_u32 s47, s72, 12288
buffer_load_dwordx4 v[68:71], v124, s[28:31], s47 offen sc1
L_sk1_3:
s_bitcmp1_b32 s56, 4
s_cbranch_scc1 L_sk1_4
s_add_u32 s47, s72, 16384
buffer_load_dwordx4 v[72:75], v124, s[28:31], s47 offen sc1
L_sk1_4:
s_bitcmp1_b32 s56, 5
s_cbranch_scc1 L_sk1_5
s_add_u32 s47, s72, 20480
buffer_load_dwordx4 v[76:79], v124, s[28:31], s47 offen sc1
L_sk1_5:
s_bitcmp1_b32 s56, 6
s_cbranch_scc1 L_sk1_6
s_add_u32 s47, s72, 24576
buffer_load_dwordx4 v[80:83], v124, s[28:31], s47 offen sc1
L_sk1_6:
s_bitcmp1_b32 s56, 7
s_cbranch_scc1 L_sk1_7
s_add_u32 s47, s72, 28672
buffer_load_dwordx4 v[84:87], v124, s[28:31], s47 offen sc1
L_sk1_7:
WM 0
L_chk1:
v_cmp_ne_u32 vcc, s53, v59
s_cbranch_vccnz L_sc1_0
s_bitset1_b32 s56, 0
L_sc1_0:
v_cmp_ne_u32 vcc, s53, v63
s_cbranch_vccnz L_sc1_1
s_bitset1_b32 s56, 1
L_sc1_1:
v_cmp_ne_u32 vcc, s53, v67
s_cbranch_vccnz L_sc1_2
s_bitset1_b32 s56, 2
L_sc1_2:
v_cmp_ne_u32 vcc, s53, v71
s_cbranch_vccnz L_sc1_3
s_bitset1_b32 s56, 3
L_sc1_3:
v_cmp_ne_u32 vcc, s53, v75
s_cbranch_vccnz L_sc1_4
s_bitset1_b32 s56, 4
L_sc1_4:
v_cmp_ne_u32 vcc, s53, v79
s_cbranch_vccnz L_sc1_5
s_bitset1_b32 s56, 5
L_sc1_5:
v_cmp_ne_u32 vcc, s53, v83
s_cbranch_vccnz L_sc1_6
s_bitset1_b32 s56, 6
L_sc1_6:
v_cmp_ne_u32 vcc, s53, v87
s_cbranch_vccnz L_sc1_7
s_bitset1_b32 s56, 7
L_sc1_7:
s_cmp_lg_u32 s56, 0xff
s_cbranch_scc1 L_oretry1
L_ook1:
v_lshlrev_b32 v8, 16, v56
v_and_b32 v9, 0xffff0000, v56
v_lshlrev_b32 v18, 16, v60
v_and_b32 v19, 0xffff0000, v60
v_pk_add_f32 v[8:9], v[8:9], v[18:19]
v_lshlrev_b32 v16, 16, v64
v_and_b32 v17, 0xffff0000, v64
v_pk_add_f32 v[8:9], v[8:9], v[16:17]
v_lshlrev_b32 v18, 16, v68
v_and_b32 v19, 0xffff0000, v68
v_pk_add_f32 v[8:9], v[8:9], v[18:19]
v_lshlrev_b32 v16, 16, v72
v_and_b32 v17, 0xffff0000, v72
v_pk_add_f32 v[8:9], v[8:9], v[16:17]
v_lshlrev_b32 v18, 16, v76
v_and_b32 v19, 0xffff0000, v76
v_pk_add_f32 v[8:9], v[8:9], v[18:19]
v_lshlrev_b32 v16, 16, v80
v_and_b32 v17, 0xffff0000, v80
v_pk_add_f32 v[8:9], v[8:9], v[16:17]
v_lshlrev_b32 v18, 16, v84
v_and_b32 v19, 0xffff0000, v84
v_pk_add_f32 v[8:9], v[8:9], v[18:19]
CV 88,8
buffer_store_dword v88, v113, s[32:35], s73 offen
v_lshlrev_b32 v10, 16, v57
v_and_b32 v11, 0xffff0000, v57
v_lshlrev_b32 v18, 16, v61
v_and_b32 v19, 0xffff0000, v61
v_pk_add_f32 v[10:11], v[10:11], v[18:19]
v_lshlrev_b32 v16, 16, v65
v_and_b32 v17, 0xffff0000, v65
v_pk_add_f32 v[10:11], v[10:11], v[16:17]
v_lshlrev_b32 v18, 16, v69
v_and_b32 v19, 0xffff0000, v69
v_pk_add_f32 v[10:11], v[10:11], v[18:19]
v_lshlrev_b32 v16, 16, v73
v_and_b32 v17, 0xffff0000, v73
v_pk_add_f32 v[10:11], v[10:11], v[16:17]
v_lshlrev_b32 v18, 16, v77
v_and_b32 v19, 0xffff0000, v77
v_pk_add_f32 v[10:11], v[10:11], v[18:19]
v_lshlrev_b32 v16, 16, v81
v_and_b32 v17, 0xffff0000, v81
v_pk_add_f32 v[10:11], v[10:11], v[16:17]
v_lshlrev_b32 v18, 16, v85
v_and_b32 v19, 0xffff0000, v85
v_pk_add_f32 v[10:11], v[10:11], v[18:19]
CV 89,10
buffer_store_dword v89, v113, s[32:35], s74 offen
v_lshlrev_b32 v12, 16, v58
v_and_b32 v13, 0xffff0000, v58
v_lshlrev_b32 v18, 16, v62
v_and_b32 v19, 0xffff0000, v62
v_pk_add_f32 v[12:13], v[12:13], v[18:19]
v_lshlrev_b32 v16, 16, v66
v_and_b32 v17, 0xffff0000, v66
v_pk_add_f32 v[12:13], v[12:13], v[16:17]
v_lshlrev_b32 v18, 16, v70
v_and_b32 v19, 0xffff0000, v70
v_pk_add_f32 v[12:13], v[12:13], v[18:19]
v_lshlrev_b32 v16, 16, v74
v_and_b32 v17, 0xffff0000, v74
v_pk_add_f32 v[12:13], v[12:13], v[16:17]
v_lshlrev_b32 v18, 16, v78
v_and_b32 v19, 0xffff0000, v78
v_pk_add_f32 v[12:13], v[12:13], v[18:19]
v_lshlrev_b32 v16, 16, v82
v_and_b32 v17, 0xffff0000, v82
v_pk_add_f32 v[12:13], v[12:13], v[16:17]
v_lshlrev_b32 v18, 16, v86
v_and_b32 v19, 0xffff0000, v86
v_pk_add_f32 v[12:13], v[12:13], v[18:19]
CV 90,12
buffer_store_dword v90, v113, s[32:35], s75 offen
s_or_b32 s43, s37, s36
s_cmp_eq_u32 s43, 0
s_cselect_b32 s43, s57, 0x20000000
s_add_u32 s44, s49, 1
v_mov_b32 v114, s44
buffer_store_dword v114, v115, s[28:31], s43 offen sc1
L_fin1:
s_endpgm
L_oretry1:
s_add_u32 s55, s55, 1
s_cmp_gt_u32 s55, 0x40000
s_cbranch_scc1 L_ook1
s_branch L_opoll1
L_tramp1_1:
s_swappc_b64 s[60:61], s[64:65]
s_branch L_back1_1
L_tramp1_2:
s_swappc_b64 s[60:61], s[58:59]
s_branch L_back1_2
L_tramp1_3:
s_swappc_b64 s[60:61], s[64:65]
s_branch L_back1_3
L_tramp1_4:
s_swappc_b64 s[60:61], s[58:59]
s_branch L_back1_4
L_tramp1_5:
s_swappc_b64 s[60:61], s[64:65]
s_branch L_back1_5
L_tramp1_6:
s_swappc_b64 s[60:61], s[58:59]
s_branch L_back1_6
L_tramp1_7:
s_swappc_b64 s[60:61], s[64:65]
s_branch L_back1_7
L_tramp1_8:
s_swappc_b64 s[60:61], s[58:59]
s_branch L_back1_8
L_tramp1_9:
s_swappc_b64 s[60:61], s[64:65]
s_branch L_back1_9
L_tramp1_10:
s_swappc_b64 s[60:61], s[58:59]
s_branch L_back1_10
L_tramp1_11:
s_swappc_b64 s[60:61], s[64:65]
s_branch L_back1_11
L_tramp1_12:
s_swappc_b64 s[60:61], s[58:59]
s_branch L_back1_12
L_tramp1_13:
s_swappc_b64 s[60:61], s[64:65]
s_branch L_back1_13
L_tramp1_14:
s_swappc_b64 s[60:61], s[58:59]
s_branch L_back1_14
L_tramp1_15:
s_swappc_b64 s[60:61], s[64:65]
s_branch L_back1_15
L_tramp1_16:
s_swappc_b64 s[60:61], s[58:59]
s_branch L_back1_16
L_tramp1_17:
s_swappc_b64 s[60:61], s[64:65]
s_branch L_back1_17
L_tramp1_18:
s_swappc_b64 s[60:61], s[58:59]
s_branch L_back1_18
L_tramp1_19:
s_swappc_b64 s[60:61], s[64:65]
s_branch L_back1_19
L_tramp1_20:
s_swappc_b64 s[60:61], s[58:59]
s_branch L_back1_20
L_tramp1_21:
s_swappc_b64 s[60:61], s[64:65]
s_branch L_back1_21
L_tramp1_22:
s_swappc_b64 s[60:61], s[58:59]
s_branch L_back1_22
L_tramp1_23:
s_swappc_b64 s[60:61], s[64:65]
s_branch L_back1_23
L_tramp1_24:
s_swappc_b64 s[60:61], s[58:59]
s_branch L_back1_24
L_tramp1_25:
s_swappc_b64 s[60:61], s[64:65]
s_branch L_back1_25
L_tramp1_26:
s_swappc_b64 s[60:61], s[58:59]
s_branch L_back1_26
L_tramp1_27:
s_swappc_b64 s[60:61], s[64:65]
s_branch L_back1_27
L_tramp1_28:
s_swappc_b64 s[60:61], s[58:59]
s_branch L_back1_28
L_tramp1_29:
s_swappc_b64 s[60:61], s[64:65]
s_branch L_back1_29
L_tramp1_30:
s_swappc_b64 s[60:61], s[58:59]
s_branch L_back1_30
L_tramp1_31:
s_swappc_b64 s[60:61], s[64:65]
s_branch L_back1_31
L_tramp1_32:
s_swappc_b64 s[60:61], s[58:59]
s_branch L_back1_32
L_tramp1_33:
s_swappc_b64 s[60:61], s[64:65]
s_branch L_back1_33
L_tramp1_34:
s_swappc_b64 s[60:61], s[58:59]
s_branch L_back1_34
L_tramp1_35:
s_swappc_b64 s[60:61], s[64:65]
s_branch L_back1_35
L_tramp1_36:
s_swappc_b64 s[60:61], s[58:59]
s_branch L_back1_36
L_tramp1_37:
s_swappc_b64 s[60:61], s[64:65]
s_branch L_back1_37
L_tramp1_38:
s_swappc_b64 s[60:61], s[58:59]
s_branch L_back1_38
L_tramp1_39:
s_swappc_b64 s[60:61], s[64:65]
s_branch L_back1_39
L_tramp1_40:
s_swappc_b64 s[60:61], s[58:59]
s_branch L_back1_40
L_tramp1_41:
s_swappc_b64 s[60:61], s[64:65]
s_branch L_back1_41
L_tramp1_42:
s_swappc_b64 s[60:61], s[58:59]
s_branch L_back1_42
L_tramp1_43:
s_swappc_b64 s[60:61], s[64:65]
s_branch L_back1_43
L_tramp1_44:
s_swappc_b64 s[60:61], s[58:59]
s_branch L_back1_44
L_tramp1_45:
s_swappc_b64 s[60:61], s[64:65]
s_branch L_back1_45
L_tramp1_46:
s_swappc_b64 s[60:61], s[58:59]
s_branch L_back1_46
L_tramp1_47:
s_swappc_b64 s[60:61], s[64:65]
s_branch L_back1_47
L_tramp1_48:
s_swappc_b64 s[60:61], s[58:59]
s_branch L_back1_48
L_tramp1_49:
s_swappc_b64 s[60:61], s[64:65]
s_branch L_back1_49
L_tramp1_50:
s_swappc_b64 s[60:61], s[58:59]
s_branch L_back1_50
L_tramp1_51:
s_swappc_b64 s[60:61], s[64:65]
s_branch L_back1_51
L_tramp1_52:
s_swappc_b64 s[60:61], s[58:59]
s_branch L_back1_52
L_tramp1_53:
s_swappc_b64 s[60:61], s[64:65]
s_branch L_back1_53
L_tramp1_54:
s_swappc_b64 s[60:61], s[58:59]
s_branch L_back1_54
L_tramp1_55:
s_swappc_b64 s[60:61], s[64:65]
s_branch L_back1_55
L_tramp1_56:
s_swappc_b64 s[60:61], s[58:59]
s_branch L_back1_56
L_tramp1_57:
s_swappc_b64 s[60:61], s[64:65]
s_branch L_back1_57
L_tramp1_58:
s_swappc_b64 s[60:61], s[58:59]
s_branch L_back1_58
L_tramp1_59:
s_swappc_b64 s[60:61], s[64:65]
s_branch L_back1_59
L_tramp1_60:
s_swappc_b64 s[60:61], s[58:59]
s_branch L_back1_60
L_tramp1_61:
s_swappc_b64 s[60:61], s[64:65]
s_branch L_back1_61
L_tramp1_62:
s_swappc_b64 s[60:61], s[58:59]
s_branch L_back1_62
L_tramp1_63:
s_swappc_b64 s[60:61], s[64:65]
s_branch L_back1_63
L_btramp1_39_0:
s_swappc_b64 s[60:61], s[4:5]
s_branch L_bback1_39_0
L_btramp1_44_0:
s_swappc_b64 s[60:61], s[4:5]
s_branch L_bback1_44_0
L_btramp1_49_0:
s_swappc_b64 s[60:61], s[4:5]
s_branch L_bback1_49_0
L_role2:
s_getpc_b64 s[60:61]
L_pcp2:
s_sub_u32 s60, s60, L_pcp2-standalone__gqa_block_cached__sampling_kernel
s_subb_u32 s61, s61, 0
s_mov_b32 s62, L_codeend-standalone__gqa_block_cached__sampling_kernel
s_mov_b32 s63, 0x20000
s_lshl_b32 s43, s38, 2
s_add_u32 s43, s43, s36
s_lshl_b32 s43, s43, 11
v_lshlrev_b32 v8, 7, v2
buffer_load_dword v9, v8, s[60:63], s43 offen
s_add_u32 m0, s42, 147456
s_nop 0
buffer_load_dwordx4 v226, s[20:23], s42 offen offset:0  lds
buffer_load_dwordx4 v227, s[20:23], s42 offen offset:1024  lds
buffer_load_dwordx4 v228, s[20:23], s42 offen offset:2048  lds
buffer_load_dwordx4 v229, s[20:23], s42 offen offset:3072  lds
s_mov_b32 s28, s78
s_mov_b32 s29, s79
s_mov_b32 s30, 0x20000000
s_mov_b32 s31, 0x20000
buffer_load_dword v6, off, s[28:31], s57 sc1
s_mov_b32 s48, 0
s_add_u32 m0, s41, 24576
s_nop 0
DM 112,8,0
DM 113,8,1024
s_mov_b32 s48, 8192
s_add_u32 m0, s41, 32768
s_nop 0
DM 112,8,0
DM 113,8,1024
s_mov_b32 s48, 0
s_add_u32 m0, s41, 81920
s_nop 0
DM 114,12,0
DM 115,12,1024
s_mov_b32 s48, 16384
s_add_u32 m0, s41, 0
s_nop 0
DM 112,8,0
DM 113,8,1024
s_mov_b32 s48, 8192
s_add_u32 m0, s41, 90112
s_nop 0
DM 114,12,0
DM 115,12,1024
s_mov_b32 s48, 24576
s_add_u32 m0, s41, 8192
s_nop 0
DM 112,8,0
DM 113,8,1024
s_lshl_b32 s43, s37, 19
s_lshl_b32 s44, s36, 8
s_add_u32 s43, s43, s44
s_add_u32 s24, s72, s43
s_addc_u32 s25, s73, 0
s_mov_b32 s26, 523520
s_mov_b32 s27, 0x20000
s_xor_b32 s43, s38, 0
s_lshl_b32 s43, s43, 14
s_mul_i32 s44, s36, 3840
s_add_u32 s43, s43, s44
v_and_b32 v14, 0x1f0, v118
v_lshlrev_b32 v14, 3, v14
buffer_load_dword v15, v14, s[24:27], s43 offen
s_lshl_b32 s43, s38, 14
s_add_u32 s32, s74, s43
s_addc_u32 s33, s75, 0
s_mov_b32 s34, 16384
s_mov_b32 s35, 0x20000
s_mov_b32 s50, 0x3e0293ee
s_mov_b32 s51, 0x41000000
s_mov_b32 s54, 0xfffffc00
s_getpc_b64 s[58:59]
L_pc2:
s_add_u32 s4, s58, L_burst-L_pc2
s_addc_u32 s5, s59, 0
s_add_u32 s64, s58, L_slow1-L_pc2
s_addc_u32 s65, s59, 0
s_add_u32 s58, s58, L_slow0-L_pc2
s_addc_u32 s59, s59, 0
s_lshl_b32 s52, s36, 17
s_add_u32 s52, s52, 262144
s_add_u32 s43, s36, 0
s_and_b32 s44, s43, 1
s_lshl_b32 s44, s44, 12
s_bitcmp1_b32 s43, 1
s_cselect_b32 s43, 40960, 0
s_add_u32 s43, s43, s44
s_add_u32 s66, s43, 24576
s_add_u32 s43, s36, 2
s_and_b32 s44, s43, 1
s_lshl_b32 s44, s44, 12
s_bitcmp1_b32 s43, 1
s_cselect_b32 s43, 40960, 0
s_add_u32 s43, s43, s44
s_add_u32 s67, s43, 24576
s_add_u32 s43, s36, 3
s_and_b32 s44, s43, 1
s_lshl_b32 s44, s44, 12
s_bitcmp1_b32 s43, 1
s_cselect_b32 s43, 40960, 0
s_add_u32 s43, s43, s44
s_add_u32 s68, s43, 24576
s_add_u32 s43, s36, 1
s_and_b32 s44, s43, 1
s_lshl_b32 s44, s44, 12
s_bitcmp1_b32 s43, 1
s_cselect_b32 s43, 40960, 0
s_add_u32 s43, s43, s44
s_add_u32 s69, s43, 24576
s_lshl_b32 s43, s38, 3
s_lshl_b32 s44, s36, 1
s_add_u32 s43, s43, s44
s_lshl_b32 s43, s43, 3
s_add_u32 s43, s43, s37
s_lshl_b32 s43, s43, 12
s_add_u32 s70, s43, 8388608
s_add_u32 s71, s70, 32768
s_lshl_b32 s72, s2, 15
s_lshl_b32 s43, s36, 10
s_add_u32 s72, s72, s43
s_add_u32 s72, s72, 8388608
s_mul_i32 s43, s36, 3
s_add_u32 s43, s43, 0
s_lshr_b32 s44, s43, 1
s_lshl_b32 s44, s44, 5
s_and_b32 s45, s43, 1
s_lshl_b32 s45, s45, 2
s_add_u32 s44, s44, s45
s_lshl_b32 s45, s37, 7
s_add_u32 s44, s44, s45
s_cmp_lt_u32 s43, 8
s_cselect_b32 s73, s44, 0x40000000
s_mul_i32 s43, s36, 3
s_add_u32 s43, s43, 1
s_lshr_b32 s44, s43, 1
s_lshl_b32 s44, s44, 5
s_and_b32 s45, s43, 1
s_lshl_b32 s45, s45, 2
s_add_u32 s44, s44, s45
s_lshl_b32 s45, s37, 7
s_add_u32 s44, s44, s45
s_cmp_lt_u32 s43, 8
s_cselect_b32 s74, s44, 0x40000000
s_mul_i32 s43, s36, 3
s_add_u32 s43, s43, 2
s_lshr_b32 s44, s43, 1
s_lshl_b32 s44, s44, 5
s_and_b32 s45, s43, 1
s_lshl_b32 s45, s45, 2
s_add_u32 s44, s44, s45
s_lshl_b32 s45, s37, 7
s_add_u32 s44, s44, s45
s_cmp_lt_u32 s43, 8
s_cselect_b32 s75, s44, 0x40000000
s_mul_i32 s3, s47, 43
s_lshr_b32 s3, s3, 7
s_mul_i32 s3, s3, 3
s_sub_u32 s3, s47, s3
v_lshlrev_b32 v18, 4, v18
v_lshl_add_u32 v100, v2, 8, v18
v_xor_b32 v101, 64, v100
v_xor_b32 v102, 128, v100
v_xor_b32 v103, 192, v100
v_and_b32 v16, 1, v1
v_lshl_add_u32 v16, v16, 2, v3
v_lshlrev_b32 v16, 5, v16
v_lshl_add_u32 v16, v4, 3, v16
v_lshl_add_u32 v17, v1, 2, v3
v_lshl_add_u32 v16, v17, 8, v16
v_add_u32 v104, 57344, v16
v_xor_b32 v105, 32, v104
v_xor_b32 v106, 64, v104
v_xor_b32 v107, 96, v104
v_xor_b32 v108, 128, v104
v_xor_b32 v109, 160, v104
v_xor_b32 v110, 192, v104
v_xor_b32 v111, 224, v104
v_lshrrev_b32 v8, 1, v1
v_xor_b32 v8, v8, v2
v_lshlrev_b32 v8, 4, v8
v_and_b32 v10, 1, v1
v_lshl_add_u32 v8, v10, 3, v8
v_lshl_add_u32 v8, v2, 10, v8
s_lshl_b32 s43, s39, 6
v_xor_b32 v8, s43, v8
v_add_u32 v11, 147456, v8
s_add_u32 s43, s42, 57344
v_add_u32 v248, s43, v104
v_add_u32 v249, s43, v105
v_add_u32 v250, s43, v106
v_add_u32 v251, s43, v107
v_add_u32 v252, s43, v108
v_add_u32 v253, s43, v109
v_add_u32 v254, s43, v110
v_add_u32 v255, s43, v111
WM 14
s_barrier
ds_read_b64 v[128:129], v11
v_xor_b32 v13, 32, v11
ds_read_b64 v[130:131], v13
v_xor_b32 v12, 64, v11
ds_read_b64 v[132:133], v12
v_xor_b32 v13, 96, v11
ds_read_b64 v[134:135], v13
v_xor_b32 v12, 128, v11
ds_read_b64 v[136:137], v12
v_xor_b32 v13, 160, v11
ds_read_b64 v[138:139], v13
v_xor_b32 v12, 192, v11
ds_read_b64 v[140:141], v12
v_xor_b32 v13, 224, v11
ds_read_b64 v[142:143], v13
v_xor_b32 v12, 256, v11
ds_read_b64 v[144:145], v12
v_xor_b32 v13, 288, v11
ds_read_b64 v[146:147], v13
v_xor_b32 v12, 320, v11
ds_read_b64 v[148:149], v12
v_xor_b32 v13, 352, v11
ds_read_b64 v[150:151], v13
v_xor_b32 v12, 384, v11
ds_read_b64 v[152:153], v12
v_xor_b32 v13, 416, v11
ds_read_b64 v[154:155], v13
v_xor_b32 v12, 448, v11
WL 8
ds_read_b64 v[156:157], v12
v_xor_b32 v13, 480, v11
ds_read_b64 v[158:159], v13
v_xor_b32 v12, 512, v11
ds_read_b64 v[160:161], v12
v_xor_b32 v13, 544, v11
ds_read_b64 v[162:163], v13
v_xor_b32 v12, 576, v11
ds_read_b64 v[164:165], v12
v_xor_b32 v13, 608, v11
ds_read_b64 v[166:167], v13
v_xor_b32 v12, 640, v11
WL 8
ds_read_b64 v[168:169], v12
v_xor_b32 v13, 672, v11
ds_read_b64 v[170:171], v13
v_xor_b32 v12, 704, v11
ds_read_b64 v[172:173], v12
v_xor_b32 v13, 736, v11
ds_read_b64 v[174:175], v13
v_xor_b32 v12, 768, v11
ds_read_b64 v[176:177], v12
v_xor_b32 v13, 800, v11
ds_read_b64 v[178:179], v13
v_xor_b32 v12, 832, v11
WL 8
ds_read_b64 v[180:181], v12
v_xor_b32 v13, 864, v11
ds_read_b64 v[182:183], v13
v_xor_b32 v12, 896, v11
ds_read_b64 v[184:185], v12
v_xor_b32 v13, 928, v11
ds_read_b64 v[186:187], v13
v_xor_b32 v12, 960, v11
ds_read_b64 v[188:189], v12
v_xor_b32 v13, 992, v11
ds_read_b64 v[190:191], v13
WL 0
s_barrier
s_mov_b32 s48, 491520
buffer_load_dwordx4 a[0:3], v112, s[8:11], s48 offen offset:0 nt
buffer_load_dwordx4 a[4:7], v113, s[8:11], s48 offen offset:1024 nt
s_mov_b32 s48, 499712
buffer_load_dwordx4 a[16:19], v112, s[8:11], s48 offen offset:0 nt
buffer_load_dwordx4 a[20:23], v113, s[8:11], s48 offen offset:1024 nt
s_mov_b32 s48, 491520
buffer_load_dwordx4 a[8:11], v114, s[12:15], s48 offen offset:0 nt
buffer_load_dwordx4 a[12:15], v115, s[12:15], s48 offen offset:1024 nt
s_mov_b32 s48, 499712
buffer_load_dwordx4 a[24:27], v114, s[12:15], s48 offen offset:0 nt
buffer_load_dwordx4 a[28:31], v115, s[12:15], s48 offen offset:1024 nt
s_mov_b32 s48, 475136
buffer_load_dwordx4 a[32:35], v112, s[8:11], s48 offen offset:0 nt
buffer_load_dwordx4 a[36:39], v113, s[8:11], s48 offen offset:1024 nt
s_mov_b32 s48, 483328
buffer_load_dwordx4 a[48:51], v112, s[8:11], s48 offen offset:0 nt
buffer_load_dwordx4 a[52:55], v113, s[8:11], s48 offen offset:1024 nt
s_mov_b32 s48, 475136
buffer_load_dwordx4 a[40:43], v114, s[12:15], s48 offen offset:0 nt
buffer_load_dwordx4 a[44:47], v115, s[12:15], s48 offen offset:1024 nt
s_mov_b32 s48, 483328
buffer_load_dwordx4 a[56:59], v114, s[12:15], s48 offen offset:0 nt
buffer_load_dwordx4 a[60:63], v115, s[12:15], s48 offen offset:1024 nt
s_mov_b32 s48, 458752
buffer_load_dwordx4 a[64:67], v112, s[8:11], s48 offen offset:0 nt
buffer_load_dwordx4 a[68:71], v113, s[8:11], s48 offen offset:1024 nt
s_mov_b32 s48, 466944
buffer_load_dwordx4 a[80:83], v112, s[8:11], s48 offen offset:0 nt
buffer_load_dwordx4 a[84:87], v113, s[8:11], s48 offen offset:1024 nt
s_mov_b32 s48, 458752
buffer_load_dwordx4 a[72:75], v114, s[12:15], s48 offen offset:0 nt
buffer_load_dwordx4 a[76:79], v115, s[12:15], s48 offen offset:1024 nt
s_mov_b32 s48, 466944
buffer_load_dwordx4 a[88:91], v114, s[12:15], s48 offen offset:0 nt
buffer_load_dwordx4 a[92:95], v115, s[12:15], s48 offen offset:1024 nt
s_mov_b32 s48, 442368
buffer_load_dwordx4 a[96:99], v112, s[8:11], s48 offen offset:0 nt
buffer_load_dwordx4 a[100:103], v113, s[8:11], s48 offen offset:1024 nt
s_mov_b32 s48, 450560
buffer_load_dwordx4 a[112:115], v112, s[8:11], s48 offen offset:0 nt
buffer_load_dwordx4 a[116:119], v113, s[8:11], s48 offen offset:1024 nt
s_mov_b32 s48, 442368
buffer_load_dwordx4 a[104:107], v114, s[12:15], s48 offen offset:0 nt
buffer_load_dwordx4 a[108:111], v115, s[12:15], s48 offen offset:1024 nt
s_mov_b32 s48, 450560
buffer_load_dwordx4 a[120:123], v114, s[12:15], s48 offen offset:0 nt
buffer_load_dwordx4 a[124:127], v115, s[12:15], s48 offen offset:1024 nt
WM 24
s_mov_b32 s48, 425984
buffer_load_dwordx4 a[128:131], v112, s[8:11], s48 offen offset:0 nt
buffer_load_dwordx4 a[132:135], v113, s[8:11], s48 offen offset:1024 nt
s_mov_b32 s48, 434176
buffer_load_dwordx4 a[144:147], v112, s[8:11], s48 offen offset:0 nt
buffer_load_dwordx4 a[148:151], v113, s[8:11], s48 offen offset:1024 nt
s_mov_b32 s48, 425984
buffer_load_dwordx4 a[136:139], v114, s[12:15], s48 offen offset:0 nt
buffer_load_dwordx4 a[140:143], v115, s[12:15], s48 offen offset:1024 nt
s_mov_b32 s48, 434176
buffer_load_dwordx4 a[152:155], v114, s[12:15], s48 offen offset:0 nt
buffer_load_dwordx4 a[156:159], v115, s[12:15], s48 offen offset:1024 nt
s_mov_b32 s48, 409600
buffer_load_dwordx4 a[160:163], v112, s[8:11], s48 offen offset:0 nt
buffer_load_dwordx4 a[164:167], v113, s[8:11], s48 offen offset:1024 nt
s_mov_b32 s48, 417792
buffer_load_dwordx4 a[176:179], v112, s[8:11], s48 offen offset:0 nt
buffer_load_dwordx4 a[180:183], v113, s[8:11], s48 offen offset:1024 nt
s_mov_b32 s48, 409600
buffer_load_dwordx4 a[168:171], v114, s[12:15], s48 offen offset:0 nt
buffer_load_dwordx4 a[172:175], v115, s[12:15], s48 offen offset:1024 nt
s_mov_b32 s48, 417792
buffer_load_dwordx4 a[184:187], v114, s[12:15], s48 offen offset:0 nt
buffer_load_dwordx4 a[188:191], v115, s[12:15], s48 offen offset:1024 nt
s_mov_b32 s48, 393216
buffer_load_dwordx4 a[192:195], v112, s[8:11], s48 offen offset:0 nt
buffer_load_dwordx4 a[196:199], v113, s[8:11], s48 offen offset:1024 nt
s_mov_b32 s48, 401408
buffer_load_dwordx4 a[208:211], v112, s[8:11], s48 offen offset:0 nt
buffer_load_dwordx4 a[212:215], v113, s[8:11], s48 offen offset:1024 nt
s_mov_b32 s48, 393216
buffer_load_dwordx4 a[200:203], v114, s[12:15], s48 offen offset:0 nt
buffer_load_dwordx4 a[204:207], v115, s[12:15], s48 offen offset:1024 nt
s_mov_b32 s48, 401408
buffer_load_dwordx4 a[216:219], v114, s[12:15], s48 offen offset:0 nt
buffer_load_dwordx4 a[220:223], v115, s[12:15], s48 offen offset:1024 nt
WM 26
s_mov_b32 s48, 376832
buffer_load_dwordx4 a[224:227], v112, s[8:11], s48 offen offset:0 nt
buffer_load_dwordx4 a[228:231], v113, s[8:11], s48 offen offset:1024 nt
s_mov_b32 s48, 385024
buffer_load_dwordx4 a[240:243], v112, s[8:11], s48 offen offset:0 nt
buffer_load_dwordx4 a[244:247], v113, s[8:11], s48 offen offset:1024 nt
s_mov_b32 s48, 376832
buffer_load_dwordx4 a[232:235], v114, s[12:15], s48 offen offset:0 nt
buffer_load_dwordx4 a[236:239], v115, s[12:15], s48 offen offset:1024 nt
s_mov_b32 s48, 385024
buffer_load_dwordx4 a[248:251], v114, s[12:15], s48 offen offset:0 nt
buffer_load_dwordx4 a[252:255], v115, s[12:15], s48 offen offset:1024 nt
s_mov_b32 s48, 368640
buffer_load_dwordx4 v[232:235], v112, s[8:11], s48 offen offset:0 nt
buffer_load_dwordx4 v[236:239], v113, s[8:11], s48 offen offset:1024 nt
s_mov_b32 s48, 368640
buffer_load_dwordx4 v[240:243], v114, s[12:15], s48 offen offset:0 nt
buffer_load_dwordx4 v[244:247], v115, s[12:15], s48 offen offset:1024 nt
s_xor_b32 s43, s40, 0
s_lshl_b32 s43, s43, 17
s_add_u32 m0, s42, 114688
s_nop 0
DH 224,16,0
s_add_u32 s43, s43, 31744
DH 225,16,1024
s_add_u32 s43, s43, 31744
DH 224,16,2048
s_add_u32 s43, s43, 31744
DH 225,16,3072
s_xor_b32 s43, s40, 1
s_lshl_b32 s43, s43, 17
s_add_u32 m0, s42, 131072
s_nop 0
DH 224,16,0
s_add_u32 s43, s43, 31744
DH 225,16,1024
s_add_u32 s43, s43, 31744
DH 224,16,2048
s_add_u32 s43, s43, 31744
DH 225,16,3072
s_xor_b32 s43, s40, 2
s_lshl_b32 s43, s43, 17
s_add_u32 m0, s42, 147456
s_nop 0
DH 224,16,0
s_add_u32 s43, s43, 31744
DH 225,16,1024
s_add_u32 s43, s43, 31744
DH 224,16,2048
s_add_u32 s43, s43, 31744
DH 225,16,3072
WM 8
TR 56,248,0
TR 60,249,0
TR 64,250,0
TR 68,251,0
TR 72,252,0
TR 76,253,0
TR 80,254,0
TR 84,255,0
WL 0
s_xor_b32 s43, s40, 3
s_lshl_b32 s43, s43, 17
s_add_u32 m0, s42, 114688
s_nop 0
DH 224,16,0
s_add_u32 s43, s43, 31744
DH 225,16,1024
s_add_u32 s43, s43, 31744
DH 224,16,2048
s_add_u32 s43, s43, 31744
DH 225,16,3072
WM 8
TR 58,248,16384
TR 62,249,16384
TR 66,250,16384
TR 70,251,16384
TR 74,252,16384
TR 78,253,16384
TR 82,254,16384
TR 86,255,16384
WL 0
s_xor_b32 s43, s40, 4
s_lshl_b32 s43, s43, 17
s_add_u32 m0, s42, 131072
s_nop 0
DH 224,16,0
s_add_u32 s43, s43, 31744
DH 225,16,1024
s_add_u32 s43, s43, 31744
DH 224,16,2048
s_add_u32 s43, s43, 31744
DH 225,16,3072
WM 8
TR 192,248,32768
TR 196,249,32768
TR 200,250,32768
TR 204,251,32768
TR 208,252,32768
TR 212,253,32768
TR 216,254,32768
TR 220,255,32768
WL 0
s_xor_b32 s43, s40, 5
s_lshl_b32 s43, s43, 17
s_add_u32 m0, s42, 147456
s_nop 0
DH 224,16,0
s_add_u32 s43, s43, 31744
DH 225,16,1024
s_add_u32 s43, s43, 31744
DH 224,16,2048
s_add_u32 s43, s43, 31744
DH 225,16,3072
MZ 8,56,128
MZ 12,60,128
MZ 16,64,128
MZ 20,68,128
WM 8
TR 194,248,0
TR 198,249,0
TR 202,250,0
TR 206,251,0
TR 210,252,0
TR 214,253,0
TR 218,254,0
TR 222,255,0
WL 0
s_xor_b32 s43, s40, 6
s_lshl_b32 s43, s43, 17
s_add_u32 m0, s42, 114688
s_nop 0
DH 224,16,0
s_add_u32 s43, s43, 31744
DH 225,16,1024
s_add_u32 s43, s43, 31744
DH 224,16,2048
s_add_u32 s43, s43, 31744
DH 225,16,3072
MZ 24,72,128
MZ 28,76,128
MZ 32,80,128
MZ 36,84,128
WM 8
TR 56,248,16384
TR 60,249,16384
TR 64,250,16384
TR 68,251,16384
TR 72,252,16384
TR 76,253,16384
TR 80,254,16384
TR 84,255,16384
WL 0
s_xor_b32 s43, s40, 7
s_lshl_b32 s43, s43, 17
s_add_u32 m0, s42, 131072
s_nop 0
DH 224,16,0
s_add_u32 s43, s43, 31744
DH 225,16,1024
s_add_u32 s43, s43, 31744
DH 224,16,2048
s_add_u32 s43, s43, 31744
DH 225,16,3072
MM 8,192,132
MM 12,196,132
MM 16,200,132
MM 20,204,132
v_readfirstlane_b32 s49, v6
s_nop 0
s_mul_i32 s53, s49, 0x9e3779b1
s_add_u32 s53, s53, 0x7f4a7c15
WM 8
TR 58,248,32768
TR 62,249,32768
TR 66,250,32768
TR 70,251,32768
TR 74,252,32768
TR 78,253,32768
TR 82,254,32768
TR 86,255,32768
WL 0
s_xor_b32 s43, s40, 8
s_lshl_b32 s43, s43, 17
s_add_u32 m0, s42, 147456
s_nop 0
DH 224,16,0
s_add_u32 s43, s43, 31744
DH 225,16,1024
s_add_u32 s43, s43, 31744
DH 224,16,2048
s_add_u32 s43, s43, 31744
DH 225,16,3072
MM 24,208,132
MM 28,212,132
MM 32,216,132
MM 36,220,132
WM 8
TR 192,248,0
TR 196,249,0
TR 200,250,0
TR 204,251,0
TR 208,252,0
TR 212,253,0
TR 216,254,0
TR 220,255,0
WL 0
s_xor_b32 s43, s40, 9
s_lshl_b32 s43, s43, 17
s_add_u32 m0, s42, 114688
s_nop 0
DH 224,16,0
s_add_u32 s43, s43, 31744
DH 225,16,1024
s_add_u32 s43, s43, 31744
DH 224,16,2048
s_add_u32 s43, s43, 31744
DH 225,16,3072
MM 8,56,136
MM 12,60,136
MM 16,64,136
MM 20,68,136
WM 8
TR 194,248,16384
TR 198,249,16384
TR 202,250,16384
TR 206,251,16384
TR 210,252,16384
TR 214,253,16384
TR 218,254,16384
TR 222,255,16384
WL 0
s_xor_b32 s43, s40, 10
s_lshl_b32 s43, s43, 17
s_add_u32 m0, s42, 131072
s_nop 0
DH 224,16,0
s_add_u32 s43, s43, 31744
DH 225,16,1024
s_add_u32 s43, s43, 31744
DH 224,16,2048
s_add_u32 s43, s43, 31744
DH 225,16,3072
MM 24,72,136
MM 28,76,136
MM 32,80,136
MM 36,84,136
WM 8
TR 56,248,32768
TR 60,249,32768
TR 64,250,32768
TR 68,251,32768
TR 72,252,32768
TR 76,253,32768
TR 80,254,32768
TR 84,255,32768
WL 0
s_xor_b32 s43, s40, 11
s_lshl_b32 s43, s43, 17
s_add_u32 m0, s42, 147456
s_nop 0
DH 224,16,0
s_add_u32 s43, s43, 31744
DH 225,16,1024
s_add_u32 s43, s43, 31744
DH 224,16,2048
s_add_u32 s43, s43, 31744
DH 225,16,3072
MM 8,192,140
MM 12,196,140
MM 16,200,140
MM 20,204,140
WM 8
TR 58,248,0
TR 62,249,0
TR 66,250,0
TR 70,251,0
TR 74,252,0
TR 78,253,0
TR 82,254,0
TR 86,255,0
WL 0
s_xor_b32 s43, s40, 12
s_lshl_b32 s43, s43, 17
s_add_u32 m0, s42, 114688
s_nop 0
DH 224,16,0
s_add_u32 s43, s43, 31744
DH 225,16,1024
s_add_u32 s43, s43, 31744
DH 224,16,2048
s_add_u32 s43, s43, 31744
DH 225,16,3072
MM 24,208,140
MM 28,212,140
MM 32,216,140
MM 36,220,140
WM 8
TR 192,248,16384
TR 196,249,16384
TR 200,250,16384
TR 204,251,16384
TR 208,252,16384
TR 212,253,16384
TR 216,254,16384
TR 220,255,16384
WL 0
s_xor_b32 s43, s40, 13
s_lshl_b32 s43, s43, 17
s_add_u32 m0, s42, 131072
s_nop 0
DH 224,16,0
s_add_u32 s43, s43, 31744
DH 225,16,1024
s_add_u32 s43, s43, 31744
DH 224,16,2048
s_add_u32 s43, s43, 31744
DH 225,16,3072
MM 8,56,144
MM 12,60,144
MM 16,64,144
MM 20,68,144
WM 8
TR 194,248,32768
TR 198,249,32768
TR 202,250,32768
TR 206,251,32768
TR 210,252,32768
TR 214,253,32768
TR 218,254,32768
TR 222,255,32768
WL 0
s_xor_b32 s43, s40, 14
s_lshl_b32 s43, s43, 17
s_add_u32 m0, s42, 147456
s_nop 0
DH 224,16,0
s_add_u32 s43, s43, 31744
DH 225,16,1024
s_add_u32 s43, s43, 31744
DH 224,16,2048
s_add_u32 s43, s43, 31744
DH 225,16,3072
MM 24,72,144
MM 28,76,144
MM 32,80,144
MM 36,84,144
WM 8
TR 56,248,0
TR 60,249,0
TR 64,250,0
TR 68,251,0
TR 72,252,0
TR 76,253,0
TR 80,254,0
TR 84,255,0
WL 0
s_xor_b32 s43, s40, 15
s_lshl_b32 s43, s43, 17
s_add_u32 m0, s42, 114688
s_nop 0
DH 224,16,0
s_add_u32 s43, s43, 31744
DH 225,16,1024
s_add_u32 s43, s43, 31744
DH 224,16,2048
s_add_u32 s43, s43, 31744
DH 225,16,3072
MM 8,192,148
MM 12,196,148
MM 16,200,148
MM 20,204,148
WM 8
TR 58,248,16384
TR 62,249,16384
TR 66,250,16384
TR 70,251,16384
TR 74,252,16384
TR 78,253,16384
TR 82,254,16384
TR 86,255,16384
WL 0
s_xor_b32 s43, s40, 16
s_lshl_b32 s43, s43, 17
s_add_u32 m0, s42, 131072
s_nop 0
DH 224,16,0
s_add_u32 s43, s43, 31744
DH 225,16,1024
s_add_u32 s43, s43, 31744
DH 224,16,2048
s_add_u32 s43, s43, 31744
DH 225,16,3072
MM 24,208,148
MM 28,212,148
MM 32,216,148
MM 36,220,148
WM 8
TR 192,248,32768
TR 196,249,32768
TR 200,250,32768
TR 204,251,32768
TR 208,252,32768
TR 212,253,32768
TR 216,254,32768
TR 220,255,32768
WL 0
s_xor_b32 s43, s40, 17
s_lshl_b32 s43, s43, 17
s_add_u32 m0, s42, 147456
s_nop 0
DH 224,16,0
s_add_u32 s43, s43, 31744
DH 225,16,1024
s_add_u32 s43, s43, 31744
DH 224,16,2048
s_add_u32 s43, s43, 31744
DH 225,16,3072
MM 8,56,152
MM 12,60,152
MM 16,64,152
MM 20,68,152
WM 8
TR 194,248,0
TR 198,249,0
TR 202,250,0
TR 206,251,0
TR 210,252,0
TR 214,253,0
TR 218,254,0
TR 222,255,0
WL 0
s_xor_b32 s43, s40, 18
s_lshl_b32 s43, s43, 17
s_add_u32 m0, s42, 114688
s_nop 0
DH 224,16,0
s_add_u32 s43, s43, 31744
DH 225,16,1024
s_add_u32 s43, s43, 31744
DH 224,16,2048
s_add_u32 s43, s43, 31744
DH 225,16,3072
MM 24,72,152
MM 28,76,152
MM 32,80,152
MM 36,84,152
WM 8
TR 56,248,16384
TR 60,249,16384
TR 64,250,16384
TR 68,251,16384
TR 72,252,16384
TR 76,253,16384
TR 80,254,16384
TR 84,255,16384
WL 0
s_xor_b32 s43, s40, 19
s_lshl_b32 s43, s43, 17
s_add_u32 m0, s42, 131072
s_nop 0
DH 224,16,0
s_add_u32 s43, s43, 31744
DH 225,16,1024
s_add_u32 s43, s43, 31744
DH 224,16,2048
s_add_u32 s43, s43, 31744
DH 225,16,3072
MM 8,192,156
MM 12,196,156
MM 16,200,156
MM 20,204,156
WM 8
TR 58,248,32768
TR 62,249,32768
TR 66,250,32768
TR 70,251,32768
TR 74,252,32768
TR 78,253,32768
TR 82,254,32768
TR 86,255,32768
WL 0
s_xor_b32 s43, s40, 20
s_lshl_b32 s43, s43, 17
s_add_u32 m0, s42, 147456
s_nop 0
DH 224,16,0
s_add_u32 s43, s43, 31744
DH 225,16,1024
s_add_u32 s43, s43, 31744
DH 224,16,2048
s_add_u32 s43, s43, 31744
DH 225,16,3072
MM 24,208,156
MM 28,212,156
MM 32,216,156
MM 36,220,156
WM 8
TR 192,248,0
TR 196,249,0
TR 200,250,0
TR 204,251,0
TR 208,252,0
TR 212,253,0
TR 216,254,0
TR 220,255,0
WL 0
s_xor_b32 s43, s40, 21
s_lshl_b32 s43, s43, 17
s_add_u32 m0, s42, 114688
s_nop 0
DH 224,16,0
s_add_u32 s43, s43, 31744
DH 225,16,1024
s_add_u32 s43, s43, 31744
DH 224,16,2048
s_add_u32 s43, s43, 31744
DH 225,16,3072
MM 8,56,160
MM 12,60,160
MM 16,64,160
MM 20,68,160
WM 8
TR 194,248,16384
TR 198,249,16384
TR 202,250,16384
TR 206,251,16384
TR 210,252,16384
TR 214,253,16384
TR 218,254,16384
TR 222,255,16384
WL 0
s_xor_b32 s43, s40, 22
s_lshl_b32 s43, s43, 17
s_add_u32 m0, s42, 131072
s_nop 0
DH 224,16,0
s_add_u32 s43, s43, 31744
DH 225,16,1024
s_add_u32 s43, s43, 31744
DH 224,16,2048
s_add_u32 s43, s43, 31744
DH 225,16,3072
MM 24,72,160
MM 28,76,160
MM 32,80,160
MM 36,84,160
WM 8
TR 56,248,32768
TR 60,249,32768
TR 64,250,32768
TR 68,251,32768
TR 72,252,32768
TR 76,253,32768
TR 80,254,32768
TR 84,255,32768
WL 0
s_xor_b32 s43, s40, 23
s_lshl_b32 s43, s43, 17
s_add_u32 m0, s42, 147456
s_nop 0
DH 224,16,0
s_add_u32 s43, s43, 31744
DH 225,16,1024
s_add_u32 s43, s43, 31744
DH 224,16,2048
s_add_u32 s43, s43, 31744
DH 225,16,3072
MM 8,192,164
MM 12,196,164
MM 16,200,164
MM 20,204,164
WM 8
TR 58,248,0
TR 62,249,0
TR 66,250,0
TR 70,251,0
TR 74,252,0
TR 78,253,0
TR 82,254,0
TR 86,255,0
WL 0
s_xor_b32 s43, s40, 24
s_lshl_b32 s43, s43, 17
s_add_u32 m0, s42, 114688
s_nop 0
DH 224,16,0
s_add_u32 s43, s43, 31744
DH 225,16,1024
s_add_u32 s43, s43, 31744
DH 224,16,2048
s_add_u32 s43, s43, 31744
DH 225,16,3072
MM 24,208,164
MM 28,212,164
MM 32,216,164
MM 36,220,164
WM 8
TR 192,248,16384
TR 196,249,16384
TR 200,250,16384
TR 204,251,16384
TR 208,252,16384
TR 212,253,16384
TR 216,254,16384
TR 220,255,16384
WL 0
s_xor_b32 s43, s40, 25
s_lshl_b32 s43, s43, 17
s_add_u32 m0, s42, 131072
s_nop 0
DH 224,16,0
s_add_u32 s43, s43, 31744
DH 225,16,1024
s_add_u32 s43, s43, 31744
DH 224,16,2048
s_add_u32 s43, s43, 31744
DH 225,16,3072
MM 8,56,168
MM 12,60,168
MM 16,64,168
MM 20,68,168
WM 8
TR 194,248,32768
TR 198,249,32768
TR 202,250,32768
TR 206,251,32768
TR 210,252,32768
TR 214,253,32768
TR 218,254,32768
TR 222,255,32768
WL 0
s_xor_b32 s43, s40, 26
s_lshl_b32 s43, s43, 17
s_add_u32 m0, s42, 147456
s_nop 0
DH 224,16,0
s_add_u32 s43, s43, 31744
DH 225,16,1024
s_add_u32 s43, s43, 31744
DH 224,16,2048
s_add_u32 s43, s43, 31744
DH 225,16,3072
MM 24,72,168
MM 28,76,168
MM 32,80,168
MM 36,84,168
WM 8
TR 56,248,0
TR 60,249,0
TR 64,250,0
TR 68,251,0
TR 72,252,0
TR 76,253,0
TR 80,254,0
TR 84,255,0
WL 0
s_xor_b32 s43, s40, 27
s_lshl_b32 s43, s43, 17
s_add_u32 m0, s42, 114688
s_nop 0
DH 224,16,0
s_add_u32 s43, s43, 31744
DH 225,16,1024
s_add_u32 s43, s43, 31744
DH 224,16,2048
s_add_u32 s43, s43, 31744
DH 225,16,3072
MM 8,192,172
MM 12,196,172
MM 16,200,172
MM 20,204,172
WM 8
TR 58,248,16384
TR 62,249,16384
TR 66,250,16384
TR 70,251,16384
TR 74,252,16384
TR 78,253,16384
TR 82,254,16384
TR 86,255,16384
WL 0
s_xor_b32 s43, s40, 28
s_lshl_b32 s43, s43, 17
s_add_u32 m0, s42, 131072
s_nop 0
DH 224,16,0
s_add_u32 s43, s43, 31744
DH 225,16,1024
s_add_u32 s43, s43, 31744
DH 224,16,2048
s_add_u32 s43, s43, 31744
DH 225,16,3072
MM 24,208,172
MM 28,212,172
MM 32,216,172
MM 36,220,172
WM 8
TR 192,248,32768
TR 196,249,32768
TR 200,250,32768
TR 204,251,32768
TR 208,252,32768
TR 212,253,32768
TR 216,254,32768
TR 220,255,32768
WL 0
s_xor_b32 s43, s40, 29
s_lshl_b32 s43, s43, 17
s_add_u32 m0, s42, 147456
s_nop 0
DH 224,16,0
s_add_u32 s43, s43, 31744
DH 225,16,1024
s_add_u32 s43, s43, 31744
DH 224,16,2048
s_add_u32 s43, s43, 31744
DH 225,16,3072
MM 8,56,176
MM 12,60,176
MM 16,64,176
MM 20,68,176
WM 8
TR 194,248,0
TR 198,249,0
TR 202,250,0
TR 206,251,0
TR 210,252,0
TR 214,253,0
TR 218,254,0
TR 222,255,0
WL 0
s_xor_b32 s43, s40, 30
s_lshl_b32 s43, s43, 17
s_add_u32 m0, s42, 114688
s_nop 0
DH 224,16,0
s_add_u32 s43, s43, 31744
DH 225,16,1024
s_add_u32 s43, s43, 31744
DH 224,16,2048
s_add_u32 s43, s43, 31744
DH 225,16,3072
MM 24,72,176
MM 28,76,176
MM 32,80,176
MM 36,84,176
WM 8
TR 56,248,16384
TR 60,249,16384
TR 64,250,16384
TR 68,251,16384
TR 72,252,16384
TR 76,253,16384
TR 80,254,16384
TR 84,255,16384
WL 0
s_xor_b32 s43, s40, 31
s_lshl_b32 s43, s43, 17
s_add_u32 m0, s42, 131072
s_nop 0
DH 224,16,0
s_add_u32 s43, s43, 31744
DH 225,16,1024
s_add_u32 s43, s43, 31744
DH 224,16,2048
s_add_u32 s43, s43, 31744
DH 225,16,3072
MM 8,192,180
MM 12,196,180
MM 16,200,180
MM 20,204,180
WM 8
TR 58,248,32768
TR 62,249,32768
TR 66,250,32768
TR 70,251,32768
TR 74,252,32768
TR 78,253,32768
TR 82,254,32768
TR 86,255,32768
WL 0
MM 24,208,180
MM 28,212,180
MM 32,216,180
MM 36,220,180
s_mov_b32 s48, 16384
s_add_u32 m0, s41, 57344
s_nop 0
DM 114,12,0
DM 115,12,1024
s_mov_b32 s48, 32768
s_add_u32 m0, s41, 16384
s_nop 0
DM 112,8,0
DM 113,8,1024
WM 8
TR 192,248,0
TR 196,249,0
TR 200,250,0
TR 204,251,0
TR 208,252,0
TR 212,253,0
TR 216,254,0
TR 220,255,0
WL 0
MM 8,56,184
MM 12,60,184
MM 16,64,184
MM 20,68,184
s_mov_b32 s48, 24576
s_add_u32 m0, s41, 65536
s_nop 0
DM 114,12,0
DM 115,12,1024
WM 6
TR 194,248,16384
TR 198,249,16384
TR 202,250,16384
TR 206,251,16384
TR 210,252,16384
TR 214,253,16384
TR 218,254,16384
TR 222,255,16384
WL 0
MM 24,72,184
MM 28,76,184
MM 32,80,184
MM 36,84,184
MM 8,192,188
MM 12,196,188
MM 16,200,188
MM 20,204,188
MM 24,208,188
MM 28,212,188
MM 32,216,188
MM 36,220,188
s_nop 2
v_mul_f32 v8, s50, v8
v_mul_f32 v9, s50, v9
v_mul_f32 v10, s50, v10
v_mul_f32 v11, s50, v11
v_mul_f32 v12, s50, v12
v_mul_f32 v13, s50, v13
v_mul_f32 v14, s50, v14
v_mul_f32 v15, s50, v15
v_mul_f32 v16, s50, v16
v_mul_f32 v17, s50, v17
v_mul_f32 v18, s50, v18
v_mul_f32 v19, s50, v19
v_mul_f32 v20, s50, v20
v_mul_f32 v21, s50, v21
v_mul_f32 v22, s50, v22
v_mul_f32 v23, s50, v23
v_mul_f32 v24, s50, v24
v_mul_f32 v25, s50, v25
v_mul_f32 v26, s50, v26
v_mul_f32 v27, s50, v27
v_mul_f32 v28, s50, v28
v_mul_f32 v29, s50, v29
v_mul_f32 v30, s50, v30
v_mul_f32 v31, s50, v31
v_mul_f32 v32, s50, v32
v_mul_f32 v33, s50, v33
v_mul_f32 v34, s50, v34
v_mul_f32 v35, s50, v35
v_mul_f32 v36, s50, v36
v_mul_f32 v37, s50, v37
v_mul_f32 v38, s50, v38
v_mul_f32 v39, s50, v39
CV 40,8
CV 42,12
CV 41,10
CV 43,14
CV 44,16
CV 46,20
CV 45,18
CV 47,22
CV 48,24
CV 50,28
CV 49,26
CV 51,30
CV 52,32
CV 54,36
CV 53,34
CV 55,38
v_permlane32_swap_b32 v40, v42
v_permlane32_swap_b32 v41, v43
v_permlane32_swap_b32 v44, v46
v_permlane32_swap_b32 v45, v47
v_permlane32_swap_b32 v48, v50
v_permlane32_swap_b32 v49, v51
v_permlane32_swap_b32 v52, v54
v_permlane32_swap_b32 v53, v55
v_permlane16_swap_b32 v40, v42
v_permlane16_swap_b32 v41, v43
v_permlane16_swap_b32 v44, v46
v_permlane16_swap_b32 v45, v47
v_permlane16_swap_b32 v48, v50
v_permlane16_swap_b32 v49, v51
v_permlane16_swap_b32 v52, v54
v_permlane16_swap_b32 v53, v55
WL 0
s_barrier
KR 56,100,40960
KR 60,100,45056
KR 64,101,40960
KR 68,101,45056
KR 72,102,40960
KR 76,102,45056
KR 80,103,40960
KR 84,103,45056
WL 4
MZ 88,56,40
MZ 92,60,40
MM 88,64,44
MM 92,68,44
WL 0
MM 88,72,48
MM 92,76,48
MM 88,80,52
MM 92,84,52
WL 0
s_barrier
KR 56,100,49152
KR 60,100,53248
KR 64,101,49152
KR 68,101,53248
KR 72,102,49152
KR 76,102,53248
KR 80,103,49152
KR 84,103,53248
WL 4
MZ 0,56,40
TR 56,104,40960
TR 58,104,45056
MZ 4,60,40
TR 60,105,40960
TR 62,105,45056
MM 0,64,44
TR 64,106,40960
TR 66,106,45056
MM 4,68,44
TR 68,107,40960
TR 70,107,45056
WL 8
MM 0,72,48
TR 72,108,40960
TR 74,108,45056
MM 4,76,48
TR 76,109,40960
TR 78,109,45056
MM 0,80,52
TR 80,110,40960
TR 82,110,45056
MM 4,84,52
WL 12
TR 84,111,40960
TR 86,111,45056
v_max3_f32 v120, v88, v89, v90
v_max3_f32 v121, v91, v92, v93
v_max3_f32 v120, v120, v94, v95
v_max_f32 v120, v120, v121
v_mov_b32 v121, v120
s_nop 1
v_permlane32_swap_b32 v120, v121
v_max_f32 v120, v120, v121
v_mov_b32 v121, v120
s_nop 1
v_permlane16_swap_b32 v120, v121
v_max_f32 v120, v120, v121
v_sub_f32 v124, 0, v120
v_sub_f32 v125, 0, v120
v_sub_f32 v126, 0, v120
v_sub_f32 v127, 0, v120
v_sub_f32 v88, v88, v120
v_sub_f32 v89, v89, v120
v_sub_f32 v90, v90, v120
v_sub_f32 v91, v91, v120
v_sub_f32 v92, v92, v120
v_sub_f32 v93, v93, v120
v_sub_f32 v94, v94, v120
v_sub_f32 v95, v95, v120
EX 88
EX 89
EX 90
EX 91
EX 92
EX 93
EX 94
EX 95
CV 96,88
CV 97,90
CV 98,92
CV 99,94
WL 0
s_barrier
MZ 8,56,96
KR 56,100,24576
v_mov_b32 v119, v88
MZ 12,60,96
KR 60,100,28672
AD 89
MZ 16,64,96
KR 64,101,24576
AD 90
MZ 20,68,96
KR 68,101,28672
AD 91
MZ 24,72,96
KR 72,102,24576
AD 92
MZ 28,76,96
KR 76,102,28672
AD 93
MZ 32,80,96
KR 80,103,24576
AD 94
MZ 36,84,96
KR 84,103,28672
AD 95
WL 4
MN 88,56,40
TR 56,104,49152
TR 58,104,53248
MN 92,60,40
TR 60,105,49152
TR 62,105,53248
MM 88,64,44
TR 64,106,49152
TR 66,106,53248
MM 92,68,44
TR 68,107,49152
TR 70,107,53248
WL 8
MM 88,72,48
TR 72,108,49152
TR 74,108,53248
MM 92,76,48
TR 76,109,49152
TR 78,109,53248
MM 88,80,52
TR 80,110,49152
TR 82,110,53248
MM 92,84,52
WL 12
TR 84,111,49152
TR 86,111,53248
WL 8
s_add_u32 s43, s41, 40960
v_add_u32 v122, s43, v118
ds_write_b128 v122, a[0:3] offset:0
ds_write_b128 v122, a[4:7] offset:1024
ds_write_b128 v122, a[8:11] offset:57344
ds_write_b128 v122, a[12:15] offset:58368
v_add_f32 v0, v0, v124
v_add_f32 v1, v1, v124
v_add_f32 v2, v2, v124
v_add_f32 v3, v3, v124
v_add_f32 v4, v4, v124
v_add_f32 v5, v5, v124
v_add_f32 v6, v6, v124
v_add_f32 v7, v7, v124
v_max3_f32 v120, v0, v1, v2
v_max3_f32 v121, v3, v4, v5
v_max3_f32 v120, v120, v6, v7
v_max_f32 v120, v120, v121
v_cmp_lt_f32 vcc, s51, v120
s_cbranch_vccnz L_tramp2_1
L_back2_1:
EX 0
EX 1
EX 2
EX 3
EX 4
EX 5
EX 6
EX 7
CV 96,0
CV 97,2
CV 98,4
CV 99,6
WL 0
s_barrier
MM 8,56,96
KR 56,100,32768
AD 0
MM 12,60,96
KR 60,100,36864
AD 1
MM 16,64,96
KR 64,101,32768
AD 2
MM 20,68,96
KR 68,101,36864
AD 3
MM 24,72,96
KR 72,102,32768
AD 4
MM 28,76,96
KR 76,102,36864
AD 5
MM 32,80,96
KR 80,103,32768
AD 6
MM 36,84,96
KR 84,103,36864
AD 7
WL 4
MN 0,56,40
TR 56,104,24576
TR 58,104,28672
MN 4,60,40
TR 60,105,24576
TR 62,105,28672
v_max3_f32 v120, v88, v89, v90
MM 0,64,44
TR 64,106,24576
TR 66,106,28672
v_max3_f32 v121, v91, v92, v93
MM 4,68,44
TR 68,107,24576
TR 70,107,28672
v_max3_f32 v120, v120, v94, v95
WL 8
MM 0,72,48
TR 72,108,24576
TR 74,108,28672
v_max_f32 v120, v120, v121
MM 4,76,48
TR 76,109,24576
TR 78,109,28672
MM 0,80,52
TR 80,110,24576
TR 82,110,28672
MM 4,84,52
WL 12
TR 84,111,24576
TR 86,111,28672
WL 8
s_add_u32 s43, s41, 49152
v_add_u32 v122, s43, v118
ds_write_b128 v122, a[16:19] offset:0
ds_write_b128 v122, a[20:23] offset:1024
ds_write_b128 v122, a[24:27] offset:57344
ds_write_b128 v122, a[28:31] offset:58368
v_cmp_lt_f32 vcc, s51, v120
s_cbranch_vccnz L_tramp2_2
L_back2_2:
EX 88
EX 89
EX 90
EX 91
EX 92
EX 93
EX 94
EX 95
CV 96,88
CV 97,90
CV 98,92
CV 99,94
WL 0
s_barrier
MM 8,56,96
s_mov_b32 s48, 40960
s_add_u32 m0, s41, 24576
KR 56,100,40960
AD 88
DM 112,8,0
MM 12,60,96
KR 60,100,45056
AD 89
MM 16,64,96
KR 64,101,40960
AD 90
MM 20,68,96
KR 68,101,45056
AD 91
MM 24,72,96
KR 72,102,40960
AD 92
MM 28,76,96
KR 76,102,45056
AD 93
MM 32,80,96
KR 80,103,40960
AD 94
DM 113,8,1024
MM 36,84,96
KR 84,103,45056
AD 95
WL 4
MN 88,56,40
TR 56,104,32768
TR 58,104,36864
MN 92,60,40
s_mov_b32 s48, 32768
s_add_u32 m0, s41, 73728
TR 60,105,32768
TR 62,105,36864
DM 114,12,0
v_max3_f32 v120, v0, v1, v2
MM 88,64,44
TR 64,106,32768
TR 66,106,36864
v_max3_f32 v121, v3, v4, v5
MM 92,68,44
TR 68,107,32768
TR 70,107,36864
v_max3_f32 v120, v120, v6, v7
WL 8
MM 88,72,48
TR 72,108,32768
TR 74,108,36864
v_max_f32 v120, v120, v121
MM 92,76,48
TR 76,109,32768
TR 78,109,36864
DM 115,12,1024
MM 88,80,52
TR 80,110,32768
TR 82,110,36864
MM 92,84,52
WL 12
TR 84,111,32768
TR 86,111,36864
v_cmp_lt_f32 vcc, s51, v120
s_cbranch_vccnz L_tramp2_3
L_back2_3:
EX 0
EX 1
EX 2
EX 3
EX 4
EX 5
EX 6
EX 7
CV 96,0
CV 97,2
CV 98,4
CV 99,6
WL 0
s_barrier
MM 8,56,96
KR 56,100,0
AD 0
MM 12,60,96
KR 60,100,4096
AD 1
MM 16,64,96
KR 64,101,0
AD 2
MM 20,68,96
KR 68,101,4096
AD 3
MM 24,72,96
KR 72,102,0
AD 4
MM 28,76,96
KR 76,102,4096
AD 5
MM 32,80,96
KR 80,103,0
AD 6
MM 36,84,96
KR 84,103,4096
AD 7
WL 4
MN 0,56,40
TR 56,104,40960
TR 58,104,45056
MN 4,60,40
TR 60,105,40960
TR 62,105,45056
v_max3_f32 v120, v88, v89, v90
MM 0,64,44
TR 64,106,40960
TR 66,106,45056
v_max3_f32 v121, v91, v92, v93
MM 4,68,44
TR 68,107,40960
TR 70,107,45056
v_max3_f32 v120, v120, v94, v95
WL 8
MM 0,72,48
TR 72,108,40960
TR 74,108,45056
v_max_f32 v120, v120, v121
MM 4,76,48
TR 76,109,40960
TR 78,109,45056
MM 0,80,52
TR 80,110,40960
TR 82,110,45056
MM 4,84,52
WL 12
TR 84,111,40960
TR 86,111,45056
v_cmp_lt_f32 vcc, s51, v120
s_cbranch_vccnz L_tramp2_4
L_back2_4:
EX 88
EX 89
EX 90
EX 91
EX 92
EX 93
EX 94
EX 95
CV 96,88
CV 97,90
CV 98,92
CV 99,94
WB 8
s_barrier
MM 8,56,96
s_mov_b32 s48, 49152
s_add_u32 m0, s41, 32768
KR 56,100,8192
AD 88
DM 112,8,0
MM 12,60,96
KR 60,100,12288
AD 89
MM 16,64,96
KR 64,101,8192
AD 90
MM 20,68,96
KR 68,101,12288
AD 91
MM 24,72,96
KR 72,102,8192
AD 92
MM 28,76,96
KR 76,102,12288
AD 93
MM 32,80,96
KR 80,103,8192
AD 94
DM 113,8,1024
MM 36,84,96
KR 84,103,12288
AD 95
WL 4
MN 88,56,40
TR 56,104,0
TR 58,104,4096
MN 92,60,40
s_mov_b32 s48, 40960
s_add_u32 m0, s41, 81920
TR 60,105,0
TR 62,105,4096
DM 114,12,0
v_max3_f32 v120, v0, v1, v2
MM 88,64,44
TR 64,106,0
TR 66,106,4096
v_max3_f32 v121, v3, v4, v5
MM 92,68,44
TR 68,107,0
TR 70,107,4096
v_max3_f32 v120, v120, v6, v7
WL 8
MM 88,72,48
TR 72,108,0
TR 74,108,4096
v_max_f32 v120, v120, v121
MM 92,76,48
TR 76,109,0
TR 78,109,4096
DM 115,12,1024
MM 88,80,52
TR 80,110,0
TR 82,110,4096
MM 92,84,52
WL 12
TR 84,111,0
TR 86,111,4096
WL 8
s_add_u32 s43, s41, 40960
v_add_u32 v122, s43, v118
ds_write_b128 v122, a[32:35] offset:0
ds_write_b128 v122, a[36:39] offset:1024
ds_write_b128 v122, a[40:43] offset:57344
ds_write_b128 v122, a[44:47] offset:58368
v_cmp_lt_f32 vcc, s51, v120
s_cbranch_vccnz L_tramp2_5
L_back2_5:
EX 0
EX 1
EX 2
EX 3
EX 4
EX 5
EX 6
EX 7
CV 96,0
CV 97,2
CV 98,4
CV 99,6
WB 8
s_barrier
MM 8,56,96
s_mov_b32 s48, 57344
s_add_u32 m0, s41, 0
KR 56,100,49152
AD 0
DM 112,8,0
MM 12,60,96
KR 60,100,53248
AD 1
MM 16,64,96
KR 64,101,49152
AD 2
MM 20,68,96
KR 68,101,53248
AD 3
MM 24,72,96
KR 72,102,49152
AD 4
MM 28,76,96
KR 76,102,53248
AD 5
MM 32,80,96
KR 80,103,49152
AD 6
DM 113,8,1024
MM 36,84,96
KR 84,103,53248
AD 7
WL 4
MN 0,56,40
TR 56,104,8192
TR 58,104,12288
MN 4,60,40
s_mov_b32 s48, 49152
s_add_u32 m0, s41, 90112
TR 60,105,8192
TR 62,105,12288
DM 114,12,0
v_max3_f32 v120, v88, v89, v90
MM 0,64,44
TR 64,106,8192
TR 66,106,12288
v_max3_f32 v121, v91, v92, v93
MM 4,68,44
TR 68,107,8192
TR 70,107,12288
v_max3_f32 v120, v120, v94, v95
WL 8
MM 0,72,48
TR 72,108,8192
TR 74,108,12288
v_max_f32 v120, v120, v121
MM 4,76,48
TR 76,109,8192
TR 78,109,12288
DM 115,12,1024
MM 0,80,52
TR 80,110,8192
TR 82,110,12288
MM 4,84,52
WL 12
TR 84,111,8192
TR 86,111,12288
v_cmp_lt_f32 vcc, s51, v120
s_cbranch_vccnz L_tramp2_6
L_back2_6:
EX 88
EX 89
EX 90
EX 91
EX 92
EX 93
EX 94
EX 95
CV 96,88
CV 97,90
CV 98,92
CV 99,94
WL 0
s_barrier
MM 8,56,96
KR 56,100,16384
AD 88
MM 12,60,96
KR 60,100,20480
AD 89
MM 16,64,96
KR 64,101,16384
AD 90
MM 20,68,96
KR 68,101,20480
AD 91
MM 24,72,96
KR 72,102,16384
AD 92
MM 28,76,96
KR 76,102,20480
AD 93
MM 32,80,96
KR 80,103,16384
AD 94
MM 36,84,96
KR 84,103,20480
AD 95
WL 4
MN 88,56,40
TR 56,104,49152
TR 58,104,53248
MN 92,60,40
TR 60,105,49152
TR 62,105,53248
v_max3_f32 v120, v0, v1, v2
MM 88,64,44
TR 64,106,49152
TR 66,106,53248
v_max3_f32 v121, v3, v4, v5
MM 92,68,44
TR 68,107,49152
TR 70,107,53248
v_max3_f32 v120, v120, v6, v7
WL 8
MM 88,72,48
TR 72,108,49152
TR 74,108,53248
v_max_f32 v120, v120, v121
MM 92,76,48
TR 76,109,49152
TR 78,109,53248
MM 88,80,52
TR 80,110,49152
TR 82,110,53248
MM 92,84,52
WL 12
TR 84,111,49152
TR 86,111,53248
v_cmp_lt_f32 vcc, s51, v120
s_cbranch_vccnz L_tramp2_7
L_back2_7:
EX 0
EX 1
EX 2
EX 3
EX 4
EX 5
EX 6
EX 7
CV 96,0
CV 97,2
CV 98,4
CV 99,6
WB 8
s_barrier
MM 8,56,96
s_mov_b32 s48, 65536
s_add_u32 m0, s41, 8192
KR 56,100,24576
AD 0
DM 112,8,0
MM 12,60,96
KR 60,100,28672
AD 1
MM 16,64,96
KR 64,101,24576
AD 2
MM 20,68,96
KR 68,101,28672
AD 3
MM 24,72,96
KR 72,102,24576
AD 4
MM 28,76,96
KR 76,102,28672
AD 5
MM 32,80,96
KR 80,103,24576
AD 6
DM 113,8,1024
MM 36,84,96
KR 84,103,28672
AD 7
WL 4
MN 0,56,40
TR 56,104,16384
TR 58,104,20480
MN 4,60,40
s_mov_b32 s48, 57344
s_add_u32 m0, s41, 57344
TR 60,105,16384
TR 62,105,20480
DM 114,12,0
v_max3_f32 v120, v88, v89, v90
MM 0,64,44
TR 64,106,16384
TR 66,106,20480
v_max3_f32 v121, v91, v92, v93
MM 4,68,44
TR 68,107,16384
TR 70,107,20480
v_max3_f32 v120, v120, v94, v95
WL 8
MM 0,72,48
TR 72,108,16384
TR 74,108,20480
v_max_f32 v120, v120, v121
MM 4,76,48
TR 76,109,16384
TR 78,109,20480
DM 115,12,1024
MM 0,80,52
TR 80,110,16384
TR 82,110,20480
MM 4,84,52
WL 12
TR 84,111,16384
TR 86,111,20480
WL 8
s_add_u32 s43, s41, 49152
v_add_u32 v122, s43, v118
ds_write_b128 v122, a[48:51] offset:0
ds_write_b128 v122, a[52:55] offset:1024
ds_write_b128 v122, a[56:59] offset:57344
ds_write_b128 v122, a[60:63] offset:58368
v_cmp_lt_f32 vcc, s51, v120
s_cbranch_vccnz L_tramp2_8
L_back2_8:
EX 88
EX 89
EX 90
EX 91
EX 92
EX 93
EX 94
EX 95
CV 96,88
CV 97,90
CV 98,92
CV 99,94
WB 8
s_barrier
MM 8,56,96
s_mov_b32 s48, 73728
s_add_u32 m0, s41, 16384
KR 56,100,40960
AD 88
DM 112,8,0
MM 12,60,96
KR 60,100,45056
AD 89
MM 16,64,96
KR 64,101,40960
AD 90
MM 20,68,96
KR 68,101,45056
AD 91
MM 24,72,96
KR 72,102,40960
AD 92
MM 28,76,96
KR 76,102,45056
AD 93
MM 32,80,96
KR 80,103,40960
AD 94
DM 113,8,1024
MM 36,84,96
KR 84,103,45056
AD 95
WL 4
MN 88,56,40
TR 56,104,24576
TR 58,104,28672
MN 92,60,40
s_mov_b32 s48, 65536
s_add_u32 m0, s41, 65536
TR 60,105,24576
TR 62,105,28672
DM 114,12,0
v_max3_f32 v120, v0, v1, v2
MM 88,64,44
TR 64,106,24576
TR 66,106,28672
v_max3_f32 v121, v3, v4, v5
MM 92,68,44
TR 68,107,24576
TR 70,107,28672
v_max3_f32 v120, v120, v6, v7
WL 8
MM 88,72,48
TR 72,108,24576
TR 74,108,28672
v_max_f32 v120, v120, v121
MM 92,76,48
TR 76,109,24576
TR 78,109,28672
DM 115,12,1024
MM 88,80,52
TR 80,110,24576
TR 82,110,28672
MM 92,84,52
WL 12
TR 84,111,24576
TR 86,111,28672
v_cmp_lt_f32 vcc, s51, v120
s_cbranch_vccnz L_tramp2_9
L_back2_9:
EX 0
EX 1
EX 2
EX 3
EX 4
EX 5
EX 6
EX 7
CV 96,0
CV 97,2
CV 98,4
CV 99,6
WL 0
s_barrier
MM 8,56,96
KR 56,100,32768
AD 0
MM 12,60,96
KR 60,100,36864
AD 1
MM 16,64,96
KR 64,101,32768
AD 2
MM 20,68,96
KR 68,101,36864
AD 3
MM 24,72,96
KR 72,102,32768
AD 4
MM 28,76,96
KR 76,102,36864
AD 5
MM 32,80,96
KR 80,103,32768
AD 6
MM 36,84,96
KR 84,103,36864
AD 7
WL 4
MN 0,56,40
TR 56,104,40960
TR 58,104,45056
MN 4,60,40
TR 60,105,40960
TR 62,105,45056
v_max3_f32 v120, v88, v89, v90
MM 0,64,44
TR 64,106,40960
TR 66,106,45056
v_max3_f32 v121, v91, v92, v93
MM 4,68,44
TR 68,107,40960
TR 70,107,45056
v_max3_f32 v120, v120, v94, v95
WL 8
MM 0,72,48
TR 72,108,40960
TR 74,108,45056
v_max_f32 v120, v120, v121
MM 4,76,48
TR 76,109,40960
TR 78,109,45056
MM 0,80,52
TR 80,110,40960
TR 82,110,45056
MM 4,84,52
WL 12
TR 84,111,40960
TR 86,111,45056
v_cmp_lt_f32 vcc, s51, v120
s_cbranch_vccnz L_tramp2_10
L_back2_10:
EX 88
EX 89
EX 90
EX 91
EX 92
EX 93
EX 94
EX 95
CV 96,88
CV 97,90
CV 98,92
CV 99,94
WB 8
s_barrier
MM 8,56,96
s_mov_b32 s48, 81920
s_add_u32 m0, s41, 24576
KR 56,100,0
AD 88
DM 112,8,0
MM 12,60,96
KR 60,100,4096
AD 89
MM 16,64,96
KR 64,101,0
AD 90
MM 20,68,96
KR 68,101,4096
AD 91
MM 24,72,96
KR 72,102,0
AD 92
MM 28,76,96
KR 76,102,4096
AD 93
MM 32,80,96
KR 80,103,0
AD 94
DM 113,8,1024
MM 36,84,96
KR 84,103,4096
AD 95
WL 4
MN 88,56,40
TR 56,104,32768
TR 58,104,36864
MN 92,60,40
s_mov_b32 s48, 73728
s_add_u32 m0, s41, 73728
TR 60,105,32768
TR 62,105,36864
DM 114,12,0
v_max3_f32 v120, v0, v1, v2
MM 88,64,44
TR 64,106,32768
TR 66,106,36864
v_max3_f32 v121, v3, v4, v5
MM 92,68,44
TR 68,107,32768
TR 70,107,36864
v_max3_f32 v120, v120, v6, v7
WL 8
MM 88,72,48
TR 72,108,32768
TR 74,108,36864
v_max_f32 v120, v120, v121
MM 92,76,48
TR 76,109,32768
TR 78,109,36864
DM 115,12,1024
MM 88,80,52
TR 80,110,32768
TR 82,110,36864
MM 92,84,52
WL 12
TR 84,111,32768
TR 86,111,36864
WL 8
s_add_u32 s43, s41, 40960
v_add_u32 v122, s43, v118
ds_write_b128 v122, a[64:67] offset:0
ds_write_b128 v122, a[68:71] offset:1024
ds_write_b128 v122, a[72:75] offset:57344
ds_write_b128 v122, a[76:79] offset:58368
v_cmp_lt_f32 vcc, s51, v120
s_cbranch_vccnz L_tramp2_11
L_back2_11:
EX 0
EX 1
EX 2
EX 3
EX 4
EX 5
EX 6
EX 7
CV 96,0
CV 97,2
CV 98,4
CV 99,6
WB 8
s_barrier
MM 8,56,96
s_mov_b32 s48, 90112
s_add_u32 m0, s41, 32768
KR 56,100,49152
AD 0
DM 112,8,0
MM 12,60,96
KR 60,100,53248
AD 1
MM 16,64,96
KR 64,101,49152
AD 2
MM 20,68,96
KR 68,101,53248
AD 3
MM 24,72,96
KR 72,102,49152
AD 4
MM 28,76,96
KR 76,102,53248
AD 5
MM 32,80,96
KR 80,103,49152
AD 6
DM 113,8,1024
MM 36,84,96
KR 84,103,53248
AD 7
WL 4
MN 0,56,40
TR 56,104,0
TR 58,104,4096
MN 4,60,40
s_mov_b32 s48, 81920
s_add_u32 m0, s41, 81920
TR 60,105,0
TR 62,105,4096
DM 114,12,0
v_max3_f32 v120, v88, v89, v90
MM 0,64,44
TR 64,106,0
TR 66,106,4096
v_max3_f32 v121, v91, v92, v93
MM 4,68,44
TR 68,107,0
TR 70,107,4096
v_max3_f32 v120, v120, v94, v95
WL 8
MM 0,72,48
TR 72,108,0
TR 74,108,4096
v_max_f32 v120, v120, v121
MM 4,76,48
TR 76,109,0
TR 78,109,4096
DM 115,12,1024
MM 0,80,52
TR 80,110,0
TR 82,110,4096
MM 4,84,52
WL 12
TR 84,111,0
TR 86,111,4096
v_cmp_lt_f32 vcc, s51, v120
s_cbranch_vccnz L_tramp2_12
L_back2_12:
EX 88
EX 89
EX 90
EX 91
EX 92
EX 93
EX 94
EX 95
CV 96,88
CV 97,90
CV 98,92
CV 99,94
WL 0
s_barrier
MM 8,56,96
KR 56,100,8192
AD 88
MM 12,60,96
KR 60,100,12288
AD 89
MM 16,64,96
KR 64,101,8192
AD 90
MM 20,68,96
KR 68,101,12288
AD 91
MM 24,72,96
KR 72,102,8192
AD 92
MM 28,76,96
KR 76,102,12288
AD 93
MM 32,80,96
KR 80,103,8192
AD 94
MM 36,84,96
KR 84,103,12288
AD 95
WL 4
MN 88,56,40
TR 56,104,49152
TR 58,104,53248
MN 92,60,40
TR 60,105,49152
TR 62,105,53248
v_max3_f32 v120, v0, v1, v2
MM 88,64,44
TR 64,106,49152
TR 66,106,53248
v_max3_f32 v121, v3, v4, v5
MM 92,68,44
TR 68,107,49152
TR 70,107,53248
v_max3_f32 v120, v120, v6, v7
WL 8
MM 88,72,48
TR 72,108,49152
TR 74,108,53248
v_max_f32 v120, v120, v121
MM 92,76,48
TR 76,109,49152
TR 78,109,53248
MM 88,80,52
TR 80,110,49152
TR 82,110,53248
MM 92,84,52
WL 12
TR 84,111,49152
TR 86,111,53248
v_cmp_lt_f32 vcc, s51, v120
s_cbranch_vccnz L_tramp2_13
L_back2_13:
EX 0
EX 1
EX 2
EX 3
EX 4
EX 5
EX 6
EX 7
CV 96,0
CV 97,2
CV 98,4
CV 99,6
WB 8
s_barrier
MM 8,56,96
s_mov_b32 s48, 98304
s_add_u32 m0, s41, 0
KR 56,100,16384
AD 0
DM 112,8,0
MM 12,60,96
KR 60,100,20480
AD 1
MM 16,64,96
KR 64,101,16384
AD 2
MM 20,68,96
KR 68,101,20480
AD 3
MM 24,72,96
KR 72,102,16384
AD 4
MM 28,76,96
KR 76,102,20480
AD 5
MM 32,80,96
KR 80,103,16384
AD 6
DM 113,8,1024
MM 36,84,96
KR 84,103,20480
AD 7
WL 4
MN 0,56,40
TR 56,104,8192
TR 58,104,12288
MN 4,60,40
s_mov_b32 s48, 90112
s_add_u32 m0, s41, 90112
TR 60,105,8192
TR 62,105,12288
DM 114,12,0
v_max3_f32 v120, v88, v89, v90
MM 0,64,44
TR 64,106,8192
TR 66,106,12288
v_max3_f32 v121, v91, v92, v93
MM 4,68,44
TR 68,107,8192
TR 70,107,12288
v_max3_f32 v120, v120, v94, v95
WL 8
MM 0,72,48
TR 72,108,8192
TR 74,108,12288
v_max_f32 v120, v120, v121
MM 4,76,48
TR 76,109,8192
TR 78,109,12288
DM 115,12,1024
MM 0,80,52
TR 80,110,8192
TR 82,110,12288
MM 4,84,52
WL 12
TR 84,111,8192
TR 86,111,12288
WL 8
s_add_u32 s43, s41, 49152
v_add_u32 v122, s43, v118
ds_write_b128 v122, a[80:83] offset:0
ds_write_b128 v122, a[84:87] offset:1024
ds_write_b128 v122, a[88:91] offset:57344
ds_write_b128 v122, a[92:95] offset:58368
v_cmp_lt_f32 vcc, s51, v120
s_cbranch_vccnz L_tramp2_14
L_back2_14:
EX 88
EX 89
EX 90
EX 91
EX 92
EX 93
EX 94
EX 95
CV 96,88
CV 97,90
CV 98,92
CV 99,94
WB 8
s_barrier
MM 8,56,96
s_mov_b32 s48, 106496
s_add_u32 m0, s41, 8192
KR 56,100,40960
AD 88
DM 112,8,0
MM 12,60,96
KR 60,100,45056
AD 89
MM 16,64,96
KR 64,101,40960
AD 90
MM 20,68,96
KR 68,101,45056
AD 91
MM 24,72,96
KR 72,102,40960
AD 92
MM 28,76,96
KR 76,102,45056
AD 93
MM 32,80,96
KR 80,103,40960
AD 94
DM 113,8,1024
MM 36,84,96
KR 84,103,45056
AD 95
WL 4
MN 88,56,40
TR 56,104,16384
TR 58,104,20480
MN 92,60,40
s_mov_b32 s48, 98304
s_add_u32 m0, s41, 57344
TR 60,105,16384
TR 62,105,20480
DM 114,12,0
v_max3_f32 v120, v0, v1, v2
MM 88,64,44
TR 64,106,16384
TR 66,106,20480
v_max3_f32 v121, v3, v4, v5
MM 92,68,44
TR 68,107,16384
TR 70,107,20480
v_max3_f32 v120, v120, v6, v7
WL 8
MM 88,72,48
TR 72,108,16384
TR 74,108,20480
v_max_f32 v120, v120, v121
MM 92,76,48
TR 76,109,16384
TR 78,109,20480
DM 115,12,1024
MM 88,80,52
TR 80,110,16384
TR 82,110,20480
MM 92,84,52
WL 12
TR 84,111,16384
TR 86,111,20480
v_cmp_lt_f32 vcc, s51, v120
s_cbranch_vccnz L_tramp2_15
L_back2_15:
EX 0
EX 1
EX 2
EX 3
EX 4
EX 5
EX 6
EX 7
CV 96,0
CV 97,2
CV 98,4
CV 99,6
WL 0
s_barrier
MM 8,56,96
KR 56,100,24576
AD 0
MM 12,60,96
KR 60,100,28672
AD 1
MM 16,64,96
KR 64,101,24576
AD 2
MM 20,68,96
KR 68,101,28672
AD 3
MM 24,72,96
KR 72,102,24576
AD 4
MM 28,76,96
KR 76,102,28672
AD 5
MM 32,80,96
KR 80,103,24576
AD 6
MM 36,84,96
KR 84,103,28672
AD 7
WL 4
MN 0,56,40
TR 56,104,40960
TR 58,104,45056
MN 4,60,40
TR 60,105,40960
TR 62,105,45056
v_max3_f32 v120, v88, v89, v90
MM 0,64,44
TR 64,106,40960
TR 66,106,45056
v_max3_f32 v121, v91, v92, v93
MM 4,68,44
TR 68,107,40960
TR 70,107,45056
v_max3_f32 v120, v120, v94, v95
WL 8
MM 0,72,48
TR 72,108,40960
TR 74,108,45056
v_max_f32 v120, v120, v121
MM 4,76,48
TR 76,109,40960
TR 78,109,45056
MM 0,80,52
TR 80,110,40960
TR 82,110,45056
MM 4,84,52
WL 12
TR 84,111,40960
TR 86,111,45056
v_cmp_lt_f32 vcc, s51, v120
s_cbranch_vccnz L_tramp2_16
L_back2_16:
EX 88
EX 89
EX 90
EX 91
EX 92
EX 93
EX 94
EX 95
CV 96,88
CV 97,90
CV 98,92
CV 99,94
WB 8
s_barrier
MM 8,56,96
s_mov_b32 s48, 114688
s_add_u32 m0, s41, 16384
KR 56,100,32768
AD 88
DM 112,8,0
MM 12,60,96
KR 60,100,36864
AD 89
MM 16,64,96
KR 64,101,32768
AD 90
MM 20,68,96
KR 68,101,36864
AD 91
MM 24,72,96
KR 72,102,32768
AD 92
MM 28,76,96
KR 76,102,36864
AD 93
MM 32,80,96
KR 80,103,32768
AD 94
DM 113,8,1024
MM 36,84,96
KR 84,103,36864
AD 95
WL 4
MN 88,56,40
TR 56,104,24576
TR 58,104,28672
MN 92,60,40
s_mov_b32 s48, 106496
s_add_u32 m0, s41, 65536
TR 60,105,24576
TR 62,105,28672
DM 114,12,0
v_max3_f32 v120, v0, v1, v2
MM 88,64,44
TR 64,106,24576
TR 66,106,28672
v_max3_f32 v121, v3, v4, v5
MM 92,68,44
TR 68,107,24576
TR 70,107,28672
v_max3_f32 v120, v120, v6, v7
WL 8
MM 88,72,48
TR 72,108,24576
TR 74,108,28672
v_max_f32 v120, v120, v121
MM 92,76,48
TR 76,109,24576
TR 78,109,28672
DM 115,12,1024
MM 88,80,52
TR 80,110,24576
TR 82,110,28672
MM 92,84,52
WL 12
TR 84,111,24576
TR 86,111,28672
WL 8
s_add_u32 s43, s41, 40960
v_add_u32 v122, s43, v118
ds_write_b128 v122, a[96:99] offset:0
ds_write_b128 v122, a[100:103] offset:1024
ds_write_b128 v122, a[104:107] offset:57344
ds_write_b128 v122, a[108:111] offset:58368
v_cmp_lt_f32 vcc, s51, v120
s_cbranch_vccnz L_tramp2_17
L_back2_17:
EX 0
EX 1
EX 2
EX 3
EX 4
EX 5
EX 6
EX 7
CV 96,0
CV 97,2
CV 98,4
CV 99,6
WB 8
s_barrier
MM 8,56,96
s_mov_b32 s48, 122880
s_add_u32 m0, s41, 24576
KR 56,100,49152
AD 0
DM 112,8,0
MM 12,60,96
KR 60,100,53248
AD 1
MM 16,64,96
KR 64,101,49152
AD 2
MM 20,68,96
KR 68,101,53248
AD 3
MM 24,72,96
KR 72,102,49152
AD 4
MM 28,76,96
KR 76,102,53248
AD 5
MM 32,80,96
KR 80,103,49152
AD 6
DM 113,8,1024
MM 36,84,96
KR 84,103,53248
AD 7
WL 4
MN 0,56,40
TR 56,104,32768
TR 58,104,36864
MN 4,60,40
s_mov_b32 s48, 114688
s_add_u32 m0, s41, 73728
TR 60,105,32768
TR 62,105,36864
DM 114,12,0
v_max3_f32 v120, v88, v89, v90
MM 0,64,44
TR 64,106,32768
TR 66,106,36864
v_max3_f32 v121, v91, v92, v93
MM 4,68,44
TR 68,107,32768
TR 70,107,36864
v_max3_f32 v120, v120, v94, v95
WL 8
MM 0,72,48
TR 72,108,32768
TR 74,108,36864
v_max_f32 v120, v120, v121
MM 4,76,48
TR 76,109,32768
TR 78,109,36864
DM 115,12,1024
MM 0,80,52
TR 80,110,32768
TR 82,110,36864
MM 4,84,52
WL 12
TR 84,111,32768
TR 86,111,36864
v_cmp_lt_f32 vcc, s51, v120
s_cbranch_vccnz L_tramp2_18
L_back2_18:
EX 88
EX 89
EX 90
EX 91
EX 92
EX 93
EX 94
EX 95
CV 96,88
CV 97,90
CV 98,92
CV 99,94
WL 0
s_barrier
MM 8,56,96
KR 56,100,0
AD 88
MM 12,60,96
KR 60,100,4096
AD 89
MM 16,64,96
KR 64,101,0
AD 90
MM 20,68,96
KR 68,101,4096
AD 91
MM 24,72,96
KR 72,102,0
AD 92
MM 28,76,96
KR 76,102,4096
AD 93
MM 32,80,96
KR 80,103,0
AD 94
MM 36,84,96
KR 84,103,4096
AD 95
WL 4
MN 88,56,40
TR 56,104,49152
TR 58,104,53248
MN 92,60,40
TR 60,105,49152
TR 62,105,53248
v_max3_f32 v120, v0, v1, v2
MM 88,64,44
TR 64,106,49152
TR 66,106,53248
v_max3_f32 v121, v3, v4, v5
MM 92,68,44
TR 68,107,49152
TR 70,107,53248
v_max3_f32 v120, v120, v6, v7
WL 8
MM 88,72,48
TR 72,108,49152
TR 74,108,53248
v_max_f32 v120, v120, v121
MM 92,76,48
TR 76,109,49152
TR 78,109,53248
MM 88,80,52
TR 80,110,49152
TR 82,110,53248
MM 92,84,52
WL 12
TR 84,111,49152
TR 86,111,53248
v_cmp_lt_f32 vcc, s51, v120
s_cbranch_vccnz L_tramp2_19
L_back2_19:
EX 0
EX 1
EX 2
EX 3
EX 4
EX 5
EX 6
EX 7
CV 96,0
CV 97,2
CV 98,4
CV 99,6
WB 8
s_barrier
MM 8,56,96
s_mov_b32 s48, 131072
s_add_u32 m0, s41, 32768
KR 56,100,8192
AD 0
DM 112,8,0
MM 12,60,96
KR 60,100,12288
AD 1
MM 16,64,96
KR 64,101,8192
AD 2
MM 20,68,96
KR 68,101,12288
AD 3
MM 24,72,96
KR 72,102,8192
AD 4
MM 28,76,96
KR 76,102,12288
AD 5
MM 32,80,96
KR 80,103,8192
AD 6
DM 113,8,1024
MM 36,84,96
KR 84,103,12288
AD 7
WL 4
MN 0,56,40
TR 56,104,0
TR 58,104,4096
MN 4,60,40
s_mov_b32 s48, 122880
s_add_u32 m0, s41, 81920
TR 60,105,0
TR 62,105,4096
DM 114,12,0
v_max3_f32 v120, v88, v89, v90
MM 0,64,44
TR 64,106,0
TR 66,106,4096
v_max3_f32 v121, v91, v92, v93
MM 4,68,44
TR 68,107,0
TR 70,107,4096
v_max3_f32 v120, v120, v94, v95
WL 8
MM 0,72,48
TR 72,108,0
TR 74,108,4096
v_max_f32 v120, v120, v121
MM 4,76,48
TR 76,109,0
TR 78,109,4096
DM 115,12,1024
MM 0,80,52
TR 80,110,0
TR 82,110,4096
MM 4,84,52
WL 12
TR 84,111,0
TR 86,111,4096
WL 8
s_add_u32 s43, s41, 49152
v_add_u32 v122, s43, v118
ds_write_b128 v122, a[112:115] offset:0
ds_write_b128 v122, a[116:119] offset:1024
ds_write_b128 v122, a[120:123] offset:57344
ds_write_b128 v122, a[124:127] offset:58368
v_cmp_lt_f32 vcc, s51, v120
s_cbranch_vccnz L_tramp2_20
L_back2_20:
EX 88
EX 89
EX 90
EX 91
EX 92
EX 93
EX 94
EX 95
CV 96,88
CV 97,90
CV 98,92
CV 99,94
WB 8
s_barrier
MM 8,56,96
s_mov_b32 s48, 139264
s_add_u32 m0, s41, 0
KR 56,100,40960
AD 88
DM 112,8,0
MM 12,60,96
KR 60,100,45056
AD 89
MM 16,64,96
KR 64,101,40960
AD 90
MM 20,68,96
KR 68,101,45056
AD 91
MM 24,72,96
KR 72,102,40960
AD 92
MM 28,76,96
KR 76,102,45056
AD 93
MM 32,80,96
KR 80,103,40960
AD 94
DM 113,8,1024
MM 36,84,96
KR 84,103,45056
AD 95
WL 4
MN 88,56,40
TR 56,104,8192
TR 58,104,12288
MN 92,60,40
s_mov_b32 s48, 131072
s_add_u32 m0, s41, 90112
TR 60,105,8192
TR 62,105,12288
DM 114,12,0
v_max3_f32 v120, v0, v1, v2
MM 88,64,44
TR 64,106,8192
TR 66,106,12288
v_max3_f32 v121, v3, v4, v5
MM 92,68,44
TR 68,107,8192
TR 70,107,12288
v_max3_f32 v120, v120, v6, v7
WL 8
MM 88,72,48
TR 72,108,8192
TR 74,108,12288
v_max_f32 v120, v120, v121
MM 92,76,48
TR 76,109,8192
TR 78,109,12288
DM 115,12,1024
MM 88,80,52
TR 80,110,8192
TR 82,110,12288
MM 92,84,52
WL 12
TR 84,111,8192
TR 86,111,12288
v_cmp_lt_f32 vcc, s51, v120
s_cbranch_vccnz L_tramp2_21
L_back2_21:
EX 0
EX 1
EX 2
EX 3
EX 4
EX 5
EX 6
EX 7
CV 96,0
CV 97,2
CV 98,4
CV 99,6
WL 0
s_barrier
MM 8,56,96
KR 56,100,16384
AD 0
MM 12,60,96
KR 60,100,20480
AD 1
MM 16,64,96
KR 64,101,16384
AD 2
MM 20,68,96
KR 68,101,20480
AD 3
MM 24,72,96
KR 72,102,16384
AD 4
MM 28,76,96
KR 76,102,20480
AD 5
MM 32,80,96
KR 80,103,16384
AD 6
MM 36,84,96
KR 84,103,20480
AD 7
WL 4
MN 0,56,40
TR 56,104,40960
TR 58,104,45056
MN 4,60,40
TR 60,105,40960
TR 62,105,45056
v_max3_f32 v120, v88, v89, v90
MM 0,64,44
TR 64,106,40960
TR 66,106,45056
v_max3_f32 v121, v91, v92, v93
MM 4,68,44
TR 68,107,40960
TR 70,107,45056
v_max3_f32 v120, v120, v94, v95
WL 8
MM 0,72,48
TR 72,108,40960
TR 74,108,45056
v_max_f32 v120, v120, v121
MM 4,76,48
TR 76,109,40960
TR 78,109,45056
MM 0,80,52
TR 80,110,40960
TR 82,110,45056
MM 4,84,52
WL 12
TR 84,111,40960
TR 86,111,45056
v_cmp_lt_f32 vcc, s51, v120
s_cbranch_vccnz L_tramp2_22
L_back2_22:
EX 88
EX 89
EX 90
EX 91
EX 92
EX 93
EX 94
EX 95
CV 96,88
CV 97,90
CV 98,92
CV 99,94
WB 8
s_barrier
MM 8,56,96
s_mov_b32 s48, 147456
s_add_u32 m0, s41, 8192
KR 56,100,24576
AD 88
DM 112,8,0
MM 12,60,96
KR 60,100,28672
AD 89
MM 16,64,96
KR 64,101,24576
AD 90
MM 20,68,96
KR 68,101,28672
AD 91
MM 24,72,96
KR 72,102,24576
AD 92
MM 28,76,96
KR 76,102,28672
AD 93
MM 32,80,96
KR 80,103,24576
AD 94
DM 113,8,1024
MM 36,84,96
KR 84,103,28672
AD 95
WL 4
MN 88,56,40
TR 56,104,16384
TR 58,104,20480
MN 92,60,40
s_mov_b32 s48, 139264
s_add_u32 m0, s41, 57344
TR 60,105,16384
TR 62,105,20480
DM 114,12,0
v_max3_f32 v120, v0, v1, v2
MM 88,64,44
TR 64,106,16384
TR 66,106,20480
v_max3_f32 v121, v3, v4, v5
MM 92,68,44
TR 68,107,16384
TR 70,107,20480
v_max3_f32 v120, v120, v6, v7
WL 8
MM 88,72,48
TR 72,108,16384
TR 74,108,20480
v_max_f32 v120, v120, v121
MM 92,76,48
TR 76,109,16384
TR 78,109,20480
DM 115,12,1024
MM 88,80,52
TR 80,110,16384
TR 82,110,20480
MM 92,84,52
WL 12
TR 84,111,16384
TR 86,111,20480
WL 8
s_add_u32 s43, s41, 40960
v_add_u32 v122, s43, v118
ds_write_b128 v122, a[128:131] offset:0
ds_write_b128 v122, a[132:135] offset:1024
ds_write_b128 v122, a[136:139] offset:57344
ds_write_b128 v122, a[140:143] offset:58368
v_cmp_lt_f32 vcc, s51, v120
s_cbranch_vccnz L_tramp2_23
L_back2_23:
EX 0
EX 1
EX 2
EX 3
EX 4
EX 5
EX 6
EX 7
CV 96,0
CV 97,2
CV 98,4
CV 99,6
WB 8
s_barrier
MM 8,56,96
s_mov_b32 s48, 155648
s_add_u32 m0, s41, 16384
KR 56,100,49152
AD 0
DM 112,8,0
MM 12,60,96
KR 60,100,53248
AD 1
MM 16,64,96
KR 64,101,49152
AD 2
MM 20,68,96
KR 68,101,53248
AD 3
MM 24,72,96
KR 72,102,49152
AD 4
MM 28,76,96
KR 76,102,53248
AD 5
MM 32,80,96
KR 80,103,49152
AD 6
DM 113,8,1024
MM 36,84,96
KR 84,103,53248
AD 7
WL 4
MN 0,56,40
TR 56,104,24576
TR 58,104,28672
MN 4,60,40
s_mov_b32 s48, 147456
s_add_u32 m0, s41, 65536
TR 60,105,24576
TR 62,105,28672
DM 114,12,0
v_max3_f32 v120, v88, v89, v90
MM 0,64,44
TR 64,106,24576
TR 66,106,28672
v_max3_f32 v121, v91, v92, v93
MM 4,68,44
TR 68,107,24576
TR 70,107,28672
v_max3_f32 v120, v120, v94, v95
WL 8
MM 0,72,48
TR 72,108,24576
TR 74,108,28672
v_max_f32 v120, v120, v121
MM 4,76,48
TR 76,109,24576
TR 78,109,28672
DM 115,12,1024
MM 0,80,52
TR 80,110,24576
TR 82,110,28672
MM 4,84,52
WL 12
TR 84,111,24576
TR 86,111,28672
v_cmp_lt_f32 vcc, s51, v120
s_cbranch_vccnz L_tramp2_24
L_back2_24:
EX 88
EX 89
EX 90
EX 91
EX 92
EX 93
EX 94
EX 95
CV 96,88
CV 97,90
CV 98,92
CV 99,94
WL 0
s_barrier
MM 8,56,96
KR 56,100,32768
AD 88
MM 12,60,96
KR 60,100,36864
AD 89
MM 16,64,96
KR 64,101,32768
AD 90
MM 20,68,96
KR 68,101,36864
AD 91
MM 24,72,96
KR 72,102,32768
AD 92
MM 28,76,96
KR 76,102,36864
AD 93
MM 32,80,96
KR 80,103,32768
AD 94
MM 36,84,96
KR 84,103,36864
AD 95
WL 4
MN 88,56,40
TR 56,104,49152
TR 58,104,53248
MN 92,60,40
TR 60,105,49152
TR 62,105,53248
v_max3_f32 v120, v0, v1, v2
MM 88,64,44
TR 64,106,49152
TR 66,106,53248
v_max3_f32 v121, v3, v4, v5
MM 92,68,44
TR 68,107,49152
TR 70,107,53248
v_max3_f32 v120, v120, v6, v7
WL 8
MM 88,72,48
TR 72,108,49152
TR 74,108,53248
v_max_f32 v120, v120, v121
MM 92,76,48
TR 76,109,49152
TR 78,109,53248
MM 88,80,52
TR 80,110,49152
TR 82,110,53248
MM 92,84,52
WL 12
TR 84,111,49152
TR 86,111,53248
v_cmp_lt_f32 vcc, s51, v120
s_cbranch_vccnz L_tramp2_25
L_back2_25:
EX 0
EX 1
EX 2
EX 3
EX 4
EX 5
EX 6
EX 7
CV 96,0
CV 97,2
CV 98,4
CV 99,6
WB 8
s_barrier
MM 8,56,96
s_mov_b32 s48, 163840
s_add_u32 m0, s41, 24576
KR 56,100,0
AD 0
DM 112,8,0
MM 12,60,96
KR 60,100,4096
AD 1
MM 16,64,96
KR 64,101,0
AD 2
MM 20,68,96
KR 68,101,4096
AD 3
MM 24,72,96
KR 72,102,0
AD 4
MM 28,76,96
KR 76,102,4096
AD 5
MM 32,80,96
KR 80,103,0
AD 6
DM 113,8,1024
MM 36,84,96
KR 84,103,4096
AD 7
WL 4
MN 0,56,40
TR 56,104,32768
TR 58,104,36864
MN 4,60,40
s_mov_b32 s48, 155648
s_add_u32 m0, s41, 73728
TR 60,105,32768
TR 62,105,36864
DM 114,12,0
v_max3_f32 v120, v88, v89, v90
MM 0,64,44
TR 64,106,32768
TR 66,106,36864
v_max3_f32 v121, v91, v92, v93
MM 4,68,44
TR 68,107,32768
TR 70,107,36864
v_max3_f32 v120, v120, v94, v95
WL 8
MM 0,72,48
TR 72,108,32768
TR 74,108,36864
v_max_f32 v120, v120, v121
MM 4,76,48
TR 76,109,32768
TR 78,109,36864
DM 115,12,1024
MM 0,80,52
TR 80,110,32768
TR 82,110,36864
MM 4,84,52
WL 12
TR 84,111,32768
TR 86,111,36864
WL 8
s_add_u32 s43, s41, 49152
v_add_u32 v122, s43, v118
ds_write_b128 v122, a[144:147] offset:0
ds_write_b128 v122, a[148:151] offset:1024
ds_write_b128 v122, a[152:155] offset:57344
ds_write_b128 v122, a[156:159] offset:58368
v_cmp_lt_f32 vcc, s51, v120
s_cbranch_vccnz L_tramp2_26
L_back2_26:
EX 88
EX 89
EX 90
EX 91
EX 92
EX 93
EX 94
EX 95
CV 96,88
CV 97,90
CV 98,92
CV 99,94
WB 8
s_barrier
MM 8,56,96
s_mov_b32 s48, 172032
s_add_u32 m0, s41, 32768
KR 56,100,40960
AD 88
DM 112,8,0
MM 12,60,96
KR 60,100,45056
AD 89
MM 16,64,96
KR 64,101,40960
AD 90
MM 20,68,96
KR 68,101,45056
AD 91
MM 24,72,96
KR 72,102,40960
AD 92
MM 28,76,96
KR 76,102,45056
AD 93
MM 32,80,96
KR 80,103,40960
AD 94
DM 113,8,1024
MM 36,84,96
KR 84,103,45056
AD 95
WL 4
MN 88,56,40
TR 56,104,0
TR 58,104,4096
MN 92,60,40
s_mov_b32 s48, 163840
s_add_u32 m0, s41, 81920
TR 60,105,0
TR 62,105,4096
DM 114,12,0
v_max3_f32 v120, v0, v1, v2
MM 88,64,44
TR 64,106,0
TR 66,106,4096
v_max3_f32 v121, v3, v4, v5
MM 92,68,44
TR 68,107,0
TR 70,107,4096
v_max3_f32 v120, v120, v6, v7
WL 8
MM 88,72,48
TR 72,108,0
TR 74,108,4096
v_max_f32 v120, v120, v121
MM 92,76,48
TR 76,109,0
TR 78,109,4096
DM 115,12,1024
MM 88,80,52
TR 80,110,0
TR 82,110,4096
MM 92,84,52
WL 12
TR 84,111,0
TR 86,111,4096
v_cmp_lt_f32 vcc, s51, v120
s_cbranch_vccnz L_tramp2_27
L_back2_27:
EX 0
EX 1
EX 2
EX 3
EX 4
EX 5
EX 6
EX 7
CV 96,0
CV 97,2
CV 98,4
CV 99,6
WL 0
s_barrier
MM 8,56,96
KR 56,100,8192
AD 0
MM 12,60,96
KR 60,100,12288
AD 1
MM 16,64,96
KR 64,101,8192
AD 2
MM 20,68,96
KR 68,101,12288
AD 3
MM 24,72,96
KR 72,102,8192
AD 4
MM 28,76,96
KR 76,102,12288
AD 5
MM 32,80,96
KR 80,103,8192
AD 6
MM 36,84,96
KR 84,103,12288
AD 7
WL 4
MN 0,56,40
TR 56,104,40960
TR 58,104,45056
MN 4,60,40
TR 60,105,40960
TR 62,105,45056
v_max3_f32 v120, v88, v89, v90
MM 0,64,44
TR 64,106,40960
TR 66,106,45056
v_max3_f32 v121, v91, v92, v93
MM 4,68,44
TR 68,107,40960
TR 70,107,45056
v_max3_f32 v120, v120, v94, v95
WL 8
MM 0,72,48
TR 72,108,40960
TR 74,108,45056
v_max_f32 v120, v120, v121
MM 4,76,48
TR 76,109,40960
TR 78,109,45056
MM 0,80,52
TR 80,110,40960
TR 82,110,45056
MM 4,84,52
WL 12
TR 84,111,40960
TR 86,111,45056
v_cmp_lt_f32 vcc, s51, v120
s_cbranch_vccnz L_tramp2_28
L_back2_28:
EX 88
EX 89
EX 90
EX 91
EX 92
EX 93
EX 94
EX 95
CV 96,88
CV 97,90
CV 98,92
CV 99,94
WB 8
s_barrier
MM 8,56,96
s_mov_b32 s48, 180224
s_add_u32 m0, s41, 0
KR 56,100,16384
AD 88
DM 112,8,0
MM 12,60,96
KR 60,100,20480
AD 89
MM 16,64,96
KR 64,101,16384
AD 90
MM 20,68,96
KR 68,101,20480
AD 91
MM 24,72,96
KR 72,102,16384
AD 92
MM 28,76,96
KR 76,102,20480
AD 93
MM 32,80,96
KR 80,103,16384
AD 94
DM 113,8,1024
MM 36,84,96
KR 84,103,20480
AD 95
WL 4
MN 88,56,40
TR 56,104,8192
TR 58,104,12288
MN 92,60,40
s_mov_b32 s48, 172032
s_add_u32 m0, s41, 90112
TR 60,105,8192
TR 62,105,12288
DM 114,12,0
v_max3_f32 v120, v0, v1, v2
MM 88,64,44
TR 64,106,8192
TR 66,106,12288
v_max3_f32 v121, v3, v4, v5
MM 92,68,44
TR 68,107,8192
TR 70,107,12288
v_max3_f32 v120, v120, v6, v7
WL 8
MM 88,72,48
TR 72,108,8192
TR 74,108,12288
v_max_f32 v120, v120, v121
MM 92,76,48
TR 76,109,8192
TR 78,109,12288
DM 115,12,1024
MM 88,80,52
TR 80,110,8192
TR 82,110,12288
MM 92,84,52
WL 12
TR 84,111,8192
TR 86,111,12288
WL 8
s_add_u32 s43, s41, 40960
v_add_u32 v122, s43, v118
ds_write_b128 v122, a[160:163] offset:0
ds_write_b128 v122, a[164:167] offset:1024
ds_write_b128 v122, a[168:171] offset:57344
ds_write_b128 v122, a[172:175] offset:58368
v_cmp_lt_f32 vcc, s51, v120
s_cbranch_vccnz L_tramp2_29
L_back2_29:
EX 0
EX 1
EX 2
EX 3
EX 4
EX 5
EX 6
EX 7
CV 96,0
CV 97,2
CV 98,4
CV 99,6
WB 8
s_barrier
MM 8,56,96
s_mov_b32 s48, 188416
s_add_u32 m0, s41, 8192
KR 56,100,49152
AD 0
DM 112,8,0
MM 12,60,96
KR 60,100,53248
AD 1
MM 16,64,96
KR 64,101,49152
AD 2
MM 20,68,96
KR 68,101,53248
AD 3
MM 24,72,96
KR 72,102,49152
AD 4
MM 28,76,96
KR 76,102,53248
AD 5
MM 32,80,96
KR 80,103,49152
AD 6
DM 113,8,1024
MM 36,84,96
KR 84,103,53248
AD 7
WL 4
MN 0,56,40
TR 56,104,16384
TR 58,104,20480
MN 4,60,40
s_mov_b32 s48, 180224
s_add_u32 m0, s41, 57344
TR 60,105,16384
TR 62,105,20480
DM 114,12,0
v_max3_f32 v120, v88, v89, v90
MM 0,64,44
TR 64,106,16384
TR 66,106,20480
v_max3_f32 v121, v91, v92, v93
MM 4,68,44
TR 68,107,16384
TR 70,107,20480
v_max3_f32 v120, v120, v94, v95
WL 8
MM 0,72,48
TR 72,108,16384
TR 74,108,20480
v_max_f32 v120, v120, v121
MM 4,76,48
TR 76,109,16384
TR 78,109,20480
DM 115,12,1024
MM 0,80,52
TR 80,110,16384
TR 82,110,20480
MM 4,84,52
WL 12
TR 84,111,16384
TR 86,111,20480
v_cmp_lt_f32 vcc, s51, v120
s_cbranch_vccnz L_tramp2_30
L_back2_30:
EX 88
EX 89
EX 90
EX 91
EX 92
EX 93
EX 94
EX 95
CV 96,88
CV 97,90
CV 98,92
CV 99,94
WL 0
s_barrier
MM 8,56,96
KR 56,100,24576
AD 88
MM 12,60,96
KR 60,100,28672
AD 89
MM 16,64,96
KR 64,101,24576
AD 90
MM 20,68,96
KR 68,101,28672
AD 91
MM 24,72,96
KR 72,102,24576
AD 92
MM 28,76,96
KR 76,102,28672
AD 93
MM 32,80,96
KR 80,103,24576
AD 94
MM 36,84,96
KR 84,103,28672
AD 95
WL 4
MN 88,56,40
TR 56,104,49152
TR 58,104,53248
MN 92,60,40
TR 60,105,49152
TR 62,105,53248
v_max3_f32 v120, v0, v1, v2
MM 88,64,44
TR 64,106,49152
TR 66,106,53248
v_max3_f32 v121, v3, v4, v5
MM 92,68,44
TR 68,107,49152
TR 70,107,53248
v_max3_f32 v120, v120, v6, v7
WL 8
MM 88,72,48
TR 72,108,49152
TR 74,108,53248
v_max_f32 v120, v120, v121
MM 92,76,48
TR 76,109,49152
TR 78,109,53248
MM 88,80,52
TR 80,110,49152
TR 82,110,53248
MM 92,84,52
WL 12
TR 84,111,49152
TR 86,111,53248
v_cmp_lt_f32 vcc, s51, v120
s_cbranch_vccnz L_tramp2_31
L_back2_31:
EX 0
EX 1
EX 2
EX 3
EX 4
EX 5
EX 6
EX 7
CV 96,0
CV 97,2
CV 98,4
CV 99,6
WB 8
s_barrier
MM 8,56,96
s_mov_b32 s48, 196608
s_add_u32 m0, s41, 16384
KR 56,100,32768
AD 0
DM 112,8,0
MM 12,60,96
KR 60,100,36864
AD 1
MM 16,64,96
KR 64,101,32768
AD 2
MM 20,68,96
KR 68,101,36864
AD 3
MM 24,72,96
KR 72,102,32768
AD 4
MM 28,76,96
KR 76,102,36864
AD 5
MM 32,80,96
KR 80,103,32768
AD 6
DM 113,8,1024
MM 36,84,96
KR 84,103,36864
AD 7
WL 4
MN 0,56,40
TR 56,104,24576
TR 58,104,28672
MN 4,60,40
s_mov_b32 s48, 188416
s_add_u32 m0, s41, 65536
TR 60,105,24576
TR 62,105,28672
DM 114,12,0
v_max3_f32 v120, v88, v89, v90
MM 0,64,44
TR 64,106,24576
TR 66,106,28672
v_max3_f32 v121, v91, v92, v93
MM 4,68,44
TR 68,107,24576
TR 70,107,28672
v_max3_f32 v120, v120, v94, v95
WL 8
MM 0,72,48
TR 72,108,24576
TR 74,108,28672
v_max_f32 v120, v120, v121
MM 4,76,48
TR 76,109,24576
TR 78,109,28672
DM 115,12,1024
MM 0,80,52
TR 80,110,24576
TR 82,110,28672
MM 4,84,52
WL 12
TR 84,111,24576
TR 86,111,28672
WL 8
s_add_u32 s43, s41, 49152
v_add_u32 v122, s43, v118
ds_write_b128 v122, a[176:179] offset:0
ds_write_b128 v122, a[180:183] offset:1024
ds_write_b128 v122, a[184:187] offset:57344
ds_write_b128 v122, a[188:191] offset:58368
v_cmp_lt_f32 vcc, s51, v120
s_cbranch_vccnz L_tramp2_32
L_back2_32:
EX 88
EX 89
EX 90
EX 91
EX 92
EX 93
EX 94
EX 95
CV 96,88
CV 97,90
CV 98,92
CV 99,94
WB 8
s_barrier
MM 8,56,96
s_mov_b32 s48, 204800
s_add_u32 m0, s41, 24576
KR 56,100,40960
AD 88
DM 112,8,0
MM 12,60,96
KR 60,100,45056
AD 89
MM 16,64,96
KR 64,101,40960
AD 90
MM 20,68,96
KR 68,101,45056
AD 91
MM 24,72,96
KR 72,102,40960
AD 92
MM 28,76,96
KR 76,102,45056
AD 93
MM 32,80,96
KR 80,103,40960
AD 94
DM 113,8,1024
MM 36,84,96
KR 84,103,45056
AD 95
WL 4
MN 88,56,40
TR 56,104,32768
TR 58,104,36864
MN 92,60,40
s_mov_b32 s48, 196608
s_add_u32 m0, s41, 73728
TR 60,105,32768
TR 62,105,36864
DM 114,12,0
v_max3_f32 v120, v0, v1, v2
MM 88,64,44
TR 64,106,32768
TR 66,106,36864
v_max3_f32 v121, v3, v4, v5
MM 92,68,44
TR 68,107,32768
TR 70,107,36864
v_max3_f32 v120, v120, v6, v7
WL 8
MM 88,72,48
TR 72,108,32768
TR 74,108,36864
v_max_f32 v120, v120, v121
MM 92,76,48
TR 76,109,32768
TR 78,109,36864
DM 115,12,1024
MM 88,80,52
TR 80,110,32768
TR 82,110,36864
MM 92,84,52
WL 12
TR 84,111,32768
TR 86,111,36864
v_cmp_lt_f32 vcc, s51, v120
s_cbranch_vccnz L_tramp2_33
L_back2_33:
EX 0
EX 1
EX 2
EX 3
EX 4
EX 5
EX 6
EX 7
CV 96,0
CV 97,2
CV 98,4
CV 99,6
WL 0
s_barrier
MM 8,56,96
KR 56,100,0
AD 0
MM 12,60,96
KR 60,100,4096
AD 1
MM 16,64,96
KR 64,101,0
AD 2
MM 20,68,96
KR 68,101,4096
AD 3
MM 24,72,96
KR 72,102,0
AD 4
MM 28,76,96
KR 76,102,4096
AD 5
MM 32,80,96
KR 80,103,0
AD 6
MM 36,84,96
KR 84,103,4096
AD 7
WL 4
MN 0,56,40
TR 56,104,40960
TR 58,104,45056
MN 4,60,40
TR 60,105,40960
TR 62,105,45056
v_max3_f32 v120, v88, v89, v90
MM 0,64,44
TR 64,106,40960
TR 66,106,45056
v_max3_f32 v121, v91, v92, v93
MM 4,68,44
TR 68,107,40960
TR 70,107,45056
v_max3_f32 v120, v120, v94, v95
WL 8
MM 0,72,48
TR 72,108,40960
TR 74,108,45056
v_max_f32 v120, v120, v121
MM 4,76,48
TR 76,109,40960
TR 78,109,45056
MM 0,80,52
TR 80,110,40960
TR 82,110,45056
MM 4,84,52
WL 12
TR 84,111,40960
TR 86,111,45056
v_cmp_lt_f32 vcc, s51, v120
s_cbranch_vccnz L_tramp2_34
L_back2_34:
EX 88
EX 89
EX 90
EX 91
EX 92
EX 93
EX 94
EX 95
CV 96,88
CV 97,90
CV 98,92
CV 99,94
WB 8
s_barrier
MM 8,56,96
s_mov_b32 s48, 212992
s_add_u32 m0, s41, 32768
KR 56,100,8192
AD 88
DM 112,8,0
MM 12,60,96
KR 60,100,12288
AD 89
MM 16,64,96
KR 64,101,8192
AD 90
MM 20,68,96
KR 68,101,12288
AD 91
MM 24,72,96
KR 72,102,8192
AD 92
MM 28,76,96
KR 76,102,12288
AD 93
MM 32,80,96
KR 80,103,8192
AD 94
DM 113,8,1024
MM 36,84,96
KR 84,103,12288
AD 95
WL 4
MN 88,56,40
TR 56,104,0
TR 58,104,4096
MN 92,60,40
s_mov_b32 s48, 204800
s_add_u32 m0, s41, 81920
TR 60,105,0
TR 62,105,4096
DM 114,12,0
v_max3_f32 v120, v0, v1, v2
MM 88,64,44
TR 64,106,0
TR 66,106,4096
v_max3_f32 v121, v3, v4, v5
MM 92,68,44
TR 68,107,0
TR 70,107,4096
v_max3_f32 v120, v120, v6, v7
WL 8
MM 88,72,48
TR 72,108,0
TR 74,108,4096
v_max_f32 v120, v120, v121
MM 92,76,48
TR 76,109,0
TR 78,109,4096
DM 115,12,1024
MM 88,80,52
TR 80,110,0
TR 82,110,4096
MM 92,84,52
WL 12
TR 84,111,0
TR 86,111,4096
WL 8
s_add_u32 s43, s41, 40960
v_add_u32 v122, s43, v118
ds_write_b128 v122, a[192:195] offset:0
ds_write_b128 v122, a[196:199] offset:1024
ds_write_b128 v122, a[200:203] offset:57344
ds_write_b128 v122, a[204:207] offset:58368
v_cmp_lt_f32 vcc, s51, v120
s_cbranch_vccnz L_tramp2_35
L_back2_35:
EX 0
EX 1
EX 2
EX 3
EX 4
EX 5
EX 6
EX 7
CV 96,0
CV 97,2
CV 98,4
CV 99,6
WB 8
s_barrier
MM 8,56,96
s_mov_b32 s48, 221184
s_add_u32 m0, s41, 0
KR 56,100,49152
AD 0
DM 112,8,0
MM 12,60,96
KR 60,100,53248
AD 1
MM 16,64,96
KR 64,101,49152
AD 2
MM 20,68,96
KR 68,101,53248
AD 3
MM 24,72,96
KR 72,102,49152
AD 4
MM 28,76,96
KR 76,102,53248
AD 5
MM 32,80,96
KR 80,103,49152
AD 6
DM 113,8,1024
MM 36,84,96
KR 84,103,53248
AD 7
WL 4
MN 0,56,40
TR 56,104,8192
TR 58,104,12288
MN 4,60,40
s_mov_b32 s48, 212992
s_add_u32 m0, s41, 90112
TR 60,105,8192
TR 62,105,12288
DM 114,12,0
v_max3_f32 v120, v88, v89, v90
MM 0,64,44
TR 64,106,8192
TR 66,106,12288
v_max3_f32 v121, v91, v92, v93
MM 4,68,44
TR 68,107,8192
TR 70,107,12288
v_max3_f32 v120, v120, v94, v95
WL 8
MM 0,72,48
TR 72,108,8192
TR 74,108,12288
v_max_f32 v120, v120, v121
MM 4,76,48
TR 76,109,8192
TR 78,109,12288
DM 115,12,1024
MM 0,80,52
TR 80,110,8192
TR 82,110,12288
MM 4,84,52
WL 12
TR 84,111,8192
TR 86,111,12288
v_cmp_lt_f32 vcc, s51, v120
s_cbranch_vccnz L_tramp2_36
L_back2_36:
EX 88
EX 89
EX 90
EX 91
EX 92
EX 93
EX 94
EX 95
CV 96,88
CV 97,90
CV 98,92
CV 99,94
WL 0
s_barrier
MM 8,56,96
KR 56,100,16384
AD 88
MM 12,60,96
KR 60,100,20480
AD 89
MM 16,64,96
KR 64,101,16384
AD 90
MM 20,68,96
KR 68,101,20480
AD 91
MM 24,72,96
KR 72,102,16384
AD 92
MM 28,76,96
KR 76,102,20480
AD 93
MM 32,80,96
KR 80,103,16384
AD 94
MM 36,84,96
KR 84,103,20480
AD 95
WL 4
MN 88,56,40
TR 56,104,49152
TR 58,104,53248
MN 92,60,40
TR 60,105,49152
TR 62,105,53248
v_max3_f32 v120, v0, v1, v2
MM 88,64,44
TR 64,106,49152
TR 66,106,53248
v_max3_f32 v121, v3, v4, v5
MM 92,68,44
TR 68,107,49152
TR 70,107,53248
v_max3_f32 v120, v120, v6, v7
WL 8
MM 88,72,48
TR 72,108,49152
TR 74,108,53248
v_max_f32 v120, v120, v121
MM 92,76,48
TR 76,109,49152
TR 78,109,53248
MM 88,80,52
TR 80,110,49152
TR 82,110,53248
MM 92,84,52
WL 12
TR 84,111,49152
TR 86,111,53248
v_cmp_lt_f32 vcc, s51, v120
s_cbranch_vccnz L_tramp2_37
L_back2_37:
EX 0
EX 1
EX 2
EX 3
EX 4
EX 5
EX 6
EX 7
CV 96,0
CV 97,2
CV 98,4
CV 99,6
WB 8
s_barrier
MM 8,56,96
s_mov_b32 s48, 229376
s_add_u32 m0, s41, 8192
KR 56,100,24576
AD 0
DM 112,8,0
MM 12,60,96
KR 60,100,28672
AD 1
MM 16,64,96
KR 64,101,24576
AD 2
MM 20,68,96
KR 68,101,28672
AD 3
MM 24,72,96
KR 72,102,24576
AD 4
MM 28,76,96
KR 76,102,28672
AD 5
MM 32,80,96
KR 80,103,24576
AD 6
DM 113,8,1024
MM 36,84,96
KR 84,103,28672
AD 7
WL 4
MN 0,56,40
TR 56,104,16384
TR 58,104,20480
MN 4,60,40
s_mov_b32 s48, 221184
s_add_u32 m0, s41, 57344
TR 60,105,16384
TR 62,105,20480
DM 114,12,0
v_max3_f32 v120, v88, v89, v90
MM 0,64,44
TR 64,106,16384
TR 66,106,20480
v_max3_f32 v121, v91, v92, v93
MM 4,68,44
TR 68,107,16384
TR 70,107,20480
v_max3_f32 v120, v120, v94, v95
WL 8
MM 0,72,48
TR 72,108,16384
TR 74,108,20480
v_max_f32 v120, v120, v121
MM 4,76,48
TR 76,109,16384
TR 78,109,20480
DM 115,12,1024
MM 0,80,52
TR 80,110,16384
TR 82,110,20480
MM 4,84,52
WL 12
TR 84,111,16384
TR 86,111,20480
WL 8
s_add_u32 s43, s41, 49152
v_add_u32 v122, s43, v118
ds_write_b128 v122, a[208:211] offset:0
ds_write_b128 v122, a[212:215] offset:1024
ds_write_b128 v122, a[216:219] offset:57344
ds_write_b128 v122, a[220:223] offset:58368
v_cmp_lt_f32 vcc, s51, v120
s_cbranch_vccnz L_tramp2_38
L_back2_38:
EX 88
EX 89
EX 90
EX 91
EX 92
EX 93
EX 94
EX 95
CV 96,88
CV 97,90
CV 98,92
CV 99,94
WB 8
s_barrier
MM 8,56,96
s_mov_b32 s48, 237568
s_add_u32 m0, s41, 16384
KR 56,100,40960
AD 88
DM 112,8,0
MM 12,60,96
KR 60,100,45056
AD 89
MM 16,64,96
KR 64,101,40960
AD 90
MM 20,68,96
KR 68,101,45056
AD 91
MM 24,72,96
KR 72,102,40960
AD 92
MM 28,76,96
KR 76,102,45056
AD 93
MM 32,80,96
KR 80,103,40960
AD 94
DM 113,8,1024
MM 36,84,96
KR 84,103,45056
AD 95
WL 4
MN 88,56,40
TR 56,104,24576
TR 58,104,28672
MN 92,60,40
s_mov_b32 s48, 229376
s_add_u32 m0, s41, 65536
TR 60,105,24576
TR 62,105,28672
DM 114,12,0
v_max3_f32 v120, v0, v1, v2
MM 88,64,44
TR 64,106,24576
TR 66,106,28672
v_max3_f32 v121, v3, v4, v5
MM 92,68,44
TR 68,107,24576
TR 70,107,28672
v_max3_f32 v120, v120, v6, v7
WL 8
MM 88,72,48
TR 72,108,24576
TR 74,108,28672
v_max_f32 v120, v120, v121
MM 92,76,48
TR 76,109,24576
TR 78,109,28672
DM 115,12,1024
MM 88,80,52
TR 80,110,24576
TR 82,110,28672
MM 92,84,52
WL 12
TR 84,111,24576
TR 86,111,28672
v_cmp_lt_f32 vcc, s51, v120
s_cbranch_vccnz L_tramp2_39
L_back2_39:
EX 0
EX 1
EX 2
EX 3
EX 4
EX 5
EX 6
EX 7
CV 96,0
CV 97,2
CV 98,4
CV 99,6
WL 0
s_barrier
MM 8,56,96
KR 56,100,32768
AD 0
MM 12,60,96
KR 60,100,36864
AD 1
MM 16,64,96
KR 64,101,32768
AD 2
MM 20,68,96
KR 68,101,36864
AD 3
MM 24,72,96
KR 72,102,32768
AD 4
MM 28,76,96
KR 76,102,36864
AD 5
MM 32,80,96
KR 80,103,32768
AD 6
MM 36,84,96
KR 84,103,36864
AD 7
WL 4
MN 0,56,40
TR 56,104,40960
TR 58,104,45056
MN 4,60,40
TR 60,105,40960
TR 62,105,45056
v_max3_f32 v120, v88, v89, v90
MM 0,64,44
TR 64,106,40960
TR 66,106,45056
v_max3_f32 v121, v91, v92, v93
MM 4,68,44
TR 68,107,40960
TR 70,107,45056
v_max3_f32 v120, v120, v94, v95
WL 8
MM 0,72,48
TR 72,108,40960
TR 74,108,45056
v_max_f32 v120, v120, v121
MM 4,76,48
TR 76,109,40960
TR 78,109,45056
MM 0,80,52
TR 80,110,40960
TR 82,110,45056
MM 4,84,52
WL 12
TR 84,111,40960
TR 86,111,45056
v_cmp_lt_f32 vcc, s51, v120
s_cbranch_vccnz L_tramp2_40
L_back2_40:
EX 88
EX 89
EX 90
EX 91
EX 92
EX 93
EX 94
EX 95
CV 96,88
CV 97,90
CV 98,92
CV 99,94
WB 8
s_barrier
MM 8,56,96
s_mov_b32 s48, 245760
s_add_u32 m0, s41, 24576
KR 56,100,0
AD 88
DM 112,8,0
MM 12,60,96
KR 60,100,4096
AD 89
MM 16,64,96
KR 64,101,0
AD 90
MM 20,68,96
KR 68,101,4096
AD 91
MM 24,72,96
KR 72,102,0
AD 92
MM 28,76,96
KR 76,102,4096
AD 93
MM 32,80,96
KR 80,103,0
AD 94
DM 113,8,1024
MM 36,84,96
KR 84,103,4096
AD 95
WL 4
MN 88,56,40
TR 56,104,32768
TR 58,104,36864
MN 92,60,40
s_mov_b32 s48, 237568
s_add_u32 m0, s41, 73728
TR 60,105,32768
TR 62,105,36864
DM 114,12,0
v_max3_f32 v120, v0, v1, v2
MM 88,64,44
TR 64,106,32768
TR 66,106,36864
v_max3_f32 v121, v3, v4, v5
MM 92,68,44
TR 68,107,32768
TR 70,107,36864
v_max3_f32 v120, v120, v6, v7
WL 8
MM 88,72,48
TR 72,108,32768
TR 74,108,36864
v_max_f32 v120, v120, v121
MM 92,76,48
TR 76,109,32768
TR 78,109,36864
DM 115,12,1024
MM 88,80,52
TR 80,110,32768
TR 82,110,36864
MM 92,84,52
WL 12
TR 84,111,32768
TR 86,111,36864
WL 8
s_add_u32 s43, s41, 40960
v_add_u32 v122, s43, v118
ds_write_b128 v122, a[224:227] offset:0
ds_write_b128 v122, a[228:231] offset:1024
ds_write_b128 v122, a[232:235] offset:57344
ds_write_b128 v122, a[236:239] offset:58368
v_cmp_lt_f32 vcc, s51, v120
s_cbranch_vccnz L_tramp2_41
L_back2_41:
EX 0
EX 1
EX 2
EX 3
EX 4
EX 5
EX 6
EX 7
CV 96,0
CV 97,2
CV 98,4
CV 99,6
WB 8
s_barrier
MM 8,56,96
s_mov_b32 s48, 253952
s_add_u32 m0, s41, 32768
KR 56,100,49152
AD 0
DM 112,8,0
MM 12,60,96
KR 60,100,53248
AD 1
MM 16,64,96
KR 64,101,49152
AD 2
MM 20,68,96
KR 68,101,53248
AD 3
MM 24,72,96
KR 72,102,49152
AD 4
MM 28,76,96
KR 76,102,53248
AD 5
MM 32,80,96
KR 80,103,49152
AD 6
DM 113,8,1024
MM 36,84,96
KR 84,103,53248
AD 7
WL 4
MN 0,56,40
TR 56,104,0
TR 58,104,4096
MN 4,60,40
s_mov_b32 s48, 245760
s_add_u32 m0, s41, 81920
TR 60,105,0
TR 62,105,4096
DM 114,12,0
v_max3_f32 v120, v88, v89, v90
MM 0,64,44
TR 64,106,0
TR 66,106,4096
v_max3_f32 v121, v91, v92, v93
MM 4,68,44
TR 68,107,0
TR 70,107,4096
v_max3_f32 v120, v120, v94, v95
WL 8
MM 0,72,48
TR 72,108,0
TR 74,108,4096
v_max_f32 v120, v120, v121
MM 4,76,48
TR 76,109,0
TR 78,109,4096
DM 115,12,1024
MM 0,80,52
TR 80,110,0
TR 82,110,4096
MM 4,84,52
WL 12
TR 84,111,0
TR 86,111,4096
v_cmp_lt_f32 vcc, s51, v120
s_cbranch_vccnz L_tramp2_42
L_back2_42:
EX 88
EX 89
EX 90
EX 91
EX 92
EX 93
EX 94
EX 95
CV 96,88
CV 97,90
CV 98,92
CV 99,94
WL 0
s_barrier
MM 8,56,96
KR 56,100,8192
AD 88
MM 12,60,96
KR 60,100,12288
AD 89
MM 16,64,96
KR 64,101,8192
AD 90
MM 20,68,96
KR 68,101,12288
AD 91
MM 24,72,96
KR 72,102,8192
AD 92
MM 28,76,96
KR 76,102,12288
AD 93
MM 32,80,96
KR 80,103,8192
AD 94
MM 36,84,96
KR 84,103,12288
AD 95
WL 4
MN 88,56,40
TR 56,104,49152
TR 58,104,53248
MN 92,60,40
TR 60,105,49152
TR 62,105,53248
v_max3_f32 v120, v0, v1, v2
MM 88,64,44
TR 64,106,49152
TR 66,106,53248
v_max3_f32 v121, v3, v4, v5
MM 92,68,44
TR 68,107,49152
TR 70,107,53248
v_max3_f32 v120, v120, v6, v7
WL 8
MM 88,72,48
TR 72,108,49152
TR 74,108,53248
v_max_f32 v120, v120, v121
MM 92,76,48
TR 76,109,49152
TR 78,109,53248
MM 88,80,52
TR 80,110,49152
TR 82,110,53248
MM 92,84,52
WL 12
TR 84,111,49152
TR 86,111,53248
v_cmp_lt_f32 vcc, s51, v120
s_cbranch_vccnz L_tramp2_43
L_back2_43:
EX 0
EX 1
EX 2
EX 3
EX 4
EX 5
EX 6
EX 7
CV 96,0
CV 97,2
CV 98,4
CV 99,6
WB 8
s_barrier
MM 8,56,96
s_mov_b32 s48, 262144
s_add_u32 m0, s41, 0
KR 56,100,16384
AD 0
DM 112,8,0
MM 12,60,96
KR 60,100,20480
AD 1
MM 16,64,96
KR 64,101,16384
AD 2
MM 20,68,96
KR 68,101,20480
AD 3
MM 24,72,96
KR 72,102,16384
AD 4
MM 28,76,96
KR 76,102,20480
AD 5
MM 32,80,96
KR 80,103,16384
AD 6
DM 113,8,1024
MM 36,84,96
KR 84,103,20480
AD 7
WL 4
MN 0,56,40
TR 56,104,8192
TR 58,104,12288
MN 4,60,40
s_mov_b32 s48, 253952
s_add_u32 m0, s41, 90112
TR 60,105,8192
TR 62,105,12288
DM 114,12,0
v_max3_f32 v120, v88, v89, v90
MM 0,64,44
TR 64,106,8192
TR 66,106,12288
v_max3_f32 v121, v91, v92, v93
MM 4,68,44
TR 68,107,8192
TR 70,107,12288
v_max3_f32 v120, v120, v94, v95
WL 8
MM 0,72,48
TR 72,108,8192
TR 74,108,12288
v_max_f32 v120, v120, v121
MM 4,76,48
TR 76,109,8192
TR 78,109,12288
DM 115,12,1024
MM 0,80,52
TR 80,110,8192
TR 82,110,12288
MM 4,84,52
WL 12
TR 84,111,8192
TR 86,111,12288
WL 8
s_add_u32 s43, s41, 49152
v_add_u32 v122, s43, v118
ds_write_b128 v122, a[240:243] offset:0
ds_write_b128 v122, a[244:247] offset:1024
ds_write_b128 v122, a[248:251] offset:57344
ds_write_b128 v122, a[252:255] offset:58368
v_cmp_lt_f32 vcc, s51, v120
s_cbranch_vccnz L_tramp2_44
L_back2_44:
EX 88
EX 89
EX 90
EX 91
EX 92
EX 93
EX 94
EX 95
CV 96,88
CV 97,90
CV 98,92
CV 99,94
WB 8
s_barrier
MM 8,56,96
s_mov_b32 s48, 270336
s_add_u32 m0, s41, 8192
KR 56,100,40960
AD 88
DM 112,8,0
MM 12,60,96
KR 60,100,45056
AD 89
MM 16,64,96
KR 64,101,40960
AD 90
MM 20,68,96
KR 68,101,45056
AD 91
MM 24,72,96
KR 72,102,40960
AD 92
MM 28,76,96
KR 76,102,45056
AD 93
MM 32,80,96
KR 80,103,40960
AD 94
DM 113,8,1024
MM 36,84,96
KR 84,103,45056
AD 95
WL 4
MN 88,56,40
TR 56,104,16384
TR 58,104,20480
MN 92,60,40
s_mov_b32 s48, 262144
s_add_u32 m0, s41, 57344
TR 60,105,16384
TR 62,105,20480
DM 114,12,0
v_max3_f32 v120, v0, v1, v2
MM 88,64,44
TR 64,106,16384
TR 66,106,20480
v_max3_f32 v121, v3, v4, v5
MM 92,68,44
TR 68,107,16384
TR 70,107,20480
v_max3_f32 v120, v120, v6, v7
WL 8
MM 88,72,48
TR 72,108,16384
TR 74,108,20480
v_max_f32 v120, v120, v121
MM 92,76,48
TR 76,109,16384
TR 78,109,20480
DM 115,12,1024
MM 88,80,52
TR 80,110,16384
TR 82,110,20480
MM 92,84,52
WL 12
TR 84,111,16384
TR 86,111,20480
v_cmp_lt_f32 vcc, s51, v120
s_cbranch_vccnz L_tramp2_45
L_back2_45:
EX 0
EX 1
EX 2
EX 3
EX 4
EX 5
EX 6
EX 7
CV 96,0
CV 97,2
CV 98,4
CV 99,6
WL 0
s_barrier
MM 8,56,96
KR 56,100,24576
AD 0
MM 12,60,96
KR 60,100,28672
AD 1
MM 16,64,96
KR 64,101,24576
AD 2
MM 20,68,96
KR 68,101,28672
AD 3
MM 24,72,96
KR 72,102,24576
AD 4
MM 28,76,96
KR 76,102,28672
AD 5
MM 32,80,96
KR 80,103,24576
AD 6
MM 36,84,96
KR 84,103,28672
AD 7
WL 4
MN 0,56,40
TR 56,104,40960
TR 58,104,45056
MN 4,60,40
TR 60,105,40960
TR 62,105,45056
v_max3_f32 v120, v88, v89, v90
MM 0,64,44
TR 64,106,40960
TR 66,106,45056
v_max3_f32 v121, v91, v92, v93
MM 4,68,44
TR 68,107,40960
TR 70,107,45056
v_max3_f32 v120, v120, v94, v95
WL 8
MM 0,72,48
TR 72,108,40960
TR 74,108,45056
v_max_f32 v120, v120, v121
MM 4,76,48
TR 76,109,40960
TR 78,109,45056
MM 0,80,52
TR 80,110,40960
TR 82,110,45056
MM 4,84,52
WL 12
TR 84,111,40960
TR 86,111,45056
v_cmp_lt_f32 vcc, s51, v120
s_cbranch_vccnz L_tramp2_46
L_back2_46:
EX 88
EX 89
EX 90
EX 91
EX 92
EX 93
EX 94
EX 95
CV 96,88
CV 97,90
CV 98,92
CV 99,94
WB 8
s_barrier
MM 8,56,96
s_mov_b32 s48, 278528
s_add_u32 m0, s41, 16384
KR 56,100,32768
AD 88
DM 112,8,0
MM 12,60,96
KR 60,100,36864
AD 89
MM 16,64,96
KR 64,101,32768
AD 90
MM 20,68,96
KR 68,101,36864
AD 91
MM 24,72,96
KR 72,102,32768
AD 92
MM 28,76,96
KR 76,102,36864
AD 93
MM 32,80,96
KR 80,103,32768
AD 94
DM 113,8,1024
MM 36,84,96
KR 84,103,36864
AD 95
WL 4
MN 88,56,40
TR 56,104,24576
TR 58,104,28672
MN 92,60,40
s_mov_b32 s48, 270336
s_add_u32 m0, s41, 65536
TR 60,105,24576
TR 62,105,28672
DM 114,12,0
v_max3_f32 v120, v0, v1, v2
MM 88,64,44
TR 64,106,24576
TR 66,106,28672
v_max3_f32 v121, v3, v4, v5
MM 92,68,44
TR 68,107,24576
TR 70,107,28672
v_max3_f32 v120, v120, v6, v7
WL 8
MM 88,72,48
TR 72,108,24576
TR 74,108,28672
v_max_f32 v120, v120, v121
MM 92,76,48
TR 76,109,24576
TR 78,109,28672
DM 115,12,1024
MM 88,80,52
TR 80,110,24576
TR 82,110,28672
MM 92,84,52
WL 12
TR 84,111,24576
TR 86,111,28672
WL 8
s_add_u32 s43, s41, 40960
v_add_u32 v122, s43, v118
ds_write_b128 v122, v[232:235] offset:0
ds_write_b128 v122, v[236:239] offset:1024
ds_write_b128 v122, v[240:243] offset:57344
ds_write_b128 v122, v[244:247] offset:58368
v_cmp_lt_f32 vcc, s51, v120
s_cbranch_vccnz L_tramp2_47
L_back2_47:
EX 0
EX 1
EX 2
EX 3
EX 4
EX 5
EX 6
EX 7
CV 96,0
CV 97,2
CV 98,4
CV 99,6
WB 8
s_barrier
MM 8,56,96
s_mov_b32 s48, 286720
s_add_u32 m0, s41, 24576
KR 56,100,49152
AD 0
DM 112,8,0
MM 12,60,96
KR 60,100,53248
AD 1
MM 16,64,96
KR 64,101,49152
AD 2
MM 20,68,96
KR 68,101,53248
AD 3
MM 24,72,96
KR 72,102,49152
AD 4
MM 28,76,96
KR 76,102,53248
AD 5
MM 32,80,96
KR 80,103,49152
AD 6
DM 113,8,1024
MM 36,84,96
KR 84,103,53248
AD 7
WL 4
MN 0,56,40
TR 56,104,32768
TR 58,104,36864
MN 4,60,40
s_mov_b32 s48, 278528
s_add_u32 m0, s41, 73728
TR 60,105,32768
TR 62,105,36864
DM 114,12,0
v_max3_f32 v120, v88, v89, v90
MM 0,64,44
TR 64,106,32768
TR 66,106,36864
v_max3_f32 v121, v91, v92, v93
MM 4,68,44
TR 68,107,32768
TR 70,107,36864
v_max3_f32 v120, v120, v94, v95
WL 8
MM 0,72,48
TR 72,108,32768
TR 74,108,36864
v_max_f32 v120, v120, v121
MM 4,76,48
TR 76,109,32768
TR 78,109,36864
DM 115,12,1024
MM 0,80,52
TR 80,110,32768
TR 82,110,36864
MM 4,84,52
WL 12
TR 84,111,32768
TR 86,111,36864
v_cmp_lt_f32 vcc, s51, v120
s_cbranch_vccnz L_tramp2_48
L_back2_48:
EX 88
EX 89
EX 90
EX 91
EX 92
EX 93
EX 94
EX 95
CV 96,88
CV 97,90
CV 98,92
CV 99,94
WL 0
s_barrier
MM 8,56,96
KR 56,100,0
AD 88
MM 12,60,96
KR 60,100,4096
AD 89
MM 16,64,96
KR 64,101,0
AD 90
MM 20,68,96
KR 68,101,4096
AD 91
MM 24,72,96
KR 72,102,0
AD 92
MM 28,76,96
KR 76,102,4096
AD 93
MM 32,80,96
KR 80,103,0
AD 94
MM 36,84,96
KR 84,103,4096
AD 95
WL 4
MN 88,56,40
TR 56,104,49152
TR 58,104,53248
MN 92,60,40
TR 60,105,49152
TR 62,105,53248
v_max3_f32 v120, v0, v1, v2
MM 88,64,44
TR 64,106,49152
TR 66,106,53248
v_max3_f32 v121, v3, v4, v5
MM 92,68,44
TR 68,107,49152
TR 70,107,53248
v_max3_f32 v120, v120, v6, v7
WL 8
MM 88,72,48
TR 72,108,49152
TR 74,108,53248
v_max_f32 v120, v120, v121
MM 92,76,48
TR 76,109,49152
TR 78,109,53248
MM 88,80,52
TR 80,110,49152
TR 82,110,53248
MM 92,84,52
WL 12
TR 84,111,49152
TR 86,111,53248
v_cmp_lt_f32 vcc, s51, v120
s_cbranch_vccnz L_tramp2_49
L_back2_49:
EX 0
EX 1
EX 2
EX 3
EX 4
EX 5
EX 6
EX 7
CV 96,0
CV 97,2
CV 98,4
CV 99,6
WB 8
s_barrier
MM 8,56,96
s_mov_b32 s48, 294912
s_add_u32 m0, s41, 32768
KR 56,100,8192
AD 0
DM 112,8,0
MM 12,60,96
KR 60,100,12288
AD 1
MM 16,64,96
KR 64,101,8192
AD 2
MM 20,68,96
KR 68,101,12288
AD 3
MM 24,72,96
KR 72,102,8192
AD 4
MM 28,76,96
KR 76,102,12288
AD 5
MM 32,80,96
KR 80,103,8192
AD 6
DM 113,8,1024
MM 36,84,96
KR 84,103,12288
AD 7
WL 4
MN 0,56,40
TR 56,104,0
TR 58,104,4096
MN 4,60,40
s_mov_b32 s48, 286720
s_add_u32 m0, s41, 81920
TR 60,105,0
TR 62,105,4096
DM 114,12,0
v_max3_f32 v120, v88, v89, v90
MM 0,64,44
TR 64,106,0
TR 66,106,4096
v_max3_f32 v121, v91, v92, v93
MM 4,68,44
TR 68,107,0
TR 70,107,4096
v_max3_f32 v120, v120, v94, v95
WL 8
MM 0,72,48
TR 72,108,0
TR 74,108,4096
v_max_f32 v120, v120, v121
MM 4,76,48
TR 76,109,0
TR 78,109,4096
DM 115,12,1024
MM 0,80,52
TR 80,110,0
TR 82,110,4096
MM 4,84,52
WL 12
TR 84,111,0
TR 86,111,4096
v_cmp_lt_f32 vcc, s51, v120
s_cbranch_vccnz L_tramp2_50
L_back2_50:
EX 88
EX 89
EX 90
EX 91
EX 92
EX 93
EX 94
EX 95
CV 96,88
CV 97,90
CV 98,92
CV 99,94
WB 8
s_barrier
MM 8,56,96
s_mov_b32 s48, 303104
s_add_u32 m0, s41, 0
KR 56,100,40960
AD 88
DM 112,8,0
MM 12,60,96
KR 60,100,45056
AD 89
MM 16,64,96
KR 64,101,40960
AD 90
MM 20,68,96
KR 68,101,45056
AD 91
MM 24,72,96
KR 72,102,40960
AD 92
MM 28,76,96
KR 76,102,45056
AD 93
MM 32,80,96
KR 80,103,40960
AD 94
DM 113,8,1024
MM 36,84,96
KR 84,103,45056
AD 95
WL 4
MN 88,56,40
TR 56,104,8192
TR 58,104,12288
MN 92,60,40
s_mov_b32 s48, 294912
s_add_u32 m0, s41, 90112
TR 60,105,8192
TR 62,105,12288
DM 114,12,0
v_max3_f32 v120, v0, v1, v2
MM 88,64,44
TR 64,106,8192
TR 66,106,12288
v_max3_f32 v121, v3, v4, v5
MM 92,68,44
TR 68,107,8192
TR 70,107,12288
v_max3_f32 v120, v120, v6, v7
WL 8
MM 88,72,48
TR 72,108,8192
TR 74,108,12288
v_max_f32 v120, v120, v121
MM 92,76,48
TR 76,109,8192
TR 78,109,12288
DM 115,12,1024
MM 88,80,52
TR 80,110,8192
TR 82,110,12288
MM 92,84,52
WL 12
TR 84,111,8192
TR 86,111,12288
v_cmp_lt_f32 vcc, s51, v120
s_cbranch_vccnz L_tramp2_51
L_back2_51:
EX 0
EX 1
EX 2
EX 3
EX 4
EX 5
EX 6
EX 7
CV 96,0
CV 97,2
CV 98,4
CV 99,6
WL 0
s_barrier
MM 8,56,96
KR 56,100,16384
AD 0
MM 12,60,96
KR 60,100,20480
AD 1
MM 16,64,96
KR 64,101,16384
AD 2
MM 20,68,96
KR 68,101,20480
AD 3
MM 24,72,96
KR 72,102,16384
AD 4
MM 28,76,96
KR 76,102,20480
AD 5
MM 32,80,96
KR 80,103,16384
AD 6
MM 36,84,96
KR 84,103,20480
AD 7
WL 4
MN 0,56,40
TR 56,104,40960
TR 58,104,45056
MN 4,60,40
TR 60,105,40960
TR 62,105,45056
v_max3_f32 v120, v88, v89, v90
MM 0,64,44
TR 64,106,40960
TR 66,106,45056
v_max3_f32 v121, v91, v92, v93
MM 4,68,44
TR 68,107,40960
TR 70,107,45056
v_max3_f32 v120, v120, v94, v95
WL 8
MM 0,72,48
TR 72,108,40960
TR 74,108,45056
v_max_f32 v120, v120, v121
MM 4,76,48
TR 76,109,40960
TR 78,109,45056
MM 0,80,52
TR 80,110,40960
TR 82,110,45056
MM 4,84,52
WL 12
TR 84,111,40960
TR 86,111,45056
v_cmp_lt_f32 vcc, s51, v120
s_cbranch_vccnz L_tramp2_52
L_back2_52:
EX 88
EX 89
EX 90
EX 91
EX 92
EX 93
EX 94
EX 95
CV 96,88
CV 97,90
CV 98,92
CV 99,94
WB 8
s_barrier
MM 8,56,96
s_mov_b32 s48, 311296
s_add_u32 m0, s41, 8192
KR 56,100,24576
AD 88
DM 112,8,0
MM 12,60,96
KR 60,100,28672
AD 89
MM 16,64,96
KR 64,101,24576
AD 90
MM 20,68,96
KR 68,101,28672
AD 91
MM 24,72,96
KR 72,102,24576
AD 92
MM 28,76,96
KR 76,102,28672
AD 93
MM 32,80,96
KR 80,103,24576
AD 94
DM 113,8,1024
MM 36,84,96
KR 84,103,28672
AD 95
s_cmp_eq_u32 s3, 0
s_cbranch_scc1 L_btramp2_52_0
L_bback2_52_0:
WL 4
MN 88,56,40
TR 56,104,16384
TR 58,104,20480
MN 92,60,40
s_mov_b32 s48, 303104
s_add_u32 m0, s41, 57344
TR 60,105,16384
TR 62,105,20480
DM 114,12,0
v_max3_f32 v120, v0, v1, v2
MM 88,64,44
TR 64,106,16384
TR 66,106,20480
v_max3_f32 v121, v3, v4, v5
MM 92,68,44
TR 68,107,16384
TR 70,107,20480
v_max3_f32 v120, v120, v6, v7
WL 8
MM 88,72,48
TR 72,108,16384
TR 74,108,20480
v_max_f32 v120, v120, v121
MM 92,76,48
TR 76,109,16384
TR 78,109,20480
DM 115,12,1024
MM 88,80,52
TR 80,110,16384
TR 82,110,20480
MM 92,84,52
WL 12
TR 84,111,16384
TR 86,111,20480
v_cmp_lt_f32 vcc, s51, v120
s_cbranch_vccnz L_tramp2_53
L_back2_53:
EX 0
EX 1
EX 2
EX 3
EX 4
EX 5
EX 6
EX 7
CV 96,0
CV 97,2
CV 98,4
CV 99,6
WB 8
s_barrier
MM 8,56,96
s_mov_b32 s48, 319488
s_add_u32 m0, s41, 16384
KR 56,100,32768
AD 0
DM 112,8,0
MM 12,60,96
KR 60,100,36864
AD 1
MM 16,64,96
KR 64,101,32768
AD 2
MM 20,68,96
KR 68,101,36864
AD 3
MM 24,72,96
KR 72,102,32768
AD 4
MM 28,76,96
KR 76,102,36864
AD 5
MM 32,80,96
KR 80,103,32768
AD 6
DM 113,8,1024
MM 36,84,96
KR 84,103,36864
AD 7
WL 4
MN 0,56,40
TR 56,104,24576
TR 58,104,28672
MN 4,60,40
s_mov_b32 s48, 311296
s_add_u32 m0, s41, 65536
TR 60,105,24576
TR 62,105,28672
DM 114,12,0
v_max3_f32 v120, v88, v89, v90
MM 0,64,44
TR 64,106,24576
TR 66,106,28672
v_max3_f32 v121, v91, v92, v93
MM 4,68,44
TR 68,107,24576
TR 70,107,28672
v_max3_f32 v120, v120, v94, v95
WL 8
MM 0,72,48
TR 72,108,24576
TR 74,108,28672
v_max_f32 v120, v120, v121
MM 4,76,48
TR 76,109,24576
TR 78,109,28672
DM 115,12,1024
MM 0,80,52
TR 80,110,24576
TR 82,110,28672
MM 4,84,52
WL 12
TR 84,111,24576
TR 86,111,28672
v_cmp_lt_f32 vcc, s51, v120
s_cbranch_vccnz L_tramp2_54
L_back2_54:
EX 88
EX 89
EX 90
EX 91
EX 92
EX 93
EX 94
EX 95
CV 96,88
CV 97,90
CV 98,92
CV 99,94
WB 8
s_barrier
MM 8,56,96
s_mov_b32 s48, 327680
s_add_u32 m0, s41, 24576
KR 56,100,0
AD 88
DM 112,8,0
MM 12,60,96
KR 60,100,4096
AD 89
MM 16,64,96
KR 64,101,0
AD 90
MM 20,68,96
KR 68,101,4096
AD 91
MM 24,72,96
KR 72,102,0
AD 92
MM 28,76,96
KR 76,102,4096
AD 93
MM 32,80,96
KR 80,103,0
AD 94
DM 113,8,1024
MM 36,84,96
KR 84,103,4096
AD 95
s_cmp_eq_u32 s3, 1
s_cbranch_scc1 L_btramp2_54_0
L_bback2_54_0:
WL 4
MN 88,56,40
TR 56,104,32768
TR 58,104,36864
MN 92,60,40
s_mov_b32 s48, 319488
s_add_u32 m0, s41, 73728
TR 60,105,32768
TR 62,105,36864
DM 114,12,0
v_max3_f32 v120, v0, v1, v2
MM 88,64,44
TR 64,106,32768
TR 66,106,36864
v_max3_f32 v121, v3, v4, v5
MM 92,68,44
TR 68,107,32768
TR 70,107,36864
v_max3_f32 v120, v120, v6, v7
WL 8
MM 88,72,48
TR 72,108,32768
TR 74,108,36864
v_max_f32 v120, v120, v121
MM 92,76,48
TR 76,109,32768
TR 78,109,36864
DM 115,12,1024
MM 88,80,52
TR 80,110,32768
TR 82,110,36864
MM 92,84,52
WL 12
TR 84,111,32768
TR 86,111,36864
v_cmp_lt_f32 vcc, s51, v120
s_cbranch_vccnz L_tramp2_55
L_back2_55:
EX 0
EX 1
EX 2
EX 3
EX 4
EX 5
EX 6
EX 7
CV 96,0
CV 97,2
CV 98,4
CV 99,6
WB 8
s_barrier
MM 8,56,96
s_mov_b32 s48, 335872
s_add_u32 m0, s41, 32768
KR 56,100,8192
AD 0
DM 112,8,0
MM 12,60,96
KR 60,100,12288
AD 1
MM 16,64,96
KR 64,101,8192
AD 2
MM 20,68,96
KR 68,101,12288
AD 3
MM 24,72,96
KR 72,102,8192
AD 4
MM 28,76,96
KR 76,102,12288
AD 5
MM 32,80,96
KR 80,103,8192
AD 6
DM 113,8,1024
MM 36,84,96
KR 84,103,12288
AD 7
WL 4
MN 0,56,40
TR 56,104,0
TR 58,104,4096
MN 4,60,40
s_mov_b32 s48, 327680
s_add_u32 m0, s41, 81920
TR 60,105,0
TR 62,105,4096
DM 114,12,0
v_max3_f32 v120, v88, v89, v90
MM 0,64,44
TR 64,106,0
TR 66,106,4096
v_max3_f32 v121, v91, v92, v93
MM 4,68,44
TR 68,107,0
TR 70,107,4096
v_max3_f32 v120, v120, v94, v95
WL 8
MM 0,72,48
TR 72,108,0
TR 74,108,4096
v_max_f32 v120, v120, v121
MM 4,76,48
TR 76,109,0
TR 78,109,4096
DM 115,12,1024
MM 0,80,52
TR 80,110,0
TR 82,110,4096
MM 4,84,52
WL 12
TR 84,111,0
TR 86,111,4096
v_cmp_lt_f32 vcc, s51, v120
s_cbranch_vccnz L_tramp2_56
L_back2_56:
EX 88
EX 89
EX 90
EX 91
EX 92
EX 93
EX 94
EX 95
CV 96,88
CV 97,90
CV 98,92
CV 99,94
WB 8
s_barrier
MM 8,56,96
s_mov_b32 s48, 344064
s_add_u32 m0, s41, 0
KR 56,100,16384
AD 88
DM 112,8,0
MM 12,60,96
KR 60,100,20480
AD 89
MM 16,64,96
KR 64,101,16384
AD 90
MM 20,68,96
KR 68,101,20480
AD 91
MM 24,72,96
KR 72,102,16384
AD 92
MM 28,76,96
KR 76,102,20480
AD 93
MM 32,80,96
KR 80,103,16384
AD 94
DM 113,8,1024
MM 36,84,96
KR 84,103,20480
AD 95
s_cmp_eq_u32 s3, 2
s_cbranch_scc1 L_btramp2_56_0
L_bback2_56_0:
WL 4
MN 88,56,40
TR 56,104,8192
TR 58,104,12288
MN 92,60,40
s_mov_b32 s48, 335872
s_add_u32 m0, s41, 90112
TR 60,105,8192
TR 62,105,12288
DM 114,12,0
v_max3_f32 v120, v0, v1, v2
MM 88,64,44
TR 64,106,8192
TR 66,106,12288
v_max3_f32 v121, v3, v4, v5
MM 92,68,44
TR 68,107,8192
TR 70,107,12288
v_max3_f32 v120, v120, v6, v7
WL 8
MM 88,72,48
TR 72,108,8192
TR 74,108,12288
v_max_f32 v120, v120, v121
MM 92,76,48
TR 76,109,8192
TR 78,109,12288
DM 115,12,1024
MM 88,80,52
TR 80,110,8192
TR 82,110,12288
MM 92,84,52
WL 12
TR 84,111,8192
TR 86,111,12288
v_cmp_lt_f32 vcc, s51, v120
s_cbranch_vccnz L_tramp2_57
L_back2_57:
EX 0
EX 1
EX 2
EX 3
EX 4
EX 5
EX 6
EX 7
CV 96,0
CV 97,2
CV 98,4
CV 99,6
WB 8
s_barrier
MM 8,56,96
s_mov_b32 s48, 352256
s_add_u32 m0, s41, 8192
KR 56,100,24576
AD 0
DM 112,8,0
MM 12,60,96
KR 60,100,28672
AD 1
MM 16,64,96
KR 64,101,24576
AD 2
MM 20,68,96
KR 68,101,28672
AD 3
MM 24,72,96
KR 72,102,24576
AD 4
MM 28,76,96
KR 76,102,28672
AD 5
MM 32,80,96
KR 80,103,24576
AD 6
DM 113,8,1024
MM 36,84,96
KR 84,103,28672
AD 7
WL 4
MN 0,56,40
TR 56,104,16384
TR 58,104,20480
MN 4,60,40
s_mov_b32 s48, 344064
s_add_u32 m0, s41, 57344
TR 60,105,16384
TR 62,105,20480
DM 114,12,0
v_max3_f32 v120, v88, v89, v90
MM 0,64,44
TR 64,106,16384
TR 66,106,20480
v_max3_f32 v121, v91, v92, v93
MM 4,68,44
TR 68,107,16384
TR 70,107,20480
v_max3_f32 v120, v120, v94, v95
WL 8
MM 0,72,48
TR 72,108,16384
TR 74,108,20480
v_max_f32 v120, v120, v121
MM 4,76,48
TR 76,109,16384
TR 78,109,20480
DM 115,12,1024
MM 0,80,52
TR 80,110,16384
TR 82,110,20480
MM 4,84,52
WL 12
TR 84,111,16384
TR 86,111,20480
v_cmp_lt_f32 vcc, s51, v120
s_cbranch_vccnz L_tramp2_58
L_back2_58:
EX 88
EX 89
EX 90
EX 91
EX 92
EX 93
EX 94
EX 95
CV 96,88
CV 97,90
CV 98,92
CV 99,94
WB 8
s_barrier
MM 8,56,96
s_mov_b32 s48, 360448
s_add_u32 m0, s41, 16384
KR 56,100,32768
AD 88
DM 112,8,0
MM 12,60,96
KR 60,100,36864
AD 89
MM 16,64,96
KR 64,101,32768
AD 90
MM 20,68,96
KR 68,101,36864
AD 91
MM 24,72,96
KR 72,102,32768
AD 92
MM 28,76,96
KR 76,102,36864
AD 93
MM 32,80,96
KR 80,103,32768
AD 94
DM 113,8,1024
MM 36,84,96
KR 84,103,36864
AD 95
WL 4
MN 88,56,40
TR 56,104,24576
TR 58,104,28672
MN 92,60,40
s_mov_b32 s48, 352256
s_add_u32 m0, s41, 65536
TR 60,105,24576
TR 62,105,28672
DM 114,12,0
v_max3_f32 v120, v0, v1, v2
MM 88,64,44
TR 64,106,24576
TR 66,106,28672
v_max3_f32 v121, v3, v4, v5
MM 92,68,44
TR 68,107,24576
TR 70,107,28672
v_max3_f32 v120, v120, v6, v7
WL 8
MM 88,72,48
TR 72,108,24576
TR 74,108,28672
v_max_f32 v120, v120, v121
MM 92,76,48
TR 76,109,24576
TR 78,109,28672
DM 115,12,1024
MM 88,80,52
TR 80,110,24576
TR 82,110,28672
MM 92,84,52
WL 12
TR 84,111,24576
TR 86,111,28672
v_cmp_lt_f32 vcc, s51, v120
s_cbranch_vccnz L_tramp2_59
L_back2_59:
EX 0
EX 1
EX 2
EX 3
EX 4
EX 5
EX 6
EX 7
CV 96,0
CV 97,2
CV 98,4
CV 99,6
WB 8
s_barrier
s_mov_b32 s48, 360448
s_add_u32 m0, s41, 73728
s_nop 0
DM 114,12,0
DM 115,12,1024
MM 8,56,96
KR 56,100,0
AD 0
MM 12,60,96
KR 60,100,4096
AD 1
MM 16,64,96
KR 64,101,0
AD 2
MM 20,68,96
KR 68,101,4096
AD 3
MM 24,72,96
KR 72,102,0
AD 4
MM 28,76,96
KR 76,102,4096
AD 5
MM 32,80,96
KR 80,103,0
AD 6
MM 36,84,96
KR 84,103,4096
AD 7
s_add_u32 s43, s52, 393216
s_and_b32 s43, s43, 0x7ffff
s_add_u32 m0, s42, 114688
s_nop 0
DH 116,24,0
s_add_u32 s43, s43, 3072
DH 117,24,1024
s_add_u32 s43, s43, 3072
DH 116,24,2048
s_add_u32 s43, s43, 3072
DH 117,24,3072
s_add_u32 s43, s52, 409600
s_and_b32 s43, s43, 0x7ffff
s_add_u32 m0, s42, 131072
s_nop 0
DH 116,24,0
s_add_u32 s43, s43, 3072
DH 117,24,1024
s_add_u32 s43, s43, 3072
DH 116,24,2048
s_add_u32 s43, s43, 3072
DH 117,24,3072
s_add_u32 s43, s52, 425984
s_and_b32 s43, s43, 0x7ffff
s_add_u32 m0, s42, 147456
s_nop 0
DH 116,24,0
s_add_u32 s43, s43, 3072
DH 117,24,1024
s_add_u32 s43, s43, 3072
DH 116,24,2048
s_add_u32 s43, s43, 3072
DH 117,24,3072
s_add_u32 s43, s52, 442368
s_and_b32 s43, s43, 0x7ffff
s_add_u32 m0, s42, 98304
s_nop 0
DH 116,24,0
s_add_u32 s43, s43, 3072
DH 117,24,1024
s_add_u32 s43, s43, 3072
DH 116,24,2048
s_add_u32 s43, s43, 3072
DH 117,24,3072
WL 4
MN 0,56,40
TR 56,104,32768
TR 58,104,36864
MN 4,60,40
TR 60,105,32768
TR 62,105,36864
v_max3_f32 v120, v88, v89, v90
MM 0,64,44
TR 64,106,32768
TR 66,106,36864
v_max3_f32 v121, v91, v92, v93
MM 4,68,44
TR 68,107,32768
TR 70,107,36864
v_max3_f32 v120, v120, v94, v95
WL 8
MM 0,72,48
TR 72,108,32768
TR 74,108,36864
v_max_f32 v120, v120, v121
MM 4,76,48
TR 76,109,32768
TR 78,109,36864
MM 0,80,52
TR 80,110,32768
TR 82,110,36864
MM 4,84,52
WL 12
TR 84,111,32768
TR 86,111,36864
v_cmp_lt_f32 vcc, s51, v120
s_cbranch_vccnz L_tramp2_60
L_back2_60:
EX 88
EX 89
EX 90
EX 91
EX 92
EX 93
EX 94
EX 95
CV 96,88
CV 97,90
CV 98,92
CV 99,94
WB 22
s_barrier
MM 8,56,96
KR 56,100,8192
AD 88
MM 12,60,96
KR 60,100,12288
AD 89
MM 16,64,96
KR 64,101,8192
AD 90
MM 20,68,96
KR 68,101,12288
AD 91
MM 24,72,96
KR 72,102,8192
AD 92
MM 28,76,96
KR 76,102,12288
AD 93
MM 32,80,96
KR 80,103,8192
AD 94
MM 36,84,96
KR 84,103,12288
AD 95
s_add_u32 s43, s52, 458752
s_and_b32 s43, s43, 0x7ffff
s_add_u32 m0, s42, 32768
s_nop 0
DH 116,24,0
s_add_u32 s43, s43, 3072
DH 117,24,1024
s_add_u32 s43, s43, 3072
DH 116,24,2048
s_add_u32 s43, s43, 3072
DH 117,24,3072
s_add_u32 s43, s52, 475136
s_and_b32 s43, s43, 0x7ffff
s_add_u32 m0, s42, 81920
s_nop 0
DH 116,24,0
s_add_u32 s43, s43, 3072
DH 117,24,1024
s_add_u32 s43, s43, 3072
DH 116,24,2048
s_add_u32 s43, s43, 3072
DH 117,24,3072
WL 4
MN 88,56,40
TR 56,104,0
TR 58,104,4096
MN 92,60,40
TR 60,105,0
TR 62,105,4096
v_max3_f32 v120, v0, v1, v2
MM 88,64,44
TR 64,106,0
TR 66,106,4096
v_max3_f32 v121, v3, v4, v5
MM 92,68,44
TR 68,107,0
TR 70,107,4096
v_max3_f32 v120, v120, v6, v7
WL 8
MM 88,72,48
TR 72,108,0
TR 74,108,4096
v_max_f32 v120, v120, v121
MM 92,76,48
TR 76,109,0
TR 78,109,4096
MM 88,80,52
TR 80,110,0
TR 82,110,4096
MM 92,84,52
WL 12
TR 84,111,0
TR 86,111,4096
v_cmp_lt_f32 vcc, s51, v120
s_cbranch_vccnz L_tramp2_61
L_back2_61:
EX 0
EX 1
EX 2
EX 3
EX 4
EX 5
EX 6
EX 7
CV 96,0
CV 97,2
CV 98,4
CV 99,6
WB 26
s_barrier
MM 8,56,96
KR 56,100,16384
AD 0
MM 12,60,96
KR 60,100,20480
AD 1
MM 16,64,96
KR 64,101,16384
AD 2
MM 20,68,96
KR 68,101,20480
AD 3
MM 24,72,96
KR 72,102,16384
AD 4
MM 28,76,96
KR 76,102,20480
AD 5
MM 32,80,96
KR 80,103,16384
AD 6
MM 36,84,96
KR 84,103,20480
AD 7
s_add_u32 s43, s52, 491520
s_and_b32 s43, s43, 0x7ffff
s_add_u32 m0, s42, 49152
s_nop 0
DH 116,24,0
s_add_u32 s43, s43, 3072
DH 117,24,1024
s_add_u32 s43, s43, 3072
DH 116,24,2048
s_add_u32 s43, s43, 3072
DH 117,24,3072
s_add_u32 s43, s52, 507904
s_and_b32 s43, s43, 0x7ffff
s_add_u32 m0, s42, 0
s_nop 0
DH 116,24,0
s_add_u32 s43, s43, 3072
DH 117,24,1024
s_add_u32 s43, s43, 3072
DH 116,24,2048
s_add_u32 s43, s43, 3072
DH 117,24,3072
WL 4
MN 0,56,40
TR 56,104,8192
TR 58,104,12288
MN 4,60,40
TR 60,105,8192
TR 62,105,12288
v_max3_f32 v120, v88, v89, v90
MM 0,64,44
TR 64,106,8192
TR 66,106,12288
v_max3_f32 v121, v91, v92, v93
MM 4,68,44
TR 68,107,8192
TR 70,107,12288
v_max3_f32 v120, v120, v94, v95
WL 8
MM 0,72,48
TR 72,108,8192
TR 74,108,12288
v_max_f32 v120, v120, v121
MM 4,76,48
TR 76,109,8192
TR 78,109,12288
MM 0,80,52
TR 80,110,8192
TR 82,110,12288
MM 4,84,52
WL 12
TR 84,111,8192
TR 86,111,12288
v_cmp_lt_f32 vcc, s51, v120
s_cbranch_vccnz L_tramp2_62
L_back2_62:
EX 88
EX 89
EX 90
EX 91
EX 92
EX 93
EX 94
EX 95
CV 96,88
CV 97,90
CV 98,92
CV 99,94
WL 0
s_nop 0
MM 8,56,96
AD 88
MM 12,60,96
AD 89
MM 16,64,96
AD 90
MM 20,68,96
AD 91
MM 24,72,96
AD 92
MM 28,76,96
AD 93
MM 32,80,96
AD 94
MM 36,84,96
AD 95
v_max3_f32 v120, v0, v1, v2
v_max3_f32 v121, v3, v4, v5
v_max3_f32 v120, v120, v6, v7
v_max_f32 v120, v120, v121
v_cmp_lt_f32 vcc, s51, v120
s_cbranch_vccnz L_tramp2_63
L_back2_63:
EX 0
EX 1
EX 2
EX 3
EX 4
EX 5
EX 6
EX 7
AD 0
AD 1
AD 2
AD 3
AD 4
AD 5
AD 6
AD 7
v_mov_b32 v121, v119
s_nop 1
v_permlane32_swap_b32 v119, v121
AD 121
v_mov_b32 v121, v119
s_nop 1
v_permlane16_swap_b32 v119, v121
AD 121
v_rcp_f32 v119, v119
v_add_u32 v112, s66, v118
v_add_u32 v113, s67, v118
v_add_u32 v114, s68, v118
v_add_u32 v115, s69, v118
v_mov_b32 v124, v118
v_pk_mul_f32 v[0:1], v[0:1], v[118:119] op_sel:[0,1] op_sel_hi:[1,1]
v_pk_mul_f32 v[2:3], v[2:3], v[118:119] op_sel:[0,1] op_sel_hi:[1,1]
v_pk_mul_f32 v[4:5], v[4:5], v[118:119] op_sel:[0,1] op_sel_hi:[1,1]
v_pk_mul_f32 v[6:7], v[6:7], v[118:119] op_sel:[0,1] op_sel_hi:[1,1]
CV 96,0
CV 97,2
CV 98,4
CV 99,6
v_pk_mul_f32 v[8:9], v[8:9], v[118:119] op_sel:[0,1] op_sel_hi:[1,1]
v_pk_mul_f32 v[10:11], v[10:11], v[118:119] op_sel:[0,1] op_sel_hi:[1,1]
v_pk_mul_f32 v[12:13], v[12:13], v[118:119] op_sel:[0,1] op_sel_hi:[1,1]
v_pk_mul_f32 v[14:15], v[14:15], v[118:119] op_sel:[0,1] op_sel_hi:[1,1]
v_pk_mul_f32 v[16:17], v[16:17], v[118:119] op_sel:[0,1] op_sel_hi:[1,1]
v_pk_mul_f32 v[18:19], v[18:19], v[118:119] op_sel:[0,1] op_sel_hi:[1,1]
v_pk_mul_f32 v[20:21], v[20:21], v[118:119] op_sel:[0,1] op_sel_hi:[1,1]
v_pk_mul_f32 v[22:23], v[22:23], v[118:119] op_sel:[0,1] op_sel_hi:[1,1]
v_pk_mul_f32 v[24:25], v[24:25], v[118:119] op_sel:[0,1] op_sel_hi:[1,1]
v_pk_mul_f32 v[26:27], v[26:27], v[118:119] op_sel:[0,1] op_sel_hi:[1,1]
v_pk_mul_f32 v[28:29], v[28:29], v[118:119] op_sel:[0,1] op_sel_hi:[1,1]
v_pk_mul_f32 v[30:31], v[30:31], v[118:119] op_sel:[0,1] op_sel_hi:[1,1]
v_pk_mul_f32 v[32:33], v[32:33], v[118:119] op_sel:[0,1] op_sel_hi:[1,1]
v_pk_mul_f32 v[34:35], v[34:35], v[118:119] op_sel:[0,1] op_sel_hi:[1,1]
v_pk_mul_f32 v[36:37], v[36:37], v[118:119] op_sel:[0,1] op_sel_hi:[1,1]
v_pk_mul_f32 v[38:39], v[38:39], v[118:119] op_sel:[0,1] op_sel_hi:[1,1]
WM 32
s_barrier
TR 56,104,16384
TR 58,104,20480
TR 60,105,16384
TR 62,105,20480
TR 64,106,16384
TR 66,106,20480
TR 68,107,16384
TR 70,107,20480
TR 72,108,16384
TR 74,108,20480
TR 76,109,16384
TR 78,109,20480
TR 80,110,16384
TR 82,110,20480
WL 12
TR 84,111,16384
TR 86,111,20480
MM 8,56,96
WL 12
MM 12,60,96
WL 10
MM 16,64,96
WL 8
MM 20,68,96
WL 6
MM 24,72,96
WL 4
MM 28,76,96
WL 2
MM 32,80,96
WL 0
MM 36,84,96
CV 72,8
CV 73,10
CV 74,12
CV 75,14
ds_write_b128 v112, v[72:75] offset:0
CV 76,16
CV 77,18
CV 78,20
CV 79,22
ds_write_b128 v112, v[76:79] offset:1024
CV 80,24
CV 81,26
CV 82,28
CV 83,30
ds_write_b128 v112, v[80:83] offset:2048
CV 84,32
CV 85,34
CV 86,36
CV 87,38
ds_write_b128 v112, v[84:87] offset:3072
MZ 8,128,72
v_add_u32 v104, s42, v104
MZ 12,132,72
v_add_u32 v105, s42, v105
MZ 16,136,72
v_add_u32 v106, s42, v106
MZ 20,140,72
v_add_u32 v107, s42, v107
MM 8,160,76
v_add_u32 v108, s42, v108
MM 12,164,76
v_add_u32 v109, s42, v109
MM 16,168,76
v_add_u32 v110, s42, v110
MM 20,172,76
v_add_u32 v111, s42, v111
WL 0
s_barrier
KR 40,113,0
KR 44,113,1024
KR 48,113,2048
KR 52,113,3072
KR 56,114,0
KR 60,114,1024
KR 64,114,2048
KR 68,114,3072
KR 88,115,0
KR 92,115,1024
KR 96,115,2048
KR 100,115,3072
MM 8,192,80
v_subrev_u32 v0, 57344, v104
MM 12,196,80
v_subrev_u32 v1, 57344, v105
MM 16,200,80
v_subrev_u32 v2, 57344, v106
MM 20,204,80
v_subrev_u32 v3, 57344, v107
MM 8,224,84
v_subrev_u32 v4, 57344, v108
MM 12,228,84
v_subrev_u32 v5, 57344, v109
MM 16,232,84
v_subrev_u32 v6, 57344, v110
MM 20,236,84
v_subrev_u32 v7, 57344, v111
MZ 24,144,72
v_add_u32 v116, 57344, v104
MZ 28,148,72
v_add_u32 v117, 57344, v105
MZ 32,152,72
v_add_u32 v118, 57344, v106
MZ 36,156,72
v_add_u32 v119, 57344, v107
MM 24,176,76
v_add_u32 v120, 57344, v108
MM 28,180,76
v_add_u32 v121, 57344, v109
MM 32,184,76
v_add_u32 v122, 57344, v110
MM 36,188,76
v_add_u32 v123, 57344, v111
MM 24,208,80
v_mov_b32 v112, s53
MM 28,212,80
v_and_b32 v113, 0xf0, v124
v_lshlrev_b32 v113, 6, v113
MM 32,216,80
v_lshrrev_b32 v114, 8, v124
v_lshl_add_u32 v113, v114, 3, v113
MM 36,220,80
v_cmp_eq_u32 vcc, 0, v124
v_mov_b32 v114, 0x20000000
s_nop 0
v_cndmask_b32 v115, v114, 0, vcc
MM 24,240,84
s_mov_b32 s55, 0
MM 28,244,84
s_mov_b32 s56, 0
MM 32,248,84
MM 36,252,84
WL 11
MA 8,0,40
WM 28
TR 128,116,0
MA 12,4,40
TR 132,117,0
MA 16,8,40
TR 136,118,0
MA 20,12,40
WL 13
TR 140,119,0
MA 8,32,44
WM 24
WL 13
TR 130,116,16384
MA 12,36,44
WL 13
TR 134,117,16384
MA 16,40,44
WL 13
TR 138,118,16384
MA 20,44,44
WL 13
TR 142,119,16384
MA 8,64,48
WM 20
WL 13
TR 160,116,32768
MA 12,68,48
WL 13
TR 164,117,32768
MA 16,72,48
WL 13
TR 168,118,32768
MA 20,76,48
WL 13
TR 172,119,32768
MA 8,96,52
WM 16
WL 13
TR 162,104,40960
MA 12,100,52
WL 13
TR 166,105,40960
MA 16,104,52
WL 13
TR 170,106,40960
MA 20,108,52
WL 13
TR 174,107,40960
MA 8,128,56
WM 12
WL 13
TR 192,0,32768
MA 12,132,56
WL 13
TR 196,1,32768
MA 16,136,56
WL 13
TR 200,2,32768
MA 20,140,56
WL 13
TR 204,3,32768
MA 8,160,60
WM 8
WL 13
TR 194,104,24576
MA 12,164,60
WL 13
TR 198,105,24576
MA 16,168,60
WL 13
TR 202,106,24576
MA 20,172,60
WL 13
TR 206,107,24576
MA 8,192,64
WM 4
WL 13
TR 224,0,49152
MA 12,196,64
WL 13
TR 228,1,49152
MA 16,200,64
WL 13
TR 232,2,49152
MA 20,204,64
WL 13
TR 236,3,49152
MA 8,224,68
WM 0
WL 13
TR 226,0,0
MA 12,228,68
WL 13
TR 230,1,0
MA 16,232,68
WL 13
TR 234,2,0
MA 20,236,68
WL 13
TR 238,3,0
MM 8,128,88
WL 13
TR 152,122,0
MM 12,132,88
WL 13
TR 156,123,0
MM 16,136,88
WL 13
TR 154,122,16384
MM 20,140,88
WL 13
TR 158,123,16384
MM 8,160,92
WL 13
TR 184,122,32768
MM 12,164,92
WL 13
TR 188,123,32768
MM 16,168,92
WL 13
TR 186,110,40960
MM 20,172,92
WL 13
TR 190,111,40960
MM 8,192,96
WL 13
TR 216,6,32768
MM 12,196,96
WL 13
TR 220,7,32768
MM 16,200,96
WL 13
TR 218,110,24576
MM 20,204,96
WL 13
TR 222,111,24576
MM 8,224,100
WL 13
TR 248,6,49152
MM 12,228,100
WL 13
TR 252,7,49152
MM 16,232,100
WL 13
TR 250,6,0
MM 20,236,100
WL 13
TR 254,7,0
MA 32,24,40
WL 13
TR 144,120,0
MA 36,28,40
WL 13
TR 148,121,0
MA 32,56,44
WL 13
TR 146,120,16384
MA 36,60,44
WL 13
TR 150,121,16384
MA 32,88,48
WL 13
TR 176,120,32768
MA 36,92,48
WL 13
TR 180,121,32768
CV 8,8
CV 9,10
CV 10,12
v_mov_b32 v11, v112
buffer_store_dwordx4 v[8:11], v124, s[28:31], s70 offen offset:0 sc1
MA 32,120,52
WL 13
TR 178,108,40960
MA 36,124,52
WL 13
TR 182,109,40960
MA 32,152,56
WL 13
TR 208,4,32768
CV 12,14
CV 13,16
CV 14,18
v_mov_b32 v15, v112
buffer_store_dwordx4 v[12:15], v124, s[28:31], s70 offen offset:1024 sc1
MA 36,156,56
WL 13
TR 212,5,32768
MA 32,184,60
WL 13
TR 210,108,24576
MA 36,188,60
WL 13
TR 214,109,24576
CV 16,20
CV 17,22
v_mov_b32 v18, v112
v_mov_b32 v19, v112
buffer_store_dwordx4 v[16:19], v124, s[28:31], s70 offen offset:2048 sc1
MA 32,216,64
WL 13
TR 240,4,49152
MA 36,220,64
WL 13
TR 244,5,49152
MA 32,248,68
WL 13
TR 242,4,0
MA 36,252,68
WL 13
TR 246,5,0
MM 32,152,88
MM 36,156,88
MM 32,184,92
MM 36,188,92
MM 32,216,96
MM 36,220,96
MM 32,248,100
MM 36,252,100
MA 24,16,40
MA 28,20,40
MA 24,48,44
MA 28,52,44
MA 24,80,48
MA 28,84,48
s_nop 3
CV 16,36
CV 17,38
buffer_store_dwordx4 v[16:19], v124, s[28:31], s71 offen offset:2048 sc1
MA 24,112,52
MA 28,116,52
MA 24,144,56
MA 28,148,56
MA 24,176,60
MA 28,180,60
MA 24,208,64
MA 28,212,64
MA 24,240,68
MA 28,244,68
WL 13
MM 24,144,88
WL 12
MM 28,148,88
WL 9
MM 24,176,92
WL 8
MM 28,180,92
WL 5
MM 24,208,96
WL 4
MM 28,212,96
WL 1
MM 24,240,100
WL 0
MM 28,244,100
s_nop 7
CV 8,24
CV 9,26
CV 10,28
buffer_store_dwordx4 v[8:11], v124, s[28:31], s71 offen offset:0 sc1
CV 12,30
CV 13,32
CV 14,34
buffer_store_dwordx4 v[12:15], v124, s[28:31], s71 offen offset:1024 sc1
s_cmp_eq_u32 s36, 3
s_cbranch_scc1 L_fin2
L_opoll2:
s_bitcmp1_b32 s56, 0
s_cbranch_scc1 L_sk2_0
s_add_u32 s47, s72, 0
buffer_load_dwordx4 v[56:59], v124, s[28:31], s47 offen sc1
L_sk2_0:
s_bitcmp1_b32 s56, 1
s_cbranch_scc1 L_sk2_1
s_add_u32 s47, s72, 4096
buffer_load_dwordx4 v[60:63], v124, s[28:31], s47 offen sc1
L_sk2_1:
s_bitcmp1_b32 s56, 2
s_cbranch_scc1 L_sk2_2
s_add_u32 s47, s72, 8192
buffer_load_dwordx4 v[64:67], v124, s[28:31], s47 offen sc1
L_sk2_2:
s_bitcmp1_b32 s56, 3
s_cbranch_scc1 L_sk2_3
s_add_u32 s47, s72, 12288
buffer_load_dwordx4 v[68:71], v124, s[28:31], s47 offen sc1
L_sk2_3:
s_bitcmp1_b32 s56, 4
s_cbranch_scc1 L_sk2_4
s_add_u32 s47, s72, 16384
buffer_load_dwordx4 v[72:75], v124, s[28:31], s47 offen sc1
L_sk2_4:
s_bitcmp1_b32 s56, 5
s_cbranch_scc1 L_sk2_5
s_add_u32 s47, s72, 20480
buffer_load_dwordx4 v[76:79], v124, s[28:31], s47 offen sc1
L_sk2_5:
s_bitcmp1_b32 s56, 6
s_cbranch_scc1 L_sk2_6
s_add_u32 s47, s72, 24576
buffer_load_dwordx4 v[80:83], v124, s[28:31], s47 offen sc1
L_sk2_6:
s_bitcmp1_b32 s56, 7
s_cbranch_scc1 L_sk2_7
s_add_u32 s47, s72, 28672
buffer_load_dwordx4 v[84:87], v124, s[28:31], s47 offen sc1
L_sk2_7:
WM 0
L_chk2:
v_cmp_ne_u32 vcc, s53, v59
s_cbranch_vccnz L_sc2_0
s_bitset1_b32 s56, 0
L_sc2_0:
v_cmp_ne_u32 vcc, s53, v63
s_cbranch_vccnz L_sc2_1
s_bitset1_b32 s56, 1
L_sc2_1:
v_cmp_ne_u32 vcc, s53, v67
s_cbranch_vccnz L_sc2_2
s_bitset1_b32 s56, 2
L_sc2_2:
v_cmp_ne_u32 vcc, s53, v71
s_cbranch_vccnz L_sc2_3
s_bitset1_b32 s56, 3
L_sc2_3:
v_cmp_ne_u32 vcc, s53, v75
s_cbranch_vccnz L_sc2_4
s_bitset1_b32 s56, 4
L_sc2_4:
v_cmp_ne_u32 vcc, s53, v79
s_cbranch_vccnz L_sc2_5
s_bitset1_b32 s56, 5
L_sc2_5:
v_cmp_ne_u32 vcc, s53, v83
s_cbranch_vccnz L_sc2_6
s_bitset1_b32 s56, 6
L_sc2_6:
v_cmp_ne_u32 vcc, s53, v87
s_cbranch_vccnz L_sc2_7
s_bitset1_b32 s56, 7
L_sc2_7:
s_cmp_lg_u32 s56, 0xff
s_cbranch_scc1 L_oretry2
L_ook2:
v_lshlrev_b32 v8, 16, v56
v_and_b32 v9, 0xffff0000, v56
v_lshlrev_b32 v18, 16, v60
v_and_b32 v19, 0xffff0000, v60
v_pk_add_f32 v[8:9], v[8:9], v[18:19]
v_lshlrev_b32 v16, 16, v64
v_and_b32 v17, 0xffff0000, v64
v_pk_add_f32 v[8:9], v[8:9], v[16:17]
v_lshlrev_b32 v18, 16, v68
v_and_b32 v19, 0xffff0000, v68
v_pk_add_f32 v[8:9], v[8:9], v[18:19]
v_lshlrev_b32 v16, 16, v72
v_and_b32 v17, 0xffff0000, v72
v_pk_add_f32 v[8:9], v[8:9], v[16:17]
v_lshlrev_b32 v18, 16, v76
v_and_b32 v19, 0xffff0000, v76
v_pk_add_f32 v[8:9], v[8:9], v[18:19]
v_lshlrev_b32 v16, 16, v80
v_and_b32 v17, 0xffff0000, v80
v_pk_add_f32 v[8:9], v[8:9], v[16:17]
v_lshlrev_b32 v18, 16, v84
v_and_b32 v19, 0xffff0000, v84
v_pk_add_f32 v[8:9], v[8:9], v[18:19]
CV 88,8
buffer_store_dword v88, v113, s[32:35], s73 offen
v_lshlrev_b32 v10, 16, v57
v_and_b32 v11, 0xffff0000, v57
v_lshlrev_b32 v18, 16, v61
v_and_b32 v19, 0xffff0000, v61
v_pk_add_f32 v[10:11], v[10:11], v[18:19]
v_lshlrev_b32 v16, 16, v65
v_and_b32 v17, 0xffff0000, v65
v_pk_add_f32 v[10:11], v[10:11], v[16:17]
v_lshlrev_b32 v18, 16, v69
v_and_b32 v19, 0xffff0000, v69
v_pk_add_f32 v[10:11], v[10:11], v[18:19]
v_lshlrev_b32 v16, 16, v73
v_and_b32 v17, 0xffff0000, v73
v_pk_add_f32 v[10:11], v[10:11], v[16:17]
v_lshlrev_b32 v18, 16, v77
v_and_b32 v19, 0xffff0000, v77
v_pk_add_f32 v[10:11], v[10:11], v[18:19]
v_lshlrev_b32 v16, 16, v81
v_and_b32 v17, 0xffff0000, v81
v_pk_add_f32 v[10:11], v[10:11], v[16:17]
v_lshlrev_b32 v18, 16, v85
v_and_b32 v19, 0xffff0000, v85
v_pk_add_f32 v[10:11], v[10:11], v[18:19]
CV 89,10
buffer_store_dword v89, v113, s[32:35], s74 offen
v_lshlrev_b32 v12, 16, v58
v_and_b32 v13, 0xffff0000, v58
v_lshlrev_b32 v18, 16, v62
v_and_b32 v19, 0xffff0000, v62
v_pk_add_f32 v[12:13], v[12:13], v[18:19]
v_lshlrev_b32 v16, 16, v66
v_and_b32 v17, 0xffff0000, v66
v_pk_add_f32 v[12:13], v[12:13], v[16:17]
v_lshlrev_b32 v18, 16, v70
v_and_b32 v19, 0xffff0000, v70
v_pk_add_f32 v[12:13], v[12:13], v[18:19]
v_lshlrev_b32 v16, 16, v74
v_and_b32 v17, 0xffff0000, v74
v_pk_add_f32 v[12:13], v[12:13], v[16:17]
v_lshlrev_b32 v18, 16, v78
v_and_b32 v19, 0xffff0000, v78
v_pk_add_f32 v[12:13], v[12:13], v[18:19]
v_lshlrev_b32 v16, 16, v82
v_and_b32 v17, 0xffff0000, v82
v_pk_add_f32 v[12:13], v[12:13], v[16:17]
v_lshlrev_b32 v18, 16, v86
v_and_b32 v19, 0xffff0000, v86
v_pk_add_f32 v[12:13], v[12:13], v[18:19]
CV 90,12
buffer_store_dword v90, v113, s[32:35], s75 offen
s_or_b32 s43, s37, s36
s_cmp_eq_u32 s43, 0
s_cselect_b32 s43, s57, 0x20000000
s_add_u32 s44, s49, 1
v_mov_b32 v114, s44
buffer_store_dword v114, v115, s[28:31], s43 offen sc1
L_fin2:
s_endpgm
L_oretry2:
s_add_u32 s55, s55, 1
s_cmp_gt_u32 s55, 0x40000
s_cbranch_scc1 L_ook2
s_branch L_opoll2
L_tramp2_1:
s_swappc_b64 s[60:61], s[64:65]
s_branch L_back2_1
L_tramp2_2:
s_swappc_b64 s[60:61], s[58:59]
s_branch L_back2_2
L_tramp2_3:
s_swappc_b64 s[60:61], s[64:65]
s_branch L_back2_3
L_tramp2_4:
s_swappc_b64 s[60:61], s[58:59]
s_branch L_back2_4
L_tramp2_5:
s_swappc_b64 s[60:61], s[64:65]
s_branch L_back2_5
L_tramp2_6:
s_swappc_b64 s[60:61], s[58:59]
s_branch L_back2_6
L_tramp2_7:
s_swappc_b64 s[60:61], s[64:65]
s_branch L_back2_7
L_tramp2_8:
s_swappc_b64 s[60:61], s[58:59]
s_branch L_back2_8
L_tramp2_9:
s_swappc_b64 s[60:61], s[64:65]
s_branch L_back2_9
L_tramp2_10:
s_swappc_b64 s[60:61], s[58:59]
s_branch L_back2_10
L_tramp2_11:
s_swappc_b64 s[60:61], s[64:65]
s_branch L_back2_11
L_tramp2_12:
s_swappc_b64 s[60:61], s[58:59]
s_branch L_back2_12
L_tramp2_13:
s_swappc_b64 s[60:61], s[64:65]
s_branch L_back2_13
L_tramp2_14:
s_swappc_b64 s[60:61], s[58:59]
s_branch L_back2_14
L_tramp2_15:
s_swappc_b64 s[60:61], s[64:65]
s_branch L_back2_15
L_tramp2_16:
s_swappc_b64 s[60:61], s[58:59]
s_branch L_back2_16
L_tramp2_17:
s_swappc_b64 s[60:61], s[64:65]
s_branch L_back2_17
L_tramp2_18:
s_swappc_b64 s[60:61], s[58:59]
s_branch L_back2_18
L_tramp2_19:
s_swappc_b64 s[60:61], s[64:65]
s_branch L_back2_19
L_tramp2_20:
s_swappc_b64 s[60:61], s[58:59]
s_branch L_back2_20
L_tramp2_21:
s_swappc_b64 s[60:61], s[64:65]
s_branch L_back2_21
L_tramp2_22:
s_swappc_b64 s[60:61], s[58:59]
s_branch L_back2_22
L_tramp2_23:
s_swappc_b64 s[60:61], s[64:65]
s_branch L_back2_23
L_tramp2_24:
s_swappc_b64 s[60:61], s[58:59]
s_branch L_back2_24
L_tramp2_25:
s_swappc_b64 s[60:61], s[64:65]
s_branch L_back2_25
L_tramp2_26:
s_swappc_b64 s[60:61], s[58:59]
s_branch L_back2_26
L_tramp2_27:
s_swappc_b64 s[60:61], s[64:65]
s_branch L_back2_27
L_tramp2_28:
s_swappc_b64 s[60:61], s[58:59]
s_branch L_back2_28
L_tramp2_29:
s_swappc_b64 s[60:61], s[64:65]
s_branch L_back2_29
L_tramp2_30:
s_swappc_b64 s[60:61], s[58:59]
s_branch L_back2_30
L_tramp2_31:
s_swappc_b64 s[60:61], s[64:65]
s_branch L_back2_31
L_tramp2_32:
s_swappc_b64 s[60:61], s[58:59]
s_branch L_back2_32
L_tramp2_33:
s_swappc_b64 s[60:61], s[64:65]
s_branch L_back2_33
L_tramp2_34:
s_swappc_b64 s[60:61], s[58:59]
s_branch L_back2_34
L_tramp2_35:
s_swappc_b64 s[60:61], s[64:65]
s_branch L_back2_35
L_tramp2_36:
s_swappc_b64 s[60:61], s[58:59]
s_branch L_back2_36
L_tramp2_37:
s_swappc_b64 s[60:61], s[64:65]
s_branch L_back2_37
L_tramp2_38:
s_swappc_b64 s[60:61], s[58:59]
s_branch L_back2_38
L_tramp2_39:
s_swappc_b64 s[60:61], s[64:65]
s_branch L_back2_39
L_tramp2_40:
s_swappc_b64 s[60:61], s[58:59]
s_branch L_back2_40
L_tramp2_41:
s_swappc_b64 s[60:61], s[64:65]
s_branch L_back2_41
L_tramp2_42:
s_swappc_b64 s[60:61], s[58:59]
s_branch L_back2_42
L_tramp2_43:
s_swappc_b64 s[60:61], s[64:65]
s_branch L_back2_43
L_tramp2_44:
s_swappc_b64 s[60:61], s[58:59]
s_branch L_back2_44
L_tramp2_45:
s_swappc_b64 s[60:61], s[64:65]
s_branch L_back2_45
L_tramp2_46:
s_swappc_b64 s[60:61], s[58:59]
s_branch L_back2_46
L_tramp2_47:
s_swappc_b64 s[60:61], s[64:65]
s_branch L_back2_47
L_tramp2_48:
s_swappc_b64 s[60:61], s[58:59]
s_branch L_back2_48
L_tramp2_49:
s_swappc_b64 s[60:61], s[64:65]
s_branch L_back2_49
L_tramp2_50:
s_swappc_b64 s[60:61], s[58:59]
s_branch L_back2_50
L_tramp2_51:
s_swappc_b64 s[60:61], s[64:65]
s_branch L_back2_51
L_tramp2_52:
s_swappc_b64 s[60:61], s[58:59]
s_branch L_back2_52
L_tramp2_53:
s_swappc_b64 s[60:61], s[64:65]
s_branch L_back2_53
L_tramp2_54:
s_swappc_b64 s[60:61], s[58:59]
s_branch L_back2_54
L_tramp2_55:
s_swappc_b64 s[60:61], s[64:65]
s_branch L_back2_55
L_tramp2_56:
s_swappc_b64 s[60:61], s[58:59]
s_branch L_back2_56
L_tramp2_57:
s_swappc_b64 s[60:61], s[64:65]
s_branch L_back2_57
L_tramp2_58:
s_swappc_b64 s[60:61], s[58:59]
s_branch L_back2_58
L_tramp2_59:
s_swappc_b64 s[60:61], s[64:65]
s_branch L_back2_59
L_tramp2_60:
s_swappc_b64 s[60:61], s[58:59]
s_branch L_back2_60
L_tramp2_61:
s_swappc_b64 s[60:61], s[64:65]
s_branch L_back2_61
L_tramp2_62:
s_swappc_b64 s[60:61], s[58:59]
s_branch L_back2_62
L_tramp2_63:
s_swappc_b64 s[60:61], s[64:65]
s_branch L_back2_63
L_btramp2_52_0:
s_swappc_b64 s[60:61], s[4:5]
s_branch L_bback2_52_0
L_btramp2_54_0:
s_swappc_b64 s[60:61], s[4:5]
s_branch L_bback2_54_0
L_btramp2_56_0:
s_swappc_b64 s[60:61], s[4:5]
s_branch L_bback2_56_0
L_slow0:
s_nop 15
v_mov_b32 v121, v120
s_nop 1
v_permlane32_swap_b32 v120, v121
v_max_f32 v120, v120, v121
v_mov_b32 v121, v120
s_nop 1
v_permlane16_swap_b32 v120, v121
v_max3_f32 v120, v120, v121, 0
v_exp_f32 v121, -v120
v_sub_f32 v124, v124, v120
v_sub_f32 v125, v125, v120
v_sub_f32 v126, v126, v120
v_sub_f32 v127, v127, v120
v_sub_f32 v88, v88, v120
v_sub_f32 v89, v89, v120
v_sub_f32 v90, v90, v120
v_sub_f32 v91, v91, v120
v_sub_f32 v92, v92, v120
v_sub_f32 v93, v93, v120
v_sub_f32 v94, v94, v120
v_sub_f32 v95, v95, v120
v_sub_f32 v0, v0, v120
v_sub_f32 v1, v1, v120
v_sub_f32 v2, v2, v120
v_sub_f32 v3, v3, v120
v_sub_f32 v4, v4, v120
v_sub_f32 v5, v5, v120
v_sub_f32 v6, v6, v120
v_sub_f32 v7, v7, v120
v_mul_f32 v119, v119, v121
v_mul_f32 v8, v8, v121
v_mul_f32 v9, v9, v121
v_mul_f32 v10, v10, v121
v_mul_f32 v11, v11, v121
v_mul_f32 v12, v12, v121
v_mul_f32 v13, v13, v121
v_mul_f32 v14, v14, v121
v_mul_f32 v15, v15, v121
v_mul_f32 v16, v16, v121
v_mul_f32 v17, v17, v121
v_mul_f32 v18, v18, v121
v_mul_f32 v19, v19, v121
v_mul_f32 v20, v20, v121
v_mul_f32 v21, v21, v121
v_mul_f32 v22, v22, v121
v_mul_f32 v23, v23, v121
v_mul_f32 v24, v24, v121
v_mul_f32 v25, v25, v121
v_mul_f32 v26, v26, v121
v_mul_f32 v27, v27, v121
v_mul_f32 v28, v28, v121
v_mul_f32 v29, v29, v121
v_mul_f32 v30, v30, v121
v_mul_f32 v31, v31, v121
v_mul_f32 v32, v32, v121
v_mul_f32 v33, v33, v121
v_mul_f32 v34, v34, v121
v_mul_f32 v35, v35, v121
v_mul_f32 v36, v36, v121
v_mul_f32 v37, v37, v121
v_mul_f32 v38, v38, v121
v_mul_f32 v39, v39, v121
s_nop 1
s_setpc_b64 s[60:61]
L_slow1:
s_nop 15
v_mov_b32 v121, v120
s_nop 1
v_permlane32_swap_b32 v120, v121
v_max_f32 v120, v120, v121
v_mov_b32 v121, v120
s_nop 1
v_permlane16_swap_b32 v120, v121
v_max3_f32 v120, v120, v121, 0
v_exp_f32 v121, -v120
v_sub_f32 v124, v124, v120
v_sub_f32 v125, v125, v120
v_sub_f32 v126, v126, v120
v_sub_f32 v127, v127, v120
v_sub_f32 v0, v0, v120
v_sub_f32 v1, v1, v120
v_sub_f32 v2, v2, v120
v_sub_f32 v3, v3, v120
v_sub_f32 v4, v4, v120
v_sub_f32 v5, v5, v120
v_sub_f32 v6, v6, v120
v_sub_f32 v7, v7, v120
v_sub_f32 v88, v88, v120
v_sub_f32 v89, v89, v120
v_sub_f32 v90, v90, v120
v_sub_f32 v91, v91, v120
v_sub_f32 v92, v92, v120
v_sub_f32 v93, v93, v120
v_sub_f32 v94, v94, v120
v_sub_f32 v95, v95, v120
v_mul_f32 v119, v119, v121
v_mul_f32 v8, v8, v121
v_mul_f32 v9, v9, v121
v_mul_f32 v10, v10, v121
v_mul_f32 v11, v11, v121
v_mul_f32 v12, v12, v121
v_mul_f32 v13, v13, v121
v_mul_f32 v14, v14, v121
v_mul_f32 v15, v15, v121
v_mul_f32 v16, v16, v121
v_mul_f32 v17, v17, v121
v_mul_f32 v18, v18, v121
v_mul_f32 v19, v19, v121
v_mul_f32 v20, v20, v121
v_mul_f32 v21, v21, v121
v_mul_f32 v22, v22, v121
v_mul_f32 v23, v23, v121
v_mul_f32 v24, v24, v121
v_mul_f32 v25, v25, v121
v_mul_f32 v26, v26, v121
v_mul_f32 v27, v27, v121
v_mul_f32 v28, v28, v121
v_mul_f32 v29, v29, v121
v_mul_f32 v30, v30, v121
v_mul_f32 v31, v31, v121
v_mul_f32 v32, v32, v121
v_mul_f32 v33, v33, v121
v_mul_f32 v34, v34, v121
v_mul_f32 v35, v35, v121
v_mul_f32 v36, v36, v121
v_mul_f32 v37, v37, v121
v_mul_f32 v38, v38, v121
v_mul_f32 v39, v39, v121
s_nop 1
s_setpc_b64 s[60:61]
L_burst:
s_add_u32 s43, s52, 0
s_and_b32 s43, s43, 0x7ffff
s_add_u32 m0, s42, 98304
s_nop 0
DH 116,24,0
s_add_u32 s43, s43, 3072
DH 117,24,1024
s_add_u32 s43, s43, 3072
DH 116,24,2048
s_add_u32 s43, s43, 3072
DH 117,24,3072
s_add_u32 s43, s52, 16384
s_and_b32 s43, s43, 0x7ffff
s_add_u32 m0, s42, 114688
s_nop 0
DH 116,24,0
s_add_u32 s43, s43, 3072
DH 117,24,1024
s_add_u32 s43, s43, 3072
DH 116,24,2048
s_add_u32 s43, s43, 3072
DH 117,24,3072
s_add_u32 s43, s52, 32768
s_and_b32 s43, s43, 0x7ffff
s_add_u32 m0, s42, 131072
s_nop 0
DH 116,24,0
s_add_u32 s43, s43, 3072
DH 117,24,1024
s_add_u32 s43, s43, 3072
DH 116,24,2048
s_add_u32 s43, s43, 3072
DH 117,24,3072
s_add_u32 s43, s52, 49152
s_and_b32 s43, s43, 0x7ffff
s_add_u32 m0, s42, 147456
s_nop 0
DH 116,24,0
s_add_u32 s43, s43, 3072
DH 117,24,1024
s_add_u32 s43, s43, 3072
DH 116,24,2048
s_add_u32 s43, s43, 3072
DH 117,24,3072
s_add_u32 s43, s42, 40960
v_add_u32 v120, s43, v104
v_add_u32 v121, s43, v105
v_add_u32 v122, s43, v106
v_add_u32 v123, s43, v107
v_add_u32 v96, s43, v108
v_add_u32 v97, s43, v109
v_add_u32 v98, s43, v110
v_add_u32 v99, s43, v111
WL 0
WM 12
ds_read_b64_tr_b16 a[0:1], v120 offset:0
ds_read_b64_tr_b16 a[4:5], v121 offset:0
ds_read_b64_tr_b16 a[8:9], v122 offset:0
ds_read_b64_tr_b16 a[12:13], v123 offset:0
ds_read_b64_tr_b16 a[16:17], v96 offset:0
ds_read_b64_tr_b16 a[20:21], v97 offset:0
ds_read_b64_tr_b16 a[24:25], v98 offset:0
ds_read_b64_tr_b16 a[28:29], v99 offset:0
WM 8
WL 0
ds_read_b64_tr_b16 a[2:3], v120 offset:16384
ds_read_b64_tr_b16 a[6:7], v121 offset:16384
ds_read_b64_tr_b16 a[10:11], v122 offset:16384
ds_read_b64_tr_b16 a[14:15], v123 offset:16384
ds_read_b64_tr_b16 a[18:19], v96 offset:16384
ds_read_b64_tr_b16 a[22:23], v97 offset:16384
ds_read_b64_tr_b16 a[26:27], v98 offset:16384
ds_read_b64_tr_b16 a[30:31], v99 offset:16384
s_add_u32 s43, s52, 65536
s_and_b32 s43, s43, 0x7ffff
s_add_u32 m0, s42, 98304
s_nop 0
DH 116,24,0
s_add_u32 s43, s43, 3072
DH 117,24,1024
s_add_u32 s43, s43, 3072
DH 116,24,2048
s_add_u32 s43, s43, 3072
DH 117,24,3072
WM 8
WL 0
ds_read_b64_tr_b16 a[32:33], v120 offset:32768
ds_read_b64_tr_b16 a[36:37], v121 offset:32768
ds_read_b64_tr_b16 a[40:41], v122 offset:32768
ds_read_b64_tr_b16 a[44:45], v123 offset:32768
ds_read_b64_tr_b16 a[48:49], v96 offset:32768
ds_read_b64_tr_b16 a[52:53], v97 offset:32768
ds_read_b64_tr_b16 a[56:57], v98 offset:32768
ds_read_b64_tr_b16 a[60:61], v99 offset:32768
s_add_u32 s43, s52, 81920
s_and_b32 s43, s43, 0x7ffff
s_add_u32 m0, s42, 114688
s_nop 0
DH 116,24,0
s_add_u32 s43, s43, 3072
DH 117,24,1024
s_add_u32 s43, s43, 3072
DH 116,24,2048
s_add_u32 s43, s43, 3072
DH 117,24,3072
WM 8
WL 0
ds_read_b64_tr_b16 a[34:35], v120 offset:49152
ds_read_b64_tr_b16 a[38:39], v121 offset:49152
ds_read_b64_tr_b16 a[42:43], v122 offset:49152
ds_read_b64_tr_b16 a[46:47], v123 offset:49152
ds_read_b64_tr_b16 a[50:51], v96 offset:49152
ds_read_b64_tr_b16 a[54:55], v97 offset:49152
ds_read_b64_tr_b16 a[58:59], v98 offset:49152
ds_read_b64_tr_b16 a[62:63], v99 offset:49152
s_add_u32 s43, s52, 98304
s_and_b32 s43, s43, 0x7ffff
s_add_u32 m0, s42, 131072
s_nop 0
DH 116,24,0
s_add_u32 s43, s43, 3072
DH 117,24,1024
s_add_u32 s43, s43, 3072
DH 116,24,2048
s_add_u32 s43, s43, 3072
DH 117,24,3072
WM 8
WL 0
ds_read_b64_tr_b16 a[64:65], v120 offset:0
ds_read_b64_tr_b16 a[68:69], v121 offset:0
ds_read_b64_tr_b16 a[72:73], v122 offset:0
ds_read_b64_tr_b16 a[76:77], v123 offset:0
ds_read_b64_tr_b16 a[80:81], v96 offset:0
ds_read_b64_tr_b16 a[84:85], v97 offset:0
ds_read_b64_tr_b16 a[88:89], v98 offset:0
ds_read_b64_tr_b16 a[92:93], v99 offset:0
s_add_u32 s43, s52, 114688
s_and_b32 s43, s43, 0x7ffff
s_add_u32 m0, s42, 147456
s_nop 0
DH 116,24,0
s_add_u32 s43, s43, 3072
DH 117,24,1024
s_add_u32 s43, s43, 3072
DH 116,24,2048
s_add_u32 s43, s43, 3072
DH 117,24,3072
WM 8
WL 0
ds_read_b64_tr_b16 a[66:67], v120 offset:16384
ds_read_b64_tr_b16 a[70:71], v121 offset:16384
ds_read_b64_tr_b16 a[74:75], v122 offset:16384
ds_read_b64_tr_b16 a[78:79], v123 offset:16384
ds_read_b64_tr_b16 a[82:83], v96 offset:16384
ds_read_b64_tr_b16 a[86:87], v97 offset:16384
ds_read_b64_tr_b16 a[90:91], v98 offset:16384
ds_read_b64_tr_b16 a[94:95], v99 offset:16384
s_add_u32 s43, s52, 131072
s_and_b32 s43, s43, 0x7ffff
s_add_u32 m0, s42, 98304
s_nop 0
DH 116,24,0
s_add_u32 s43, s43, 3072
DH 117,24,1024
s_add_u32 s43, s43, 3072
DH 116,24,2048
s_add_u32 s43, s43, 3072
DH 117,24,3072
WM 8
WL 0
ds_read_b64_tr_b16 a[96:97], v120 offset:32768
ds_read_b64_tr_b16 a[100:101], v121 offset:32768
ds_read_b64_tr_b16 a[104:105], v122 offset:32768
ds_read_b64_tr_b16 a[108:109], v123 offset:32768
ds_read_b64_tr_b16 a[112:113], v96 offset:32768
ds_read_b64_tr_b16 a[116:117], v97 offset:32768
ds_read_b64_tr_b16 a[120:121], v98 offset:32768
ds_read_b64_tr_b16 a[124:125], v99 offset:32768
s_add_u32 s43, s52, 147456
s_and_b32 s43, s43, 0x7ffff
s_add_u32 m0, s42, 114688
s_nop 0
DH 116,24,0
s_add_u32 s43, s43, 3072
DH 117,24,1024
s_add_u32 s43, s43, 3072
DH 116,24,2048
s_add_u32 s43, s43, 3072
DH 117,24,3072
WM 8
WL 0
ds_read_b64_tr_b16 a[98:99], v120 offset:49152
ds_read_b64_tr_b16 a[102:103], v121 offset:49152
ds_read_b64_tr_b16 a[106:107], v122 offset:49152
ds_read_b64_tr_b16 a[110:111], v123 offset:49152
ds_read_b64_tr_b16 a[114:115], v96 offset:49152
ds_read_b64_tr_b16 a[118:119], v97 offset:49152
ds_read_b64_tr_b16 a[122:123], v98 offset:49152
ds_read_b64_tr_b16 a[126:127], v99 offset:49152
s_add_u32 s43, s52, 163840
s_and_b32 s43, s43, 0x7ffff
s_add_u32 m0, s42, 131072
s_nop 0
DH 116,24,0
s_add_u32 s43, s43, 3072
DH 117,24,1024
s_add_u32 s43, s43, 3072
DH 116,24,2048
s_add_u32 s43, s43, 3072
DH 117,24,3072
WM 8
WL 0
ds_read_b64_tr_b16 a[128:129], v120 offset:0
ds_read_b64_tr_b16 a[132:133], v121 offset:0
ds_read_b64_tr_b16 a[136:137], v122 offset:0
ds_read_b64_tr_b16 a[140:141], v123 offset:0
ds_read_b64_tr_b16 a[144:145], v96 offset:0
ds_read_b64_tr_b16 a[148:149], v97 offset:0
ds_read_b64_tr_b16 a[152:153], v98 offset:0
ds_read_b64_tr_b16 a[156:157], v99 offset:0
s_add_u32 s43, s52, 180224
s_and_b32 s43, s43, 0x7ffff
s_add_u32 m0, s42, 147456
s_nop 0
DH 116,24,0
s_add_u32 s43, s43, 3072
DH 117,24,1024
s_add_u32 s43, s43, 3072
DH 116,24,2048
s_add_u32 s43, s43, 3072
DH 117,24,3072
WM 8
WL 0
ds_read_b64_tr_b16 a[130:131], v120 offset:16384
ds_read_b64_tr_b16 a[134:135], v121 offset:16384
ds_read_b64_tr_b16 a[138:139], v122 offset:16384
ds_read_b64_tr_b16 a[142:143], v123 offset:16384
ds_read_b64_tr_b16 a[146:147], v96 offset:16384
ds_read_b64_tr_b16 a[150:151], v97 offset:16384
ds_read_b64_tr_b16 a[154:155], v98 offset:16384
ds_read_b64_tr_b16 a[158:159], v99 offset:16384
s_add_u32 s43, s52, 196608
s_and_b32 s43, s43, 0x7ffff
s_add_u32 m0, s42, 98304
s_nop 0
DH 116,24,0
s_add_u32 s43, s43, 3072
DH 117,24,1024
s_add_u32 s43, s43, 3072
DH 116,24,2048
s_add_u32 s43, s43, 3072
DH 117,24,3072
WM 8
WL 0
ds_read_b64_tr_b16 a[160:161], v120 offset:32768
ds_read_b64_tr_b16 a[164:165], v121 offset:32768
ds_read_b64_tr_b16 a[168:169], v122 offset:32768
ds_read_b64_tr_b16 a[172:173], v123 offset:32768
ds_read_b64_tr_b16 a[176:177], v96 offset:32768
ds_read_b64_tr_b16 a[180:181], v97 offset:32768
ds_read_b64_tr_b16 a[184:185], v98 offset:32768
ds_read_b64_tr_b16 a[188:189], v99 offset:32768
s_add_u32 s43, s52, 212992
s_and_b32 s43, s43, 0x7ffff
s_add_u32 m0, s42, 114688
s_nop 0
DH 116,24,0
s_add_u32 s43, s43, 3072
DH 117,24,1024
s_add_u32 s43, s43, 3072
DH 116,24,2048
s_add_u32 s43, s43, 3072
DH 117,24,3072
WM 8
WL 0
ds_read_b64_tr_b16 a[162:163], v120 offset:49152
ds_read_b64_tr_b16 a[166:167], v121 offset:49152
ds_read_b64_tr_b16 a[170:171], v122 offset:49152
ds_read_b64_tr_b16 a[174:175], v123 offset:49152
ds_read_b64_tr_b16 a[178:179], v96 offset:49152
ds_read_b64_tr_b16 a[182:183], v97 offset:49152
ds_read_b64_tr_b16 a[186:187], v98 offset:49152
ds_read_b64_tr_b16 a[190:191], v99 offset:49152
s_add_u32 s43, s52, 229376
s_and_b32 s43, s43, 0x7ffff
s_add_u32 m0, s42, 131072
s_nop 0
DH 116,24,0
s_add_u32 s43, s43, 3072
DH 117,24,1024
s_add_u32 s43, s43, 3072
DH 116,24,2048
s_add_u32 s43, s43, 3072
DH 117,24,3072
WM 8
WL 0
ds_read_b64_tr_b16 a[192:193], v120 offset:0
ds_read_b64_tr_b16 a[196:197], v121 offset:0
ds_read_b64_tr_b16 a[200:201], v122 offset:0
ds_read_b64_tr_b16 a[204:205], v123 offset:0
ds_read_b64_tr_b16 a[208:209], v96 offset:0
ds_read_b64_tr_b16 a[212:213], v97 offset:0
ds_read_b64_tr_b16 a[216:217], v98 offset:0
ds_read_b64_tr_b16 a[220:221], v99 offset:0
s_add_u32 s43, s52, 245760
s_and_b32 s43, s43, 0x7ffff
s_add_u32 m0, s42, 147456
s_nop 0
DH 116,24,0
s_add_u32 s43, s43, 3072
DH 117,24,1024
s_add_u32 s43, s43, 3072
DH 116,24,2048
s_add_u32 s43, s43, 3072
DH 117,24,3072
WM 8
WL 0
ds_read_b64_tr_b16 a[194:195], v120 offset:16384
ds_read_b64_tr_b16 a[198:199], v121 offset:16384
ds_read_b64_tr_b16 a[202:203], v122 offset:16384
ds_read_b64_tr_b16 a[206:207], v123 offset:16384
ds_read_b64_tr_b16 a[210:211], v96 offset:16384
ds_read_b64_tr_b16 a[214:215], v97 offset:16384
ds_read_b64_tr_b16 a[218:219], v98 offset:16384
ds_read_b64_tr_b16 a[222:223], v99 offset:16384
s_add_u32 s43, s52, 262144
s_and_b32 s43, s43, 0x7ffff
s_add_u32 m0, s42, 98304
s_nop 0
DH 116,24,0
s_add_u32 s43, s43, 3072
DH 117,24,1024
s_add_u32 s43, s43, 3072
DH 116,24,2048
s_add_u32 s43, s43, 3072
DH 117,24,3072
WM 8
WL 0
ds_read_b64_tr_b16 a[224:225], v120 offset:32768
ds_read_b64_tr_b16 a[228:229], v121 offset:32768
ds_read_b64_tr_b16 a[232:233], v122 offset:32768
ds_read_b64_tr_b16 a[236:237], v123 offset:32768
ds_read_b64_tr_b16 a[240:241], v96 offset:32768
ds_read_b64_tr_b16 a[244:245], v97 offset:32768
ds_read_b64_tr_b16 a[248:249], v98 offset:32768
ds_read_b64_tr_b16 a[252:253], v99 offset:32768
s_add_u32 s43, s52, 278528
s_and_b32 s43, s43, 0x7ffff
s_add_u32 m0, s42, 114688
s_nop 0
DH 116,24,0
s_add_u32 s43, s43, 3072
DH 117,24,1024
s_add_u32 s43, s43, 3072
DH 116,24,2048
s_add_u32 s43, s43, 3072
DH 117,24,3072
WM 8
WL 0
ds_read_b64_tr_b16 a[226:227], v120 offset:49152
ds_read_b64_tr_b16 a[230:231], v121 offset:49152
ds_read_b64_tr_b16 a[234:235], v122 offset:49152
ds_read_b64_tr_b16 a[238:239], v123 offset:49152
ds_read_b64_tr_b16 a[242:243], v96 offset:49152
ds_read_b64_tr_b16 a[246:247], v97 offset:49152
ds_read_b64_tr_b16 a[250:251], v98 offset:49152
ds_read_b64_tr_b16 a[254:255], v99 offset:49152
s_add_u32 s43, s52, 294912
s_and_b32 s43, s43, 0x7ffff
s_add_u32 m0, s42, 131072
s_nop 0
DH 116,24,0
s_add_u32 s43, s43, 3072
DH 117,24,1024
s_add_u32 s43, s43, 3072
DH 116,24,2048
s_add_u32 s43, s43, 3072
DH 117,24,3072
WM 8
WL 0
TR 128,120,0
TR 132,121,0
TR 136,122,0
TR 140,123,0
TR 144,96,0
TR 148,97,0
TR 152,98,0
TR 156,99,0
s_add_u32 s43, s52, 311296
s_and_b32 s43, s43, 0x7ffff
s_add_u32 m0, s42, 147456
s_nop 0
DH 116,24,0
s_add_u32 s43, s43, 3072
DH 117,24,1024
s_add_u32 s43, s43, 3072
DH 116,24,2048
s_add_u32 s43, s43, 3072
DH 117,24,3072
WM 8
WL 0
TR 130,120,16384
TR 134,121,16384
TR 138,122,16384
TR 142,123,16384
TR 146,96,16384
TR 150,97,16384
TR 154,98,16384
TR 158,99,16384
s_add_u32 s43, s52, 327680
s_and_b32 s43, s43, 0x7ffff
s_add_u32 m0, s42, 98304
s_nop 0
DH 116,24,0
s_add_u32 s43, s43, 3072
DH 117,24,1024
s_add_u32 s43, s43, 3072
DH 116,24,2048
s_add_u32 s43, s43, 3072
DH 117,24,3072
WM 8
WL 0
TR 160,120,32768
TR 164,121,32768
TR 168,122,32768
TR 172,123,32768
TR 176,96,32768
TR 180,97,32768
TR 184,98,32768
TR 188,99,32768
s_add_u32 s43, s52, 344064
s_and_b32 s43, s43, 0x7ffff
s_add_u32 m0, s42, 114688
s_nop 0
DH 116,24,0
s_add_u32 s43, s43, 3072
DH 117,24,1024
s_add_u32 s43, s43, 3072
DH 116,24,2048
s_add_u32 s43, s43, 3072
DH 117,24,3072
WM 8
WL 0
TR 162,120,49152
TR 166,121,49152
TR 170,122,49152
TR 174,123,49152
TR 178,96,49152
TR 182,97,49152
TR 186,98,49152
TR 190,99,49152
s_add_u32 s43, s52, 360448
s_and_b32 s43, s43, 0x7ffff
s_add_u32 m0, s42, 131072
s_nop 0
DH 116,24,0
s_add_u32 s43, s43, 3072
DH 117,24,1024
s_add_u32 s43, s43, 3072
DH 116,24,2048
s_add_u32 s43, s43, 3072
DH 117,24,3072
WM 8
WL 0
TR 192,120,0
TR 196,121,0
TR 200,122,0
TR 204,123,0
TR 208,96,0
TR 212,97,0
TR 216,98,0
TR 220,99,0
s_add_u32 s43, s52, 376832
s_and_b32 s43, s43, 0x7ffff
s_add_u32 m0, s42, 147456
s_nop 0
DH 116,24,0
s_add_u32 s43, s43, 3072
DH 117,24,1024
s_add_u32 s43, s43, 3072
DH 116,24,2048
s_add_u32 s43, s43, 3072
DH 117,24,3072
WM 8
WL 0
TR 194,120,16384
TR 198,121,16384
TR 202,122,16384
TR 206,123,16384
TR 210,96,16384
TR 214,97,16384
TR 218,98,16384
TR 222,99,16384
WM 4
WL 0
TR 224,120,32768
TR 228,121,32768
TR 232,122,32768
TR 236,123,32768
TR 240,96,32768
TR 244,97,32768
TR 248,98,32768
TR 252,99,32768
WM 0
WL 0
TR 226,120,49152
TR 230,121,49152
TR 234,122,49152
TR 238,123,49152
TR 242,96,49152
TR 246,97,49152
TR 250,98,49152
TR 254,99,49152
WL 0
s_setpc_b64 s[60:61]
L_codeend:
.section .rodata,"a"
.p2align 6
.amdhsa_kernel standalone__gqa_block_cached__sampling_kernel
  .amdhsa_next_free_vgpr 512
  .amdhsa_next_free_sgpr 102
  .amdhsa_accum_offset 256
  .amdhsa_group_segment_fixed_size 0
  .amdhsa_kernarg_size 64
  .amdhsa_user_sgpr_count 2
  .amdhsa_user_sgpr_kernarg_segment_ptr 1
  .amdhsa_system_sgpr_workgroup_id_x 1
.end_amdhsa_kernel
```
